```python
import torch

def _softmax(x, axis=-1):
    return torch.softmax(x, dim=axis)

def _gelu(x):
    return torch.nn.functional.gelu(x, approximate='tanh')

def _silu(x):
    return torch.nn.functional.silu(x)

def _sigmoid(x):
    return torch.sigmoid(x)

def _layernorm(x, axis=-1, eps=1e-05):
    m = x.mean(dim=axis, keepdim=True)
    v = x.var(dim=axis, keepdim=True, unbiased=False)
    return (x - m) / torch.sqrt(v + eps)

def _scatter_add(tgt, idx, src, axis=0):
    return tgt.clone().index_add_(axis, idx, src)

def _segment_sum(src, seg, n):
    out = torch.zeros((n,) + src.shape[1:], dtype=src.dtype)
    return out.index_add_(0, seg, src)

def _pad(x, pw):
    flat = tuple((v for pair in reversed(pw) for v in pair))
    return torch.nn.functional.pad(x, flat)
kernel_name = 'recurrent_scan__grouped_kv_mqa__mixer_gmlp__prompt'

def setup_inputs():

    _w = lambda a: (lambda t: t.to(torch.bfloat16) if t.is_floating_point() else t)(torch.as_tensor(a))

    def _A_setup():
        B, S, D, H = (1, 2048, 640, 32)
        Dh = D // H
        return {'x': _w((lambda *s: torch.randn(*s, dtype=torch.bfloat16) * 0.05)(B, S, D)), 'wq': _w((lambda *s: torch.randn(*s, dtype=torch.bfloat16) * 0.05)(D, H * Dh)), 'wk': _w((lambda *s: torch.randn(*s, dtype=torch.bfloat16) * 0.05)(D, Dh)), 'wv': _w((lambda *s: torch.randn(*s, dtype=torch.bfloat16) * 0.05)(D, Dh)), 'wo': _w((lambda *s: torch.randn(*s, dtype=torch.bfloat16) * 0.05)(H * Dh, D))}
    _A_in = _A_setup()

    def _B_setup():
        B, S, D, F = (1, 2048, 640, 1728)
        Fh = F // 2
        return {'x': _w((lambda *s: torch.randn(*s, dtype=torch.bfloat16) * 0.05)(B, S, D)), 'w_in': _w((lambda *s: torch.randn(*s, dtype=torch.bfloat16) * 1.6)(D, 2 * Fh)), 'w_sp': _w(0.01 * (lambda *s: torch.randn(*s, dtype=torch.bfloat16) * 1.6)(S, S)), 'b_sp': _w(1.0 + 0.01 * (lambda *s: torch.randn(*s, dtype=torch.bfloat16) * 0.05)(S)), 'w_out': _w((lambda *s: torch.randn(*s, dtype=torch.bfloat16) * 0.05)(Fh, D))}
    _B_in = _B_setup()
    return {'A_x': _A_in['x'], 'A_wq': _A_in['wq'], 'A_wk': _A_in['wk'], 'A_wv': _A_in['wv'], 'A_wo': _A_in['wo'], 'B_x': _B_in['x'], 'B_w_in': _B_in['w_in'], 'B_w_sp': _B_in['w_sp'], 'B_b_sp': _B_in['b_sp'], 'B_w_out': _B_in['w_out']}

def reference(A_x, A_wq, A_wk, A_wv, A_wo, B_x, B_w_in, B_w_sp, B_b_sp, B_w_out):

    def _A_ref(x, wq, wk, wv, wo):
        B, S, D = x.shape
        H = 32
        Dh = D // H
        q = (lambda x, *d: x.permute(*d))((x @ wq).reshape(B, S, H, Dh), 0, 2, 1, 3)
        k = x @ wk
        v = x @ wv
        scores = torch.einsum('bhqd,bkd->bhqk', q, k) * Dh ** (-0.5)
        p = _softmax(scores, axis=-1)
        o = torch.einsum('bhqk,bkd->bhqd', p, v)
        return (lambda x, *d: x.permute(*d))(o, 0, 2, 1, 3).reshape(B, S, H * Dh) @ wo

    def _B_ref(x, w_in, w_sp, b_sp, w_out):
        B, S, D = x.shape
        F = w_in.shape[-1]
        Fh = F // 2
        z = _gelu(torch.einsum('bsd,df->bsf', x, w_in))
        z1 = z[..., :Fh].clone()
        z2 = _layernorm(z[..., Fh:], axis=-1)
        g = torch.einsum('ts,bsf->btf', w_sp, z2) + b_sp[None, :, None]
        return torch.einsum('bsf,fd->bsd', z1 * g, w_out)
    x = A_x
    xn = _layernorm(x, axis=-1)
    s = _A_ref(xn, A_wq, A_wk, A_wv, A_wo)
    g = _silu(_B_ref(xn, B_w_in, B_w_sp, B_b_sp, B_w_out))
    return x + s * g
```

```asm
; @launch grid=(256,1,1) block=(512,1,1) lds=163840
.amdgcn_target "amdgcn-amd-amdhsa--gfx950"
.text
.globl recurrent_scan__grouped_kv_mqa__mixer_gmlp__prompt_kernel
.p2align 8
.type recurrent_scan__grouped_kv_mqa__mixer_gmlp__prompt_kernel,@function
recurrent_scan__grouped_kv_mqa__mixer_gmlp__prompt_kernel:
    s_cmp_ge_u32 s2, 256
    s_cbranch_scc1 L_end
    s_load_dwordx16 s[64:79], s[0:1], 0
    s_load_dwordx8 s[80:87], s[0:1], 64
    s_load_dwordx2 s[88:89], s[0:1], 96
    v_lshrrev_b32 v4, 6, v0
    v_and_b32 v1, 63, v0
    v_readfirstlane_b32 s52, v4
    v_lshlrev_b32 v7, 4, v1
    s_cmp_le_u32 s52, 1
    s_cbranch_scc0 Le_1
    s_getpc_b64 s[6:7]
L_pc:
    s_lshr_b32 s60, s2, 3
    s_lshl_b32 s61, s52, 5
    s_add_u32 s60, s60, s61
    s_lshl_b32 s60, s60, 10
    v_add_u32 v16, s60, v7
    v_min_u32 v16, L_end-L_pc-16, v16
    global_load_dwordx4 v[220:223], v16, s[6:7]
Le_1:
    v_and_b32 v2, 31, v0
    v_bfe_u32 v3, v0, 5, 1
    s_and_b32 s60, s2, 7
    s_lshr_b32 s61, s2, 3
    s_lshr_b32 s53, s60, 1
    s_lshl_b32 s53, s53, 3
    s_lshr_b32 s62, s61, 2
    s_add_u32 s53, s53, s62
    s_and_b32 s54, s60, 1
    s_lshl_b32 s54, s54, 2
    s_and_b32 s62, s61, 3
    s_add_u32 s54, s54, s62
    s_mov_b32 s6, 0x0C080400
    s_mov_b32 s7, 0x1816120E
    s_lshl_b32 s62, s54, 3
    s_lshr_b64 s[6:7], s[6:7], s62
    s_and_b32 s55, s6, 0xff
    s_lshl_b32 s62, s54, 2
    s_lshr_b32 s63, 0x32442444, s62
    s_and_b32 s56, s63, 7
    s_and_b32 s62, s52, 3
    s_sub_u32 s62, s62, 1
    s_max_i32 s62, s62, 0
    s_cmp_eq_u32 s54, 3
    s_cselect_b32 s57, s62, 0
    s_lshr_b32 s58, s52, 2
    s_and_b32 s62, s54, 3
    s_lshl_b32 s62, s62, 1
    s_and_b32 s59, s53, 7
    s_add_u32 s59, s59, s62
    s_cmp_ge_u32 s59, 10
    s_cselect_b32 s62, 10, 0
    s_sub_u32 s90, s59, s62
    v_lshrrev_b32 v4, 3, v1
    v_mul_u32_u24 v4, 1280, v4
    s_and_b32 s62, s52, 1
    s_lshl_b32 s62, s62, 2
    v_lshrrev_b32 v5, 4, v1
    v_or_b32 v5, s62, v5
    v_and_b32 v6, 7, v1
    v_xor_b32 v5, v5, v6
    v_lshl_add_u32 v4, v5, 4, v4
    s_and_b32 s62, s54, 1
    s_lshl_b32 s62, s62, 2
    s_xor_b32 s97, s62, s52
    s_lshl_b32 s62, s53, 3
    s_add_u32 s62, s62, s97
    s_mul_i32 s63, s62, 10240
    s_waitcnt lgkmcnt(0)
    s_mov_b32 s8, s64
    s_mov_b32 s9, s65
    s_mov_b32 s10, 0x280000
    s_mov_b32 s11, 0x00020000
    s_lshl_b32 s62, s90, 7
    s_add_u32 s60, s63, s62
    buffer_load_dwordx4 v[176:179], v4, s[8:11], s60 offen
    s_add_u32 s62, s62, 128
    s_cmp_eq_u32 s62, 1280
    s_cselect_b32 s62, 0, s62
    s_add_u32 s60, s63, s62
    buffer_load_dwordx4 v[180:183], v4, s[8:11], s60 offen
    s_add_u32 s62, s62, 128
    s_cmp_eq_u32 s62, 1280
    s_cselect_b32 s62, 0, s62
    s_add_u32 s60, s63, s62
    buffer_load_dwordx4 v[184:187], v4, s[8:11], s60 offen
    s_add_u32 s62, s62, 128
    s_cmp_eq_u32 s62, 1280
    s_cselect_b32 s62, 0, s62
    s_add_u32 s60, s63, s62
    buffer_load_dwordx4 v[188:191], v4, s[8:11], s60 offen
    s_add_u32 s62, s62, 128
    s_cmp_eq_u32 s62, 1280
    s_cselect_b32 s62, 0, s62
    s_mov_b32 s39, s62
    v_mov_b32 v216, v4
    v_mov_b32 v8, 0
    v_mov_b32 v9, 0
    v_mov_b32 v10, 0
    v_mov_b32 v11, 0
    v_mov_b32 v12, 0
    v_mov_b32 v46, 0
    v_mov_b32 v232, 0
    v_mov_b32 v233, 0
    v_mov_b32 v234, 0
    v_mov_b32 v235, 0
    v_mov_b32 v236, 0
    s_lshr_b32 s60, s52, 2
    s_lshl_b32 s60, s60, 12
    v_lshrrev_b32 v4, 3, v2
    v_lshlrev_b32 v4, 10, v4
    v_and_b32 v5, 7, v2
    v_lshl_add_u32 v4, v5, 7, v4
    v_bfe_u32 v5, v2, 1, 3
    v_xor_b32 v5, v5, v3
    v_lshl_add_u32 v4, v5, 4, v4
    v_add_u32 v240, s60, v4
    v_xor_b32 v241, 32, v240
    v_xor_b32 v242, 64, v240
    v_xor_b32 v243, 96, v240
    v_lshrrev_b32 v4, 4, v1
    v_lshlrev_b32 v5, 2, v4
    v_and_b32 v6, 15, v1
    v_xor_b32 v5, v5, v6
    v_mul_u32_u24 v4, 3456, v4
    v_lshl_add_u32 v245, v5, 4, v4
    v_lshrrev_b32 v6, 2, v5
    v_and_b32 v5, 3, v5
    v_lshlrev_b32 v5, 4, v5
    s_add_u32 s60, s55, 1
    v_add_u32 v9, s60, v6
    v_cmp_gt_u32 vcc, 27, v9
    s_nop 1
    v_cndmask_b32 v9, 0, v9, vcc
    v_lshl_add_u32 v9, v9, 6, v5
    v_add_u32 v9, 1728, v9
    v_mov_b32 v10, s76
    v_mov_b32 v11, s77
    v_mov_b32 v12, 3456
    s_cmp_eq_u32 s54, 3
    s_cbranch_scc0 Le_2
    v_min_u32 v5, 24, v5
    v_cmp_eq_u32 vcc, 2, v6
    v_mov_b32 v13, s68
    s_nop 0
    v_cndmask_b32 v10, v10, v13, vcc
    v_mov_b32 v13, s69
    v_cndmask_b32 v11, v11, v13, vcc
    v_cndmask_b32 v12, v12, 40, vcc
    v_cndmask_b32 v9, v9, v5, vcc
    v_cmp_eq_u32 vcc, 3, v6
    v_mov_b32 v13, s70
    s_nop 0
    v_cndmask_b32 v10, v10, v13, vcc
    v_mov_b32 v13, s71
    v_cndmask_b32 v11, v11, v13, vcc
    v_cndmask_b32 v12, v12, 40, vcc
    v_cndmask_b32 v9, v9, v5, vcc
Le_2:
    s_lshl_b32 s60, s90, 4
    s_add_u32 s60, s60, s52
    s_lshl_b32 s60, s60, 2
    v_lshrrev_b32 v13, 4, v1
    v_add_u32 v13, s60, v13
    v_mad_u64_u32 v[10:11], vcc, v12, v13, v[10:11]
    v_mad_u64_u32 v[10:11], vcc, v9, 1, v[10:11]
    v_lshrrev_b32 v4, 4, v1
    v_bfe_u32 v5, v1, 2, 2
    v_and_b32 v6, 3, v1
    v_lshrrev_b32 v14, 1, v4
    v_lshl_add_u32 v14, v14, 3, v5
    v_lshlrev_b32 v15, 8, v14
    s_and_b32 s60, s52, 3
    v_xor_b32 v13, s60, v5
    v_lshl_add_u32 v15, v13, 6, v15
    v_and_b32 v13, 1, v4
    v_lshlrev_b32 v13, 5, v13
    v_lshl_add_u32 v13, v6, 3, v13
    v_add_u32 v15, v15, v13
    v_add_u32 v246, 0x14000, v15
    s_cmp_lg_u32 s57, 0
    s_cselect_b32 s61, 8, 0
    v_and_b32 v4, 1, v4
    v_mad_u32_u24 v246, v4, s61, v246
    v_add_u32 v15, v14, v5
    v_mul_u32_u24 v15, 160, v15
    s_lshl_b32 s61, s60, 6
    v_add_u32 v15, s61, v15
    v_add_u32 v244, v15, v13
    s_mul_i32 s61, s52, 2304
    s_add_u32 s61, s61, 63488
    v_mul_u32_u24 v15, 72, v14
    v_add3_u32 v15, v15, v13, s61
    v_mul_u32_u24 v14, 72, v2
    v_lshl_add_u32 v14, v3, 3, v14
    v_add_u32 v14, s61, v14
    s_mul_i32 s60, s58, 5376
    s_and_b32 s61, s52, 3
    s_lshl_b32 s61, s61, 6
    s_add_u32 s60, s60, s61
    s_add_u32 s60, s60, 147456
    v_mul_u32_u24 v247, 168, v2
    v_lshl_add_u32 v247, v3, 3, v247
    v_add_u32 v247, s60, v247
    v_add_u32 v13, 0x10000, v246
    s_lshr_b32 s37, 0x37, s52
    s_and_b32 s37, s37, 1
    s_sub_u32 s60, s52, s58
    s_min_u32 s60, s60, 4
    s_lshl_b32 s36, s60, 10
    s_lshl_b32 s60, s60, 6
    v_add_u32 v4, s60, v1
    v_mul_u32_u24 v5, 6554, v4
    v_lshrrev_b32 v5, 16, v5
    v_mul_u32_u24 v8, 10, v5
    v_sub_u32 v4, v4, v8
    v_lshlrev_b32 v4, 4, v4
    v_and_b32 v8, 1, v5
    v_lshlrev_b32 v8, 2, v8
    v_and_or_b32 v8, v5, 56, v8
    v_bfe_u32 v5, v5, 1, 2
    v_or_b32 v5, v5, v8
    v_mul_u32_u24 v5, 1280, v5
    v_add_u32 v8, v5, v4
    s_mul_i32 s38, s90, 81920
    s_mul_i32 s96, s54, 160
    s_mul_i32 s60, s52, 13824
    s_lshl_b32 s61, s55, 6
    s_add_u32 s92, s60, s61
    s_mov_b32 s91, s90
    s_lshl_b32 s93, s52, 10
    s_mul_i32 s90, s90, 221184
    s_add_u32 s60, s63, s39
    buffer_load_dwordx4 v[192:195], v216, s[8:11], s60 offen
    s_add_u32 s39, s39, 128
    s_cmp_eq_u32 s39, 1280
    s_cselect_b32 s39, 0, s39
    s_add_u32 s60, s63, s39
    buffer_load_dwordx4 v[196:199], v216, s[8:11], s60 offen
    s_add_u32 s39, s39, 128
    s_cmp_eq_u32 s39, 1280
    s_cselect_b32 s39, 0, s39
    s_add_u32 s60, s63, s39
    buffer_load_dwordx4 v[200:203], v216, s[8:11], s60 offen
    s_add_u32 s39, s39, 128
    s_cmp_eq_u32 s39, 1280
    s_cselect_b32 s39, 0, s39
    s_add_u32 s60, s63, s39
    buffer_load_dwordx4 v[204:207], v216, s[8:11], s60 offen
    s_add_u32 s39, s39, 128
    s_cmp_eq_u32 s39, 1280
    s_cselect_b32 s39, 0, s39
    s_add_u32 s60, s63, s39
    buffer_load_dwordx4 v[208:211], v216, s[8:11], s60 offen
    s_add_u32 s39, s39, 128
    s_cmp_eq_u32 s39, 1280
    s_cselect_b32 s39, 0, s39
    s_add_u32 s60, s63, s39
    buffer_load_dwordx4 v[212:215], v216, s[8:11], s60 offen
    s_mov_b32 s12, s66
    s_mov_b32 s13, s67
    s_mov_b32 s14, 0xc8000
    s_mov_b32 s15, 0x00020000
    s_mov_b32 s20, s76
    s_mov_b32 s21, s77
    s_mov_b32 s22, 0x21c000
    s_mov_b32 s23, 0x00020000
    s_mov_b32 s24, s78
    s_mov_b32 s25, s79
    s_mov_b32 s26, 0x800000
    s_mov_b32 s27, 0x00020000
    s_mov_b32 s28, s80
    s_mov_b32 s29, s81
    s_mov_b32 s30, 0x1000
    s_mov_b32 s31, 0x00020000
    s_lshl_b32 s60, s53, 1
    s_add_u32 s100, s60, s58
    s_mov_b32 s62, 819200
    s_cmp_lt_u32 s100, 27
    s_cselect_b32 s32, s82, s72
    s_cselect_b32 s33, s83, s73
    s_cselect_b32 s34, 1105920, s62
    s_mov_b32 s35, 0x00020000
    s_mov_b32 s40, s84
    s_mov_b32 s41, s85
    s_mov_b32 s42, 0x280000
    s_mov_b32 s43, 0x00020000
    s_mov_b32 s48, s86
    s_mov_b32 s49, s87
    s_mov_b32 s50, 0x100
    s_mov_b32 s51, 0x00020000
    s_mov_b32 s44, s88
    s_mov_b32 s45, s89
    s_mov_b32 s46, 0x1100000
    s_mov_b32 s47, 0x00020000
    s_and_b32 s60, s52, 3
    s_lshl_b32 s60, s60, 16
    s_add_u32 s60, s60, 0x40000
    s_add_u32 s16, s88, s60
    s_addc_u32 s17, s89, 0
    s_mov_b32 s18, 0x10000
    s_mov_b32 s19, 0x00020000
    s_cmp_le_u32 s52, 4
    s_cbranch_scc1 Le_3
    s_cmp_eq_u32 s52, 7
    s_cbranch_scc0 Le_4
    s_cmp_eq_u32 s2, 0
    s_cbranch_scc0 Le_3
    v_mov_b32 v16, 0
    v_mov_b32 v17, 0
    v_mov_b32 v18, 0
    v_mov_b32 v19, 0
    s_mov_b32 s60, 0
    buffer_store_dwordx4 v[16:19], v7, s[44:47], s60 offen sc1
    s_mov_b32 s60, 1024
    buffer_store_dwordx4 v[16:19], v7, s[44:47], s60 offen sc1
    s_mov_b32 s60, 2048
    buffer_store_dwordx4 v[16:19], v7, s[44:47], s60 offen sc1
    s_mov_b32 s60, 3072
    buffer_store_dwordx4 v[16:19], v7, s[44:47], s60 offen sc1
    s_mov_b32 s60, 4096
    buffer_store_dwordx4 v[16:19], v7, s[44:47], s60 offen sc1
    s_mov_b32 s60, 5120
    buffer_store_dwordx4 v[16:19], v7, s[44:47], s60 offen sc1
    s_mov_b32 s60, 6144
    buffer_store_dwordx4 v[16:19], v7, s[44:47], s60 offen sc1
    s_mov_b32 s60, 7168
    buffer_store_dwordx4 v[16:19], v7, s[44:47], s60 offen sc1
    s_mov_b32 s60, 8192
    buffer_store_dwordx4 v[16:19], v7, s[44:47], s60 offen sc1
    s_mov_b32 s60, 9216
    buffer_store_dwordx4 v[16:19], v7, s[44:47], s60 offen sc1
    s_mov_b32 s60, 10240
    buffer_store_dwordx4 v[16:19], v7, s[44:47], s60 offen sc1
    s_waitcnt vmcnt(0)
    v_mov_b32 v20, 1
    s_mov_b64 exec, 1
    buffer_store_dword v20, v16, s[48:51], 0 offen sc1
    s_mov_b64 exec, -1
    s_branch Le_3
Le_4:
Le_3:
    s_and_b32 s60, s52, 3
    s_cmp_eq_u32 s60, 3
    s_cbranch_scc0 Le_6
    s_sub_u32 s61, s100, 27
    s_lshl_b32 s61, s61, 2
    s_lshl_b32 s62, s100, 5
    v_lshrrev_b32 v4, 4, v2
    v_bfe_u32 v6, v2, 2, 1
    v_lshl_add_u32 v4, v4, 1, v6
    v_add_u32 v4, s61, v4
    v_mul_u32_u24 v6, 205, v4
    v_lshrrev_b32 v6, 11, v6
    v_mul_u32_u24 v16, 10, v6
    v_sub_u32 v4, v4, v16
    v_bfe_u32 v16, v2, 3, 1
    v_lshrrev_b32 v17, 1, v4
    v_mul_u32_u24 v17, 20, v17
    v_and_b32 v18, 1, v4
    v_lshl_add_u32 v17, v18, 2, v17
    v_lshl_add_u32 v17, v16, 3, v17
    v_lshl_add_u32 v18, v18, 1, v16
    v_mul_u32_u24 v18, 20, v18
    v_add_u32 v18, 16, v18
    v_cmp_gt_u32 vcc, 8, v4
    s_nop 1
    v_cndmask_b32 v17, v18, v17, vcc
    v_and_b32 v18, 3, v2
    v_mul_u32_u24 v6, 80, v6
    v_add3_u32 v17, v17, v18, v6
    v_add_u32 v5, s62, v2
    s_cmp_lt_u32 s100, 27
    s_cselect_b64 vcc, -1, 0
    v_cndmask_b32 v5, v17, v5, vcc
    v_mul_u32_u24 v5, 1280, v5
    v_add_u32 v4, 0, v1
    v_mul_u32_u24 v6, 6554, v4
    v_lshrrev_b32 v6, 16, v6
    v_mul_u32_u24 v16, 10, v6
    v_sub_u32 v20, v4, v16
    v_lshlrev_b32 v6, 2, v6
    ds_bpermute_b32 v232, v6, v5
    v_add_u32 v4, 64, v1
    v_mul_u32_u24 v6, 6554, v4
    v_lshrrev_b32 v6, 16, v6
    v_mul_u32_u24 v16, 10, v6
    v_sub_u32 v21, v4, v16
    v_lshlrev_b32 v6, 2, v6
    ds_bpermute_b32 v233, v6, v5
    v_add_u32 v4, 128, v1
    v_mul_u32_u24 v6, 6554, v4
    v_lshrrev_b32 v6, 16, v6
    v_mul_u32_u24 v16, 10, v6
    v_sub_u32 v22, v4, v16
    v_lshlrev_b32 v6, 2, v6
    ds_bpermute_b32 v234, v6, v5
    v_add_u32 v4, 192, v1
    v_mul_u32_u24 v6, 6554, v4
    v_lshrrev_b32 v6, 16, v6
    v_mul_u32_u24 v16, 10, v6
    v_sub_u32 v23, v4, v16
    v_lshlrev_b32 v6, 2, v6
    ds_bpermute_b32 v235, v6, v5
    v_add_u32 v4, 256, v1
    v_mul_u32_u24 v6, 6554, v4
    v_lshrrev_b32 v6, 16, v6
    v_mul_u32_u24 v16, 10, v6
    v_sub_u32 v24, v4, v16
    v_lshlrev_b32 v6, 2, v6
    ds_bpermute_b32 v236, v6, v5
    s_waitcnt lgkmcnt(0)
    v_lshl_add_u32 v232, v20, 4, v232
    v_lshl_add_u32 v233, v21, 4, v233
    v_lshl_add_u32 v234, v22, 4, v234
    v_lshl_add_u32 v235, v23, 4, v235
    v_lshl_add_u32 v236, v24, 4, v236
Le_6:
    s_waitcnt vmcnt(6)
    s_mov_b32 s62, 0x3f803f80
    v_dot2_f32_bf16 v16, v176, s62, 0
    v_dot2_f32_bf16 v20, v176, v176, 0
    v_dot2_f32_bf16 v17, v177, s62, 0
    v_dot2_f32_bf16 v21, v177, v177, 0
    v_dot2_f32_bf16 v18, v178, s62, 0
    v_dot2_f32_bf16 v22, v178, v178, 0
    v_dot2_f32_bf16 v19, v179, s62, 0
    v_dot2_f32_bf16 v23, v179, v179, 0
    v_dot2_f32_bf16 v16, v180, s62, v16
    v_dot2_f32_bf16 v20, v180, v180, v20
    v_dot2_f32_bf16 v17, v181, s62, v17
    v_dot2_f32_bf16 v21, v181, v181, v21
    v_dot2_f32_bf16 v18, v182, s62, v18
    v_dot2_f32_bf16 v22, v182, v182, v22
    v_dot2_f32_bf16 v19, v183, s62, v19
    v_dot2_f32_bf16 v23, v183, v183, v23
    v_dot2_f32_bf16 v16, v184, s62, v16
    v_dot2_f32_bf16 v20, v184, v184, v20
    v_dot2_f32_bf16 v17, v185, s62, v17
    v_dot2_f32_bf16 v21, v185, v185, v21
    v_dot2_f32_bf16 v18, v186, s62, v18
    v_dot2_f32_bf16 v22, v186, v186, v22
    v_dot2_f32_bf16 v19, v187, s62, v19
    v_dot2_f32_bf16 v23, v187, v187, v23
    v_dot2_f32_bf16 v16, v188, s62, v16
    v_dot2_f32_bf16 v20, v188, v188, v20
    v_dot2_f32_bf16 v17, v189, s62, v17
    v_dot2_f32_bf16 v21, v189, v189, v21
    v_dot2_f32_bf16 v18, v190, s62, v18
    v_dot2_f32_bf16 v22, v190, v190, v22
    v_dot2_f32_bf16 v19, v191, s62, v19
    v_dot2_f32_bf16 v23, v191, v191, v23
    s_waitcnt vmcnt(5)
    v_dot2_f32_bf16 v16, v192, s62, v16
    v_dot2_f32_bf16 v20, v192, v192, v20
    v_dot2_f32_bf16 v17, v193, s62, v17
    v_dot2_f32_bf16 v21, v193, v193, v21
    v_dot2_f32_bf16 v18, v194, s62, v18
    v_dot2_f32_bf16 v22, v194, v194, v22
    v_dot2_f32_bf16 v19, v195, s62, v19
    v_dot2_f32_bf16 v23, v195, v195, v23
    s_waitcnt vmcnt(4)
    v_dot2_f32_bf16 v16, v196, s62, v16
    v_dot2_f32_bf16 v20, v196, v196, v20
    v_dot2_f32_bf16 v17, v197, s62, v17
    v_dot2_f32_bf16 v21, v197, v197, v21
    v_dot2_f32_bf16 v18, v198, s62, v18
    v_dot2_f32_bf16 v22, v198, v198, v22
    v_dot2_f32_bf16 v19, v199, s62, v19
    v_dot2_f32_bf16 v23, v199, v199, v23
    s_waitcnt vmcnt(3)
    v_dot2_f32_bf16 v16, v200, s62, v16
    v_dot2_f32_bf16 v20, v200, v200, v20
    v_dot2_f32_bf16 v17, v201, s62, v17
    v_dot2_f32_bf16 v21, v201, v201, v21
    v_dot2_f32_bf16 v18, v202, s62, v18
    v_dot2_f32_bf16 v22, v202, v202, v22
    v_dot2_f32_bf16 v19, v203, s62, v19
    v_dot2_f32_bf16 v23, v203, v203, v23
    s_waitcnt vmcnt(2)
    v_dot2_f32_bf16 v16, v204, s62, v16
    v_dot2_f32_bf16 v20, v204, v204, v20
    v_dot2_f32_bf16 v17, v205, s62, v17
    v_dot2_f32_bf16 v21, v205, v205, v21
    v_dot2_f32_bf16 v18, v206, s62, v18
    v_dot2_f32_bf16 v22, v206, v206, v22
    v_dot2_f32_bf16 v19, v207, s62, v19
    v_dot2_f32_bf16 v23, v207, v207, v23
    s_waitcnt vmcnt(1)
    v_dot2_f32_bf16 v16, v208, s62, v16
    v_dot2_f32_bf16 v20, v208, v208, v20
    v_dot2_f32_bf16 v17, v209, s62, v17
    v_dot2_f32_bf16 v21, v209, v209, v21
    v_dot2_f32_bf16 v18, v210, s62, v18
    v_dot2_f32_bf16 v22, v210, v210, v22
    v_dot2_f32_bf16 v19, v211, s62, v19
    v_dot2_f32_bf16 v23, v211, v211, v23
    s_waitcnt vmcnt(0)
    v_dot2_f32_bf16 v16, v212, s62, v16
    v_dot2_f32_bf16 v20, v212, v212, v20
    s_add_u32 m0, s93, 81920
    s_mov_b32 s60, 32
    global_load_lds_dwordx4 v[10:11], off
    v_mad_i64_i32 v[10:11], vcc, v12, s60, v[10:11]
    v_dot2_f32_bf16 v17, v213, s62, v17
    v_dot2_f32_bf16 v21, v213, v213, v21
    s_add_u32 m0, s93, 90112
    s_add_u32 s91, s91, 1
    s_cmp_eq_u32 s91, 10
    s_cselect_b32 s60, -608, 32
    global_load_lds_dwordx4 v[10:11], off
    v_mad_i64_i32 v[10:11], vcc, v12, s60, v[10:11]
    v_dot2_f32_bf16 v18, v214, s62, v18
    v_dot2_f32_bf16 v22, v214, v214, v22
    s_add_u32 m0, s93, 98304
    s_mov_b32 s60, 32
    global_load_lds_dwordx4 v[10:11], off
    v_mad_i64_i32 v[10:11], vcc, v12, s60, v[10:11]
    v_dot2_f32_bf16 v19, v215, s62, v19
    v_dot2_f32_bf16 v23, v215, v215, v23
    s_add_u32 m0, s93, 106496
    s_add_u32 s91, s91, 1
    s_cmp_eq_u32 s91, 10
    s_cselect_b32 s60, -608, 32
    global_load_lds_dwordx4 v[10:11], off
    v_mad_i64_i32 v[10:11], vcc, v12, s60, v[10:11]
    v_add_f32 v16, v16, v17
    v_add_f32 v18, v18, v19
    v_add_f32 v20, v20, v21
    v_add_f32 v22, v22, v23
    v_add_f32 v16, v16, v18
    v_add_f32 v20, v20, v22
    s_nop 0
    v_add_f32_dpp v16, v16, v16 quad_perm:[1,0,3,2] row_mask:0xf bank_mask:0xf
    v_add_f32_dpp v20, v20, v20 quad_perm:[1,0,3,2] row_mask:0xf bank_mask:0xf
    s_nop 0
    v_add_f32_dpp v16, v16, v16 quad_perm:[2,3,0,1] row_mask:0xf bank_mask:0xf
    v_add_f32_dpp v20, v20, v20 quad_perm:[2,3,0,1] row_mask:0xf bank_mask:0xf
    s_nop 0
    v_add_f32_dpp v16, v16, v16 row_half_mirror row_mask:0xf bank_mask:0xf
    v_add_f32_dpp v20, v20, v20 row_half_mirror row_mask:0xf bank_mask:0xf
    v_mul_f32 v16, 0x3acccccd, v16
    v_mul_f32 v20, 0x3acccccd, v20
    v_fma_f32 v20, -v16, v16, v20
    v_max_f32 v20, 0, v20
    v_add_f32 v20, 0x3727c5ac, v20
    v_rsq_f32 v20, v20
    v_lshl_add_u32 v22, s97, 10, v7
    v_mul_f32_e64 v21, -v16, v20
    s_mov_b32 s62, 0xffff0000
    v_add_u32 v23, 0x10000, v22
    v_lshlrev_b32 v24, 16, v176
    v_and_b32 v25, s62, v176
    v_lshlrev_b32 v26, 16, v177
    v_and_b32 v27, s62, v177
    v_lshlrev_b32 v28, 16, v178
    v_and_b32 v29, s62, v178
    v_lshlrev_b32 v30, 16, v179
    v_and_b32 v31, s62, v179
    v_pk_fma_f32 v[24:25], v[24:25], v[20:21], v[20:21] op_sel:[0,0,1] op_sel_hi:[1,0,1]
    v_pk_fma_f32 v[26:27], v[26:27], v[20:21], v[20:21] op_sel:[0,0,1] op_sel_hi:[1,0,1]
    v_pk_fma_f32 v[28:29], v[28:29], v[20:21], v[20:21] op_sel:[0,0,1] op_sel_hi:[1,0,1]
    v_pk_fma_f32 v[30:31], v[30:31], v[20:21], v[20:21] op_sel:[0,0,1] op_sel_hi:[1,0,1]
    v_cvt_pk_bf16_f32 v176, v24, v25
    v_cvt_pk_bf16_f32 v177, v26, v27
    v_cvt_pk_bf16_f32 v178, v28, v29
    v_cvt_pk_bf16_f32 v179, v30, v31
    ds_write_b128 v22, v[176:179] offset:0
    s_add_u32 m0, s93, 114688
    s_mov_b32 s60, 32
    global_load_lds_dwordx4 v[10:11], off
    v_mad_i64_i32 v[10:11], vcc, v12, s60, v[10:11]
    v_lshlrev_b32 v24, 16, v180
    v_and_b32 v25, s62, v180
    v_lshlrev_b32 v26, 16, v181
    v_and_b32 v27, s62, v181
    v_lshlrev_b32 v28, 16, v182
    v_and_b32 v29, s62, v182
    v_lshlrev_b32 v30, 16, v183
    v_and_b32 v31, s62, v183
    v_pk_fma_f32 v[24:25], v[24:25], v[20:21], v[20:21] op_sel:[0,0,1] op_sel_hi:[1,0,1]
    v_pk_fma_f32 v[26:27], v[26:27], v[20:21], v[20:21] op_sel:[0,0,1] op_sel_hi:[1,0,1]
    v_pk_fma_f32 v[28:29], v[28:29], v[20:21], v[20:21] op_sel:[0,0,1] op_sel_hi:[1,0,1]
    v_pk_fma_f32 v[30:31], v[30:31], v[20:21], v[20:21] op_sel:[0,0,1] op_sel_hi:[1,0,1]
    v_cvt_pk_bf16_f32 v180, v24, v25
    v_cvt_pk_bf16_f32 v181, v26, v27
    v_cvt_pk_bf16_f32 v182, v28, v29
    v_cvt_pk_bf16_f32 v183, v30, v31
    ds_write_b128 v22, v[180:183] offset:8192
    s_add_u32 m0, s93, 122880
    s_add_u32 s91, s91, 1
    s_cmp_eq_u32 s91, 10
    s_cselect_b32 s60, -608, 32
    global_load_lds_dwordx4 v[10:11], off
    v_mad_i64_i32 v[10:11], vcc, v12, s60, v[10:11]
    v_lshlrev_b32 v24, 16, v184
    v_and_b32 v25, s62, v184
    v_lshlrev_b32 v26, 16, v185
    v_and_b32 v27, s62, v185
    v_lshlrev_b32 v28, 16, v186
    v_and_b32 v29, s62, v186
    v_lshlrev_b32 v30, 16, v187
    v_and_b32 v31, s62, v187
    v_pk_fma_f32 v[24:25], v[24:25], v[20:21], v[20:21] op_sel:[0,0,1] op_sel_hi:[1,0,1]
    v_pk_fma_f32 v[26:27], v[26:27], v[20:21], v[20:21] op_sel:[0,0,1] op_sel_hi:[1,0,1]
    v_pk_fma_f32 v[28:29], v[28:29], v[20:21], v[20:21] op_sel:[0,0,1] op_sel_hi:[1,0,1]
    v_pk_fma_f32 v[30:31], v[30:31], v[20:21], v[20:21] op_sel:[0,0,1] op_sel_hi:[1,0,1]
    v_cvt_pk_bf16_f32 v184, v24, v25
    v_cvt_pk_bf16_f32 v185, v26, v27
    v_cvt_pk_bf16_f32 v186, v28, v29
    v_cvt_pk_bf16_f32 v187, v30, v31
    ds_write_b128 v22, v[184:187] offset:16384
    s_add_u32 m0, s93, 131072
    s_mov_b32 s60, 32
    global_load_lds_dwordx4 v[10:11], off
    v_mad_i64_i32 v[10:11], vcc, v12, s60, v[10:11]
    v_lshlrev_b32 v24, 16, v188
    v_and_b32 v25, s62, v188
    v_lshlrev_b32 v26, 16, v189
    v_and_b32 v27, s62, v189
    v_lshlrev_b32 v28, 16, v190
    v_and_b32 v29, s62, v190
    v_lshlrev_b32 v30, 16, v191
    v_and_b32 v31, s62, v191
    v_pk_fma_f32 v[24:25], v[24:25], v[20:21], v[20:21] op_sel:[0,0,1] op_sel_hi:[1,0,1]
    v_pk_fma_f32 v[26:27], v[26:27], v[20:21], v[20:21] op_sel:[0,0,1] op_sel_hi:[1,0,1]
    v_pk_fma_f32 v[28:29], v[28:29], v[20:21], v[20:21] op_sel:[0,0,1] op_sel_hi:[1,0,1]
    v_pk_fma_f32 v[30:31], v[30:31], v[20:21], v[20:21] op_sel:[0,0,1] op_sel_hi:[1,0,1]
    v_cvt_pk_bf16_f32 v188, v24, v25
    v_cvt_pk_bf16_f32 v189, v26, v27
    v_cvt_pk_bf16_f32 v190, v28, v29
    v_cvt_pk_bf16_f32 v191, v30, v31
    ds_write_b128 v22, v[188:191] offset:24576
    s_add_u32 m0, s93, 139264
    s_add_u32 s91, s91, 1
    s_cmp_eq_u32 s91, 10
    s_cselect_b32 s60, -608, 32
    global_load_lds_dwordx4 v[10:11], off
    v_mad_i64_i32 v[10:11], vcc, v12, s60, v[10:11]
    v_lshlrev_b32 v24, 16, v192
    v_and_b32 v25, s62, v192
    v_lshlrev_b32 v26, 16, v193
    v_and_b32 v27, s62, v193
    v_lshlrev_b32 v28, 16, v194
    v_and_b32 v29, s62, v194
    v_lshlrev_b32 v30, 16, v195
    v_and_b32 v31, s62, v195
    v_pk_fma_f32 v[24:25], v[24:25], v[20:21], v[20:21] op_sel:[0,0,1] op_sel_hi:[1,0,1]
    v_pk_fma_f32 v[26:27], v[26:27], v[20:21], v[20:21] op_sel:[0,0,1] op_sel_hi:[1,0,1]
    v_pk_fma_f32 v[28:29], v[28:29], v[20:21], v[20:21] op_sel:[0,0,1] op_sel_hi:[1,0,1]
    v_pk_fma_f32 v[30:31], v[30:31], v[20:21], v[20:21] op_sel:[0,0,1] op_sel_hi:[1,0,1]
    v_cvt_pk_bf16_f32 v192, v24, v25
    v_cvt_pk_bf16_f32 v193, v26, v27
    v_cvt_pk_bf16_f32 v194, v28, v29
    v_cvt_pk_bf16_f32 v195, v30, v31
    ds_write_b128 v22, v[192:195] offset:32768
    s_add_u32 m0, s93, 147456
    s_mov_b32 s60, 32
    global_load_lds_dwordx4 v[10:11], off
    v_mad_i64_i32 v[10:11], vcc, v12, s60, v[10:11]
    v_lshlrev_b32 v24, 16, v196
    v_and_b32 v25, s62, v196
    v_lshlrev_b32 v26, 16, v197
    v_and_b32 v27, s62, v197
    v_lshlrev_b32 v28, 16, v198
    v_and_b32 v29, s62, v198
    v_lshlrev_b32 v30, 16, v199
    v_and_b32 v31, s62, v199
    v_pk_fma_f32 v[24:25], v[24:25], v[20:21], v[20:21] op_sel:[0,0,1] op_sel_hi:[1,0,1]
    v_pk_fma_f32 v[26:27], v[26:27], v[20:21], v[20:21] op_sel:[0,0,1] op_sel_hi:[1,0,1]
    v_pk_fma_f32 v[28:29], v[28:29], v[20:21], v[20:21] op_sel:[0,0,1] op_sel_hi:[1,0,1]
    v_pk_fma_f32 v[30:31], v[30:31], v[20:21], v[20:21] op_sel:[0,0,1] op_sel_hi:[1,0,1]
    v_cvt_pk_bf16_f32 v196, v24, v25
    v_cvt_pk_bf16_f32 v197, v26, v27
    v_cvt_pk_bf16_f32 v198, v28, v29
    v_cvt_pk_bf16_f32 v199, v30, v31
    ds_write_b128 v22, v[196:199] offset:40960
    s_add_u32 m0, s93, 155648
    s_add_u32 s91, s91, 1
    s_cmp_eq_u32 s91, 10
    s_cselect_b32 s60, -608, 32
    global_load_lds_dwordx4 v[10:11], off
    v_mad_i64_i32 v[10:11], vcc, v12, s60, v[10:11]
    v_lshlrev_b32 v24, 16, v200
    v_and_b32 v25, s62, v200
    v_lshlrev_b32 v26, 16, v201
    v_and_b32 v27, s62, v201
    v_lshlrev_b32 v28, 16, v202
    v_and_b32 v29, s62, v202
    v_lshlrev_b32 v30, 16, v203
    v_and_b32 v31, s62, v203
    v_pk_fma_f32 v[24:25], v[24:25], v[20:21], v[20:21] op_sel:[0,0,1] op_sel_hi:[1,0,1]
    v_pk_fma_f32 v[26:27], v[26:27], v[20:21], v[20:21] op_sel:[0,0,1] op_sel_hi:[1,0,1]
    v_pk_fma_f32 v[28:29], v[28:29], v[20:21], v[20:21] op_sel:[0,0,1] op_sel_hi:[1,0,1]
    v_pk_fma_f32 v[30:31], v[30:31], v[20:21], v[20:21] op_sel:[0,0,1] op_sel_hi:[1,0,1]
    v_cvt_pk_bf16_f32 v200, v24, v25
    v_cvt_pk_bf16_f32 v201, v26, v27
    v_cvt_pk_bf16_f32 v202, v28, v29
    v_cvt_pk_bf16_f32 v203, v30, v31
    ds_write_b128 v22, v[200:203] offset:49152
    v_lshlrev_b32 v24, 16, v204
    v_and_b32 v25, s62, v204
    v_lshlrev_b32 v26, 16, v205
    v_and_b32 v27, s62, v205
    v_lshlrev_b32 v28, 16, v206
    v_and_b32 v29, s62, v206
    v_lshlrev_b32 v30, 16, v207
    v_and_b32 v31, s62, v207
    v_pk_fma_f32 v[24:25], v[24:25], v[20:21], v[20:21] op_sel:[0,0,1] op_sel_hi:[1,0,1]
    v_pk_fma_f32 v[26:27], v[26:27], v[20:21], v[20:21] op_sel:[0,0,1] op_sel_hi:[1,0,1]
    v_pk_fma_f32 v[28:29], v[28:29], v[20:21], v[20:21] op_sel:[0,0,1] op_sel_hi:[1,0,1]
    v_pk_fma_f32 v[30:31], v[30:31], v[20:21], v[20:21] op_sel:[0,0,1] op_sel_hi:[1,0,1]
    v_cvt_pk_bf16_f32 v204, v24, v25
    v_cvt_pk_bf16_f32 v205, v26, v27
    v_cvt_pk_bf16_f32 v206, v28, v29
    v_cvt_pk_bf16_f32 v207, v30, v31
    ds_write_b128 v22, v[204:207] offset:57344
    v_lshlrev_b32 v24, 16, v208
    v_and_b32 v25, s62, v208
    v_lshlrev_b32 v26, 16, v209
    v_and_b32 v27, s62, v209
    v_lshlrev_b32 v28, 16, v210
    v_and_b32 v29, s62, v210
    v_lshlrev_b32 v30, 16, v211
    v_and_b32 v31, s62, v211
    v_pk_fma_f32 v[24:25], v[24:25], v[20:21], v[20:21] op_sel:[0,0,1] op_sel_hi:[1,0,1]
    v_pk_fma_f32 v[26:27], v[26:27], v[20:21], v[20:21] op_sel:[0,0,1] op_sel_hi:[1,0,1]
    v_pk_fma_f32 v[28:29], v[28:29], v[20:21], v[20:21] op_sel:[0,0,1] op_sel_hi:[1,0,1]
    v_pk_fma_f32 v[30:31], v[30:31], v[20:21], v[20:21] op_sel:[0,0,1] op_sel_hi:[1,0,1]
    v_cvt_pk_bf16_f32 v208, v24, v25
    v_cvt_pk_bf16_f32 v209, v26, v27
    v_cvt_pk_bf16_f32 v210, v28, v29
    v_cvt_pk_bf16_f32 v211, v30, v31
    ds_write_b128 v23, v[208:211] offset:0
    v_lshlrev_b32 v24, 16, v212
    v_and_b32 v25, s62, v212
    v_lshlrev_b32 v26, 16, v213
    v_and_b32 v27, s62, v213
    v_lshlrev_b32 v28, 16, v214
    v_and_b32 v29, s62, v214
    v_lshlrev_b32 v30, 16, v215
    v_and_b32 v31, s62, v215
    v_pk_fma_f32 v[24:25], v[24:25], v[20:21], v[20:21] op_sel:[0,0,1] op_sel_hi:[1,0,1]
    v_pk_fma_f32 v[26:27], v[26:27], v[20:21], v[20:21] op_sel:[0,0,1] op_sel_hi:[1,0,1]
    v_pk_fma_f32 v[28:29], v[28:29], v[20:21], v[20:21] op_sel:[0,0,1] op_sel_hi:[1,0,1]
    v_pk_fma_f32 v[30:31], v[30:31], v[20:21], v[20:21] op_sel:[0,0,1] op_sel_hi:[1,0,1]
    v_cvt_pk_bf16_f32 v212, v24, v25
    v_cvt_pk_bf16_f32 v213, v26, v27
    v_cvt_pk_bf16_f32 v214, v28, v29
    v_cvt_pk_bf16_f32 v215, v30, v31
    ds_write_b128 v23, v[212:215] offset:8192
    s_and_b32 s99, s52, 3
    s_waitcnt vmcnt(8)
    s_waitcnt lgkmcnt(0)
    s_barrier
    ds_read_b128 v[16:19], v240 offset:0
    ds_read_b64_tr_b16 v[176:177], v246 offset:0
    ds_read_b64_tr_b16 v[178:179], v246 offset:1024
    ds_read_b128 v[20:23], v241 offset:0
    ds_read_b64_tr_b16 v[180:181], v246 offset:4096
    ds_read_b64_tr_b16 v[182:183], v246 offset:5120
    ds_read_b128 v[24:27], v242 offset:0
    ds_read_b64_tr_b16 v[184:185], v246 offset:8192
    ds_read_b64_tr_b16 v[186:187], v246 offset:9216
    ds_read_b128 v[28:31], v243 offset:0
    ds_read_b64_tr_b16 v[188:189], v246 offset:12288
    ds_read_b64_tr_b16 v[190:191], v246 offset:13312
    s_waitcnt vmcnt(6)
    s_waitcnt lgkmcnt(0)
    s_barrier
    v_mfma_f32_32x32x16_bf16 v[208:223], v[176:179], v[16:19], 0
    ds_read_b128 v[32:35], v240 offset:8192
    ds_read_b64_tr_b16 v[192:193], v246 offset:16384
    ds_read_b64_tr_b16 v[194:195], v246 offset:17408
    ds_read_b128 v[36:39], v241 offset:8192
    ds_read_b64_tr_b16 v[196:197], v246 offset:20480
    ds_read_b64_tr_b16 v[198:199], v246 offset:21504
    v_mfma_f32_32x32x16_bf16 v[208:223], v[180:183], v[20:23], v[208:223]
    ds_read_b128 v[40:43], v242 offset:8192
    ds_read_b64_tr_b16 v[200:201], v246 offset:24576
    ds_read_b64_tr_b16 v[202:203], v246 offset:25600
    ds_read_b128 v[44:47], v243 offset:8192
    ds_read_b64_tr_b16 v[204:205], v246 offset:28672
    ds_read_b64_tr_b16 v[206:207], v246 offset:29696
    s_add_u32 m0, s93, 81920
    s_mov_b32 s60, 32
    global_load_lds_dwordx4 v[10:11], off
    v_mad_i64_i32 v[10:11], vcc, v12, s60, v[10:11]
    v_mfma_f32_32x32x16_bf16 v[208:223], v[184:187], v[24:27], v[208:223]
    s_add_u32 m0, s93, 90112
    s_add_u32 s91, s91, 1
    s_cmp_eq_u32 s91, 10
    s_cselect_b32 s60, -608, 32
    global_load_lds_dwordx4 v[10:11], off
    v_mad_i64_i32 v[10:11], vcc, v12, s60, v[10:11]
    v_mfma_f32_32x32x16_bf16 v[208:223], v[188:191], v[28:31], v[208:223]
    s_waitcnt vmcnt(6)
    s_waitcnt lgkmcnt(0)
    s_barrier
    v_mfma_f32_32x32x16_bf16 v[208:223], v[192:195], v[32:35], v[208:223]
    ds_read_b128 v[48:51], v240 offset:16384
    ds_read_b64_tr_b16 v[176:177], v246 offset:32768
    ds_read_b64_tr_b16 v[178:179], v246 offset:33792
    ds_read_b128 v[52:55], v241 offset:16384
    ds_read_b64_tr_b16 v[180:181], v246 offset:36864
    ds_read_b64_tr_b16 v[182:183], v246 offset:37888
    v_mfma_f32_32x32x16_bf16 v[208:223], v[196:199], v[36:39], v[208:223]
    ds_read_b128 v[56:59], v242 offset:16384
    ds_read_b64_tr_b16 v[184:185], v246 offset:40960
    ds_read_b64_tr_b16 v[186:187], v246 offset:41984
    ds_read_b128 v[60:63], v243 offset:16384
    ds_read_b64_tr_b16 v[188:189], v246 offset:45056
    ds_read_b64_tr_b16 v[190:191], v246 offset:46080
    s_add_u32 m0, s93, 98304
    s_mov_b32 s60, 32
    global_load_lds_dwordx4 v[10:11], off
    v_mad_i64_i32 v[10:11], vcc, v12, s60, v[10:11]
    v_mfma_f32_32x32x16_bf16 v[208:223], v[200:203], v[40:43], v[208:223]
    s_add_u32 m0, s93, 106496
    s_add_u32 s91, s91, 1
    s_cmp_eq_u32 s91, 10
    s_cselect_b32 s60, -608, 32
    global_load_lds_dwordx4 v[10:11], off
    v_mad_i64_i32 v[10:11], vcc, v12, s60, v[10:11]
    v_mfma_f32_32x32x16_bf16 v[208:223], v[204:207], v[44:47], v[208:223]
    s_waitcnt vmcnt(6)
    s_waitcnt lgkmcnt(0)
    s_barrier
    v_mfma_f32_32x32x16_bf16 v[208:223], v[176:179], v[48:51], v[208:223]
    ds_read_b128 v[64:67], v240 offset:24576
    ds_read_b64_tr_b16 v[192:193], v246 offset:49152
    ds_read_b64_tr_b16 v[194:195], v246 offset:50176
    ds_read_b128 v[68:71], v241 offset:24576
    ds_read_b64_tr_b16 v[196:197], v246 offset:53248
    ds_read_b64_tr_b16 v[198:199], v246 offset:54272
    v_mfma_f32_32x32x16_bf16 v[208:223], v[180:183], v[52:55], v[208:223]
    ds_read_b128 v[72:75], v242 offset:24576
    ds_read_b64_tr_b16 v[200:201], v246 offset:57344
    ds_read_b64_tr_b16 v[202:203], v246 offset:58368
    ds_read_b128 v[76:79], v243 offset:24576
    ds_read_b64_tr_b16 v[204:205], v246 offset:61440
    ds_read_b64_tr_b16 v[206:207], v246 offset:62464
    s_add_u32 m0, s93, 114688
    s_mov_b32 s60, 32
    global_load_lds_dwordx4 v[10:11], off
    v_mad_i64_i32 v[10:11], vcc, v12, s60, v[10:11]
    v_mfma_f32_32x32x16_bf16 v[208:223], v[184:187], v[56:59], v[208:223]
    s_add_u32 m0, s93, 122880
    s_add_u32 s91, s91, 1
    s_cmp_eq_u32 s91, 10
    s_cselect_b32 s60, -608, 32
    global_load_lds_dwordx4 v[10:11], off
    v_mad_i64_i32 v[10:11], vcc, v12, s60, v[10:11]
    v_mfma_f32_32x32x16_bf16 v[208:223], v[188:191], v[60:63], v[208:223]
    s_waitcnt vmcnt(6)
    s_waitcnt lgkmcnt(0)
    s_barrier
    v_mfma_f32_32x32x16_bf16 v[208:223], v[192:195], v[64:67], v[208:223]
    ds_read_b128 v[80:83], v240 offset:32768
    ds_read_b64_tr_b16 v[176:177], v13 offset:0
    ds_read_b64_tr_b16 v[178:179], v13 offset:1024
    ds_read_b128 v[84:87], v241 offset:32768
    ds_read_b64_tr_b16 v[180:181], v13 offset:4096
    ds_read_b64_tr_b16 v[182:183], v13 offset:5120
    v_mfma_f32_32x32x16_bf16 v[208:223], v[196:199], v[68:71], v[208:223]
    ds_read_b128 v[88:91], v242 offset:32768
    ds_read_b64_tr_b16 v[184:185], v13 offset:8192
    ds_read_b64_tr_b16 v[186:187], v13 offset:9216
    ds_read_b128 v[92:95], v243 offset:32768
    ds_read_b64_tr_b16 v[188:189], v13 offset:12288
    ds_read_b64_tr_b16 v[190:191], v13 offset:13312
    s_add_u32 m0, s93, 131072
    s_mov_b32 s60, 32
    global_load_lds_dwordx4 v[10:11], off
    v_mad_i64_i32 v[10:11], vcc, v12, s60, v[10:11]
    v_mfma_f32_32x32x16_bf16 v[208:223], v[200:203], v[72:75], v[208:223]
    s_add_u32 m0, s93, 139264
    s_add_u32 s91, s91, 1
    s_cmp_eq_u32 s91, 10
    s_cselect_b32 s60, -608, 32
    global_load_lds_dwordx4 v[10:11], off
    v_mad_i64_i32 v[10:11], vcc, v12, s60, v[10:11]
    v_mfma_f32_32x32x16_bf16 v[208:223], v[204:207], v[76:79], v[208:223]
    s_cmp_eq_u32 s52, 7
    s_cbranch_scc0 Lz_8
    v_mov_b32 v4, 0
    buffer_load_dword v5, v4, s[48:51], 0 offen sc1
Lz_8:
    s_waitcnt vmcnt(6)
    s_waitcnt lgkmcnt(0)
    s_barrier
    v_mfma_f32_32x32x16_bf16 v[208:223], v[176:179], v[80:83], v[208:223]
    ds_read_b128 v[96:99], v240 offset:40960
    ds_read_b64_tr_b16 v[192:193], v246 offset:0
    ds_read_b64_tr_b16 v[194:195], v246 offset:1024
    ds_read_b128 v[100:103], v241 offset:40960
    ds_read_b64_tr_b16 v[196:197], v246 offset:4096
    ds_read_b64_tr_b16 v[198:199], v246 offset:5120
    v_mfma_f32_32x32x16_bf16 v[208:223], v[180:183], v[84:87], v[208:223]
    ds_read_b128 v[104:107], v242 offset:40960
    ds_read_b64_tr_b16 v[200:201], v246 offset:8192
    ds_read_b64_tr_b16 v[202:203], v246 offset:9216
    ds_read_b128 v[108:111], v243 offset:40960
    ds_read_b64_tr_b16 v[204:205], v246 offset:12288
    ds_read_b64_tr_b16 v[206:207], v246 offset:13312
    s_add_u32 m0, s93, 147456
    s_mov_b32 s60, 32
    global_load_lds_dwordx4 v[10:11], off
    v_mad_i64_i32 v[10:11], vcc, v12, s60, v[10:11]
    v_mfma_f32_32x32x16_bf16 v[208:223], v[184:187], v[88:91], v[208:223]
    s_add_u32 m0, s93, 155648
    s_add_u32 s91, s91, 1
    s_cmp_eq_u32 s91, 10
    s_cselect_b32 s60, -608, 32
    global_load_lds_dwordx4 v[10:11], off
    v_mfma_f32_32x32x16_bf16 v[208:223], v[188:191], v[92:95], v[208:223]
    s_waitcnt vmcnt(6)
    s_waitcnt lgkmcnt(0)
    s_barrier
    v_mfma_f32_32x32x16_bf16 v[208:223], v[192:195], v[96:99], v[208:223]
    ds_read_b128 v[112:115], v240 offset:49152
    ds_read_b64_tr_b16 v[176:177], v246 offset:16384
    ds_read_b64_tr_b16 v[178:179], v246 offset:17408
    ds_read_b128 v[116:119], v241 offset:49152
    ds_read_b64_tr_b16 v[180:181], v246 offset:20480
    ds_read_b64_tr_b16 v[182:183], v246 offset:21504
    v_mfma_f32_32x32x16_bf16 v[208:223], v[196:199], v[100:103], v[208:223]
    ds_read_b128 v[120:123], v242 offset:49152
    ds_read_b64_tr_b16 v[184:185], v246 offset:24576
    ds_read_b64_tr_b16 v[186:187], v246 offset:25600
    ds_read_b128 v[124:127], v243 offset:49152
    ds_read_b64_tr_b16 v[188:189], v246 offset:28672
    ds_read_b64_tr_b16 v[190:191], v246 offset:29696
    s_cmp_eq_u32 s37, 1
    s_cbranch_scc0 Ls_9
    s_add_u32 m0, s36, 0
    s_add_u32 s60, s96, s38
    buffer_load_dwordx4 v8, s[12:15], s60 offen lds
    s_add_u32 s38, s38, 40960
Ls_9:
    v_mfma_f32_32x32x16_bf16 v[208:223], v[200:203], v[104:107], v[208:223]
    s_cmp_eq_u32 s37, 1
    s_cbranch_scc0 Ls_10
    s_add_u32 m0, s36, 5120
    s_add_u32 s60, s96, s38
    buffer_load_dwordx4 v8, s[12:15], s60 offen lds
    s_add_u32 s38, s38, 40960
    s_cmp_eq_u32 s38, 819200
    s_cselect_b32 s38, 0, s38
Ls_10:
    v_mfma_f32_32x32x16_bf16 v[208:223], v[204:207], v[108:111], v[208:223]
    s_cmp_eq_u32 s37, 1
    s_cbranch_scc1 Lw_11
    s_waitcnt vmcnt(4)
Lw_11:
    s_waitcnt vmcnt(6)
    s_waitcnt lgkmcnt(0)
    s_barrier
    v_mfma_f32_32x32x16_bf16 v[208:223], v[176:179], v[112:115], v[208:223]
    ds_read_b128 v[128:131], v240 offset:57344
    ds_read_b64_tr_b16 v[192:193], v246 offset:32768
    ds_read_b64_tr_b16 v[194:195], v246 offset:33792
    ds_read_b128 v[132:135], v241 offset:57344
    ds_read_b64_tr_b16 v[196:197], v246 offset:36864
    ds_read_b64_tr_b16 v[198:199], v246 offset:37888
    v_mfma_f32_32x32x16_bf16 v[208:223], v[180:183], v[116:119], v[208:223]
    ds_read_b128 v[136:139], v242 offset:57344
    ds_read_b64_tr_b16 v[200:201], v246 offset:40960
    ds_read_b64_tr_b16 v[202:203], v246 offset:41984
    ds_read_b128 v[140:143], v243 offset:57344
    ds_read_b64_tr_b16 v[204:205], v246 offset:45056
    ds_read_b64_tr_b16 v[206:207], v246 offset:46080
    s_cmp_eq_u32 s37, 1
    s_cbranch_scc0 Ls_12
    s_add_u32 m0, s36, 10240
    s_add_u32 s60, s96, s38
    buffer_load_dwordx4 v8, s[12:15], s60 offen lds
    s_add_u32 s38, s38, 40960
Ls_12:
    v_mfma_f32_32x32x16_bf16 v[208:223], v[184:187], v[120:123], v[208:223]
    s_cmp_eq_u32 s37, 1
    s_cbranch_scc0 Ls_13
    s_add_u32 m0, s36, 15360
    s_add_u32 s60, s96, s38
    buffer_load_dwordx4 v8, s[12:15], s60 offen lds
    s_add_u32 s38, s38, 40960
    s_cmp_eq_u32 s38, 819200
    s_cselect_b32 s38, 0, s38
Ls_13:
    v_mfma_f32_32x32x16_bf16 v[208:223], v[188:191], v[124:127], v[208:223]
    s_cmp_eq_u32 s37, 1
    s_cbranch_scc1 Lw_14
    s_waitcnt vmcnt(2)
Lw_14:
    s_waitcnt vmcnt(6)
    s_waitcnt lgkmcnt(0)
    s_barrier
    v_mfma_f32_32x32x16_bf16 v[208:223], v[192:195], v[128:131], v[208:223]
    v_add_u32 v240, 0x10000, v240
    ds_read_b128 v[144:147], v240 offset:0
    ds_read_b64_tr_b16 v[176:177], v246 offset:49152
    ds_read_b64_tr_b16 v[178:179], v246 offset:50176
    v_add_u32 v241, 0x10000, v241
    ds_read_b128 v[148:151], v241 offset:0
    ds_read_b64_tr_b16 v[180:181], v246 offset:53248
    ds_read_b64_tr_b16 v[182:183], v246 offset:54272
    v_mfma_f32_32x32x16_bf16 v[208:223], v[196:199], v[132:135], v[208:223]
    v_add_u32 v242, 0x10000, v242
    ds_read_b128 v[152:155], v242 offset:0
    ds_read_b64_tr_b16 v[184:185], v246 offset:57344
    ds_read_b64_tr_b16 v[186:187], v246 offset:58368
    v_add_u32 v243, 0x10000, v243
    ds_read_b128 v[156:159], v243 offset:0
    ds_read_b64_tr_b16 v[188:189], v246 offset:61440
    ds_read_b64_tr_b16 v[190:191], v246 offset:62464
    s_cmp_eq_u32 s37, 1
    s_cbranch_scc0 Ls_15
    s_add_u32 m0, s36, 20480
    s_add_u32 s60, s96, s38
    buffer_load_dwordx4 v8, s[12:15], s60 offen lds
    s_add_u32 s38, s38, 40960
Ls_15:
    v_mfma_f32_32x32x16_bf16 v[208:223], v[200:203], v[136:139], v[208:223]
    s_cmp_eq_u32 s37, 1
    s_cbranch_scc0 Ls_16
    s_add_u32 m0, s36, 25600
    s_add_u32 s60, s96, s38
    buffer_load_dwordx4 v8, s[12:15], s60 offen lds
    s_add_u32 s38, s38, 40960
    s_cmp_eq_u32 s38, 819200
    s_cselect_b32 s38, 0, s38
Ls_16:
    v_mfma_f32_32x32x16_bf16 v[208:223], v[204:207], v[140:143], v[208:223]
    s_cmp_eq_u32 s52, 7
    s_cbranch_scc0 Lz_17
    s_mov_b64 s[4:5], 1
    s_mov_b32 s3, 0x20000
    s_waitcnt vmcnt(2)
    s_branch Lpollc_19
Lpoll_18:
    buffer_load_dword v5, v4, s[48:51], 0 offen sc1
    s_waitcnt vmcnt(0)
Lpollc_19:
    v_cmp_ne_u32 vcc, 0, v5
    s_nop 0
    s_and_b64 s[6:7], vcc, s[4:5]
    s_cmp_eq_u64 s[6:7], s[4:5]
    s_cbranch_scc1 Lpolld_20
    s_sub_u32 s3, s3, 1
    s_cbranch_scc1 Lpolld_20
    s_sleep 2
    s_branch Lpoll_18
Lpolld_20:
Lz_17:
    s_cmp_eq_u32 s37, 1
    s_cbranch_scc1 Lw_21
    s_waitcnt vmcnt(0)
Lw_21:
    s_waitcnt vmcnt(6)
    s_waitcnt lgkmcnt(0)
    s_barrier
    v_mfma_f32_32x32x16_bf16 v[208:223], v[176:179], v[144:147], v[208:223]
    ds_read_b128 v[160:163], v240 offset:8192
    ds_read_b64_tr_b16 v[192:193], v13 offset:0
    ds_read_b64_tr_b16 v[194:195], v13 offset:1024
    ds_read_b128 v[164:167], v241 offset:8192
    ds_read_b64_tr_b16 v[196:197], v13 offset:4096
    ds_read_b64_tr_b16 v[198:199], v13 offset:5120
    v_mfma_f32_32x32x16_bf16 v[208:223], v[180:183], v[148:151], v[208:223]
    ds_read_b128 v[168:171], v242 offset:8192
    ds_read_b64_tr_b16 v[200:201], v13 offset:8192
    ds_read_b64_tr_b16 v[202:203], v13 offset:9216
    ds_read_b128 v[172:175], v243 offset:8192
    ds_read_b64_tr_b16 v[204:205], v13 offset:12288
    ds_read_b64_tr_b16 v[206:207], v13 offset:13312
    s_cmp_eq_u32 s37, 1
    s_cbranch_scc0 Ls_22
    s_add_u32 m0, s36, 30720
    s_add_u32 s60, s96, s38
    buffer_load_dwordx4 v8, s[12:15], s60 offen lds
    s_add_u32 s38, s38, 40960
Ls_22:
    v_mfma_f32_32x32x16_bf16 v[208:223], v[184:187], v[152:155], v[208:223]
    s_cmp_eq_u32 s37, 1
    s_cbranch_scc0 Ls_23
    s_add_u32 m0, s36, 35840
    s_add_u32 s60, s96, s38
    buffer_load_dwordx4 v8, s[12:15], s60 offen lds
    s_add_u32 s38, s38, 40960
    s_cmp_eq_u32 s38, 819200
    s_cselect_b32 s38, 0, s38
Ls_23:
    v_mfma_f32_32x32x16_bf16 v[208:223], v[188:191], v[156:159], v[208:223]
    s_cmp_eq_u32 s37, 0
    s_cbranch_scc1 Lw_24
    s_waitcnt vmcnt(6)
Lw_24:
    s_waitcnt lgkmcnt(0)
    s_barrier
    v_mfma_f32_32x32x16_bf16 v[208:223], v[192:195], v[160:163], v[208:223]
    ds_read_b64_tr_b16 v[176:177], v244 offset:0
    ds_read_b64_tr_b16 v[178:179], v244 offset:160
    ds_read_b64_tr_b16 v[180:181], v244 offset:2560
    ds_read_b64_tr_b16 v[182:183], v244 offset:2720
    v_mfma_f32_32x32x16_bf16 v[208:223], v[196:199], v[164:167], v[208:223]
    ds_read_b64_tr_b16 v[184:185], v244 offset:5120
    ds_read_b64_tr_b16 v[186:187], v244 offset:5280
    ds_read_b64_tr_b16 v[188:189], v244 offset:7680
    ds_read_b64_tr_b16 v[190:191], v244 offset:7840
    s_cmp_eq_u32 s37, 1
    s_cbranch_scc0 Ls_25
    s_add_u32 m0, s36, 40960
    s_add_u32 s60, s96, s38
    buffer_load_dwordx4 v8, s[12:15], s60 offen lds
    s_add_u32 s38, s38, 40960
Ls_25:
    v_mfma_f32_32x32x16_bf16 v[208:223], v[200:203], v[168:171], v[208:223]
    s_cmp_eq_u32 s37, 1
    s_cbranch_scc0 Ls_26
    s_add_u32 m0, s36, 46080
    s_add_u32 s60, s96, s38
    buffer_load_dwordx4 v8, s[12:15], s60 offen lds
    s_add_u32 s38, s38, 40960
    s_cmp_eq_u32 s38, 819200
    s_cselect_b32 s38, 0, s38
Ls_26:
    v_mfma_f32_32x32x16_bf16 v[208:223], v[204:207], v[172:175], v[208:223]
    s_cmp_eq_u32 s99, 3
    s_cselect_b32 s100, s100, 99
    s_cmp_lt_u32 s100, 47
    s_cbranch_scc0 Lz_27
    s_mul_i32 s61, s58, 5120
    s_add_u32 m0, s61, 51200
    s_nop 0
    buffer_load_dwordx4 v232, s[32:35], s96 offen lds
    s_add_u32 m0, s61, 52224
    s_nop 0
    buffer_load_dwordx4 v233, s[32:35], s96 offen lds
    s_add_u32 m0, s61, 53248
    s_nop 0
    buffer_load_dwordx4 v234, s[32:35], s96 offen lds
    s_add_u32 m0, s61, 54272
    s_nop 0
    buffer_load_dwordx4 v235, s[32:35], s96 offen lds
    s_add_u32 m0, s61, 55296
    s_nop 0
    buffer_load_dwordx4 v236, s[32:35], s96 offen lds
Lz_27:
    s_cmp_lg_u32 s57, 0
    s_cbranch_scc1 Le_28
    v_mov_b32 v12, 0xbdd2d3e8
    v_mov_b32 v13, 0xc0135761
    s_nop 3
    v_pk_mul_f32 v[224:225], v[208:209], v[208:209]
    s_lshl_b32 s32, s99, 13
    v_pk_mul_f32 v[226:227], v[210:211], v[210:211]
    s_lshl_b32 s33, s53, 18
    v_pk_mul_f32 v[228:229], v[212:213], v[212:213]
    s_lshl_b32 s62, s99, 10
    v_pk_mul_f32 v[230:231], v[214:215], v[214:215]
    s_add_u32 s33, s33, s62
    v_pk_mul_f32 v[232:233], v[216:217], v[216:217]
    s_bfm_b32 s62, s56, 0
    v_pk_mul_f32 v[234:235], v[218:219], v[218:219]
    s_lshl_b32 s61, s62, 4
    v_pk_mul_f32 v[236:237], v[220:221], v[220:221]
    s_or_b32 s62, s62, s61
    v_pk_mul_f32 v[238:239], v[222:223], v[222:223]
    s_lshr_b32 s39, s62, s99
    v_pk_fma_f32 v[224:225], v[224:225], v[12:13], v[12:13] op_sel:[0,0,1] op_sel_hi:[1,0,1]
    s_sub_u32 s63, s56, 1
    v_pk_fma_f32 v[226:227], v[226:227], v[12:13], v[12:13] op_sel:[0,0,1] op_sel_hi:[1,0,1]
    s_lshl_b32 s61, s99, 15
    v_pk_fma_f32 v[228:229], v[228:229], v[12:13], v[12:13] op_sel:[0,0,1] op_sel_hi:[1,0,1]
    s_add_u32 s61, s61, 0x100000
    v_pk_fma_f32 v[230:231], v[230:231], v[12:13], v[12:13] op_sel:[0,0,1] op_sel_hi:[1,0,1]
    s_add_u32 s62, s99, 0
    v_pk_fma_f32 v[232:233], v[232:233], v[12:13], v[12:13] op_sel:[0,0,1] op_sel_hi:[1,0,1]
    s_and_b32 s62, s62, 3
    v_pk_fma_f32 v[234:235], v[234:235], v[12:13], v[12:13] op_sel:[0,0,1] op_sel_hi:[1,0,1]
    s_min_u32 s62, s62, s63
    v_pk_fma_f32 v[236:237], v[236:237], v[12:13], v[12:13] op_sel:[0,0,1] op_sel_hi:[1,0,1]
    s_add_u32 s62, s62, s55
    v_pk_fma_f32 v[238:239], v[238:239], v[12:13], v[12:13] op_sel:[0,0,1] op_sel_hi:[1,0,1]
    s_mov_b32 s34, s62
    v_pk_mul_f32 v[224:225], v[224:225], v[208:209]
    s_lshl_b32 s62, s62, 17
    v_pk_mul_f32 v[226:227], v[226:227], v[210:211]
    s_add_u32 s48, s62, s61
    v_pk_mul_f32 v[228:229], v[228:229], v[212:213]
    s_add_u32 s62, s99, 1
    v_pk_mul_f32 v[230:231], v[230:231], v[214:215]
    s_and_b32 s62, s62, 3
    v_pk_mul_f32 v[232:233], v[232:233], v[216:217]
    s_min_u32 s62, s62, s63
    v_pk_mul_f32 v[234:235], v[234:235], v[218:219]
    s_add_u32 s62, s62, s55
    v_pk_mul_f32 v[236:237], v[236:237], v[220:221]
    s_lshl_b32 s62, s62, 17
    v_pk_mul_f32 v[238:239], v[238:239], v[222:223]
    s_add_u32 s49, s62, s61
    v_exp_f32 v224, v224
    s_add_u32 s62, s99, 2
    v_exp_f32 v225, v225
    s_and_b32 s62, s62, 3
    v_exp_f32 v226, v226
    s_min_u32 s62, s62, s63
    v_exp_f32 v227, v227
    s_add_u32 s62, s62, s55
    v_exp_f32 v228, v228
    s_lshl_b32 s62, s62, 17
    v_exp_f32 v229, v229
    s_add_u32 s50, s62, s61
    v_exp_f32 v230, v230
    s_add_u32 s62, s99, 3
    v_exp_f32 v231, v231
    s_and_b32 s62, s62, 3
    v_exp_f32 v232, v232
    s_min_u32 s62, s62, s63
    v_exp_f32 v233, v233
    s_add_u32 s62, s62, s55
    v_exp_f32 v234, v234
    s_lshl_b32 s62, s62, 17
    v_exp_f32 v235, v235
    s_add_u32 s51, s62, s61
    v_exp_f32 v236, v236
    v_exp_f32 v237, v237
    v_exp_f32 v238, v238
    v_exp_f32 v239, v239
    v_pk_add_f32 v[224:225], v[224:225], 1.0 op_sel_hi:[1,0]
    v_pk_add_f32 v[226:227], v[226:227], 1.0 op_sel_hi:[1,0]
    v_pk_add_f32 v[228:229], v[228:229], 1.0 op_sel_hi:[1,0]
    v_pk_add_f32 v[230:231], v[230:231], 1.0 op_sel_hi:[1,0]
    v_pk_add_f32 v[232:233], v[232:233], 1.0 op_sel_hi:[1,0]
    v_pk_add_f32 v[234:235], v[234:235], 1.0 op_sel_hi:[1,0]
    v_pk_add_f32 v[236:237], v[236:237], 1.0 op_sel_hi:[1,0]
    v_pk_add_f32 v[238:239], v[238:239], 1.0 op_sel_hi:[1,0]
    v_rcp_f32 v224, v224
    v_rcp_f32 v225, v225
    v_rcp_f32 v226, v226
    v_rcp_f32 v227, v227
    v_rcp_f32 v228, v228
    v_rcp_f32 v229, v229
    v_rcp_f32 v230, v230
    v_rcp_f32 v231, v231
    v_rcp_f32 v232, v232
    v_rcp_f32 v233, v233
    v_rcp_f32 v234, v234
    v_rcp_f32 v235, v235
    v_rcp_f32 v236, v236
    v_rcp_f32 v237, v237
    v_rcp_f32 v238, v238
    v_rcp_f32 v239, v239
    v_pk_mul_f32 v[224:225], v[208:209], v[224:225]
    v_pk_mul_f32 v[226:227], v[210:211], v[226:227]
    v_pk_mul_f32 v[228:229], v[212:213], v[228:229]
    v_pk_mul_f32 v[230:231], v[214:215], v[230:231]
    v_pk_mul_f32 v[232:233], v[216:217], v[232:233]
    v_pk_mul_f32 v[234:235], v[218:219], v[234:235]
    v_pk_mul_f32 v[236:237], v[220:221], v[236:237]
    v_pk_mul_f32 v[238:239], v[222:223], v[238:239]
    v_pk_add_f32 v[4:5], v[224:225], v[226:227]
    v_pk_mul_f32 v[10:11], v[224:225], v[224:225]
    v_pk_fma_f32 v[10:11], v[226:227], v[226:227], v[10:11]
    v_pk_add_f32 v[4:5], v[4:5], v[228:229]
    v_pk_fma_f32 v[10:11], v[228:229], v[228:229], v[10:11]
    v_pk_add_f32 v[4:5], v[4:5], v[230:231]
    v_pk_fma_f32 v[10:11], v[230:231], v[230:231], v[10:11]
    v_pk_add_f32 v[4:5], v[4:5], v[232:233]
    v_pk_fma_f32 v[10:11], v[232:233], v[232:233], v[10:11]
    v_pk_add_f32 v[4:5], v[4:5], v[234:235]
    v_pk_fma_f32 v[10:11], v[234:235], v[234:235], v[10:11]
    v_pk_add_f32 v[4:5], v[4:5], v[236:237]
    v_pk_fma_f32 v[10:11], v[236:237], v[236:237], v[10:11]
    v_pk_add_f32 v[4:5], v[4:5], v[238:239]
    v_pk_fma_f32 v[10:11], v[238:239], v[238:239], v[10:11]
    v_add_f32 v4, v4, v5
    v_add_f32 v5, v10, v11
    v_mov_b32 v10, v4
    v_mov_b32 v11, v5
    s_nop 0
    v_permlane32_swap_b32 v4, v10
    v_permlane32_swap_b32 v5, v11
    v_pk_add_f32 v[4:5], v[4:5], v[10:11]
    s_lshl_b32 s60, s99, 9
    s_lshl_b32 s61, s58, 8
    s_add_u32 s60, s60, s61
    s_add_u32 s60, s60, 158208
    v_lshl_add_u32 v12, v2, 3, s60
    s_mov_b32 exec_hi, 0
    ds_write_b64 v12, v[4:5]
    s_mov_b64 exec, -1
    s_branch Le_31
Le_28:
    s_lshl_b32 s60, s53, 1
    s_add_u32 s60, s60, s58
    s_lshl_b32 s61, s60, 12
    s_add_u32 s61, s61, 0x40000
    s_lshl_b32 s94, s60, 2
    v_cmp_eq_u32 vcc, 0, v3
    s_nop 1
    v_cndmask_b32 v216, 0, v216, vcc
    v_cndmask_b32 v217, 0, v217, vcc
    v_cndmask_b32 v218, 0, v218, vcc
    v_cndmask_b32 v219, 0, v219, vcc
    s_cmp_eq_u32 s57, 1
    s_cbranch_scc0 Le_29
    v_mov_b32 v4, 0x3ea52b5c
    v_pk_mul_f32 v[208:209], v[208:209], v[4:5] op_sel_hi:[1,0]
    v_pk_mul_f32 v[210:211], v[210:211], v[4:5] op_sel_hi:[1,0]
    v_pk_mul_f32 v[212:213], v[212:213], v[4:5] op_sel_hi:[1,0]
    v_pk_mul_f32 v[214:215], v[214:215], v[4:5] op_sel_hi:[1,0]
    v_pk_mul_f32 v[216:217], v[216:217], v[4:5] op_sel_hi:[1,0]
    v_pk_mul_f32 v[218:219], v[218:219], v[4:5] op_sel_hi:[1,0]
    v_cvt_pk_bf16_f32 v208, v208, v209
    v_cvt_pk_bf16_f32 v209, v210, v211
    v_cvt_pk_bf16_f32 v210, v212, v213
    v_cvt_pk_bf16_f32 v211, v214, v215
    v_cvt_pk_bf16_f32 v212, v216, v217
    v_cvt_pk_bf16_f32 v213, v218, v219
    buffer_store_dwordx4 v[208:211], v7, s[44:47], s61 offen sc1
    v_lshlrev_b32 v4, 3, v2
    s_mov_b32 exec_hi, 0
    buffer_store_dwordx2 v[212:213], v4, s[44:47], s61 offen offset:3072 sc1
    s_mov_b64 exec, -1
    v_dot2_f32_bf16 v10, v208, v208, 0
    v_dot2_f32_bf16 v10, v209, v209, v10
    v_dot2_f32_bf16 v10, v210, v210, v10
    v_dot2_f32_bf16 v10, v211, v211, v10
    v_dot2_f32_bf16 v10, v212, v212, v10
    v_dot2_f32_bf16 v10, v213, v213, v10
    s_nop 2
    v_mov_b32 v11, v10
    s_nop 1
    v_permlane32_swap_b32 v10, v11
    v_add_f32 v10, v10, v11
    s_branch Le_30
Le_29:
    v_max3_f32 v10, |v208|, |v209|, 0
    v_max3_f32 v10, |v210|, |v211|, v10
    v_max3_f32 v10, |v212|, |v213|, v10
    v_max3_f32 v10, |v214|, |v215|, v10
    v_max3_f32 v10, |v216|, |v217|, v10
    v_max3_f32 v10, |v218|, |v219|, v10
    v_cvt_pk_bf16_f32 v208, v208, v209
    v_cvt_pk_bf16_f32 v209, v210, v211
    v_cvt_pk_bf16_f32 v210, v212, v213
    v_cvt_pk_bf16_f32 v211, v214, v215
    v_cvt_pk_bf16_f32 v212, v216, v217
    v_cvt_pk_bf16_f32 v213, v218, v219
    ds_write_b64 v14, v[208:209] offset:0
    ds_write_b64 v14, v[210:211] offset:16
    ds_write_b64 v14, v[212:213] offset:32
    v_mul_u32_u24 v4, 288, v3
    v_sub_u32 v4, v15, v4
    ds_read_b64_tr_b16 v[224:225], v4 offset:0
    ds_read_b64_tr_b16 v[226:227], v4 offset:576
    ds_read_b64_tr_b16 v[228:229], v4 offset:1152
    ds_read_b64_tr_b16 v[230:231], v4 offset:1728
    v_cmp_eq_u32 vcc, 20, v2
    v_mov_b32 v11, 0x3f803f80
    s_nop 0
    v_cndmask_b32 v11, 0, v11, vcc
    v_cmp_gt_u32 vcc, 20, v2
    s_waitcnt lgkmcnt(0)
    s_nop 0
    v_cndmask_b32 v224, v11, v224, vcc
    v_cndmask_b32 v225, v11, v225, vcc
    v_cndmask_b32 v226, v11, v226, vcc
    v_cndmask_b32 v227, v11, v227, vcc
    v_cndmask_b32 v228, v11, v228, vcc
    v_cndmask_b32 v229, v11, v229, vcc
    v_cndmask_b32 v230, v11, v230, vcc
    v_cndmask_b32 v231, v11, v231, vcc
    buffer_store_dwordx4 v[224:227], v7, s[44:47], s61 offen offset:1024 sc1
    buffer_store_dwordx4 v[228:231], v7, s[44:47], s61 offen offset:2048 sc1
    s_add_u32 s94, s94, 256
Le_30:
    v_cmp_o_f32 vcc, v10, v10
    v_mov_b32 v11, 0x7f800000
    s_nop 0
    v_cndmask_b32 v10, v11, v10, vcc
    s_nop 1
    v_max_u32_dpp v10, v10, v10 row_shr:1 row_mask:0xf bank_mask:0xf
    s_nop 1
    v_max_u32_dpp v10, v10, v10 row_shr:2 row_mask:0xf bank_mask:0xf
    s_nop 1
    v_max_u32_dpp v10, v10, v10 row_shr:4 row_mask:0xf bank_mask:0xf
    s_nop 1
    v_max_u32_dpp v10, v10, v10 row_shr:8 row_mask:0xf bank_mask:0xf
    s_nop 1
    v_max_u32_dpp v10, v10, v10 row_bcast:15 row_mask:0xa bank_mask:0xf
    s_nop 1
    v_max_u32_dpp v10, v10, v10 row_bcast:31 row_mask:0xc bank_mask:0xf
    s_nop 0
    v_readlane_b32 s95, v10, 63
    s_nop 0
    s_or_b32 s95, s95, 1
    s_lshl_b32 s32, s99, 13
    s_lshl_b32 s33, s53, 18
    s_lshl_b32 s62, s99, 10
    s_add_u32 s33, s33, s62
    s_bfm_b32 s62, s56, 0
    s_lshl_b32 s61, s62, 4
    s_or_b32 s62, s62, s61
    s_lshr_b32 s39, s62, s99
    s_sub_u32 s63, s56, 1
    s_lshl_b32 s61, s99, 15
    s_add_u32 s61, s61, 0x100000
    s_add_u32 s62, s99, 0
    s_and_b32 s62, s62, 3
    s_min_u32 s62, s62, s63
    s_add_u32 s62, s62, s55
    s_mov_b32 s34, s62
    s_lshl_b32 s62, s62, 17
    s_add_u32 s48, s62, s61
    s_add_u32 s62, s99, 1
    s_and_b32 s62, s62, 3
    s_min_u32 s62, s62, s63
    s_add_u32 s62, s62, s55
    s_lshl_b32 s62, s62, 17
    s_add_u32 s49, s62, s61
    s_add_u32 s62, s99, 2
    s_and_b32 s62, s62, 3
    s_min_u32 s62, s62, s63
    s_add_u32 s62, s62, s55
    s_lshl_b32 s62, s62, 17
    s_add_u32 s50, s62, s61
    s_add_u32 s62, s99, 3
    s_and_b32 s62, s62, 3
    s_min_u32 s62, s62, s63
    s_add_u32 s62, s62, s55
    s_lshl_b32 s62, s62, 17
    s_add_u32 s51, s62, s61
Le_31:
    s_cmp_eq_u32 s99, 3
    s_cbranch_scc1 L_qI
    s_cmp_eq_u32 s37, 0
    s_cbranch_scc1 L_q0
    s_branch L_qW
L_qI:
    s_waitcnt lgkmcnt(0)
    s_barrier
    s_cmp_eq_u32 s52, 7
    s_cbranch_scc1 Lz_32
    v_mov_b32 v176, 0
    v_lshlrev_b32 v177, 2, v1
    v_add_u32 v177, 0x27e00, v177
    ds_write_b32 v177, v176
    s_branch Lz_34
Lz_32:
    v_lshlrev_b32 v10, 3, v1
    v_add_u32 v11, 0x26a00, v10
    ds_read_b64 v[176:177], v11 offset:0
    ds_read_b64 v[178:179], v11 offset:512
    ds_read_b64 v[180:181], v11 offset:1024
    ds_read_b64 v[182:183], v11 offset:1536
    s_lshl_b32 s61, s53, 3
    s_add_u32 s61, s61, s54
    s_lshl_b32 s60, s61, 9
    s_add_u32 s60, s60, 0x8000
    s_lshl_b32 s61, s61, 8
    s_add_u32 s61, s61, 0x30000
    v_mov_b32 v184, 0
    v_lshlrev_b32 v185, 2, v1
    buffer_store_dword v184, v185, s[44:47], s61 offen sc1
    s_waitcnt lgkmcnt(0)
    v_pk_add_f32 v[176:177], v[176:177], v[178:179]
    s_cmp_eq_u32 s56, 2
    s_cbranch_scc1 Lz_33
    v_pk_add_f32 v[176:177], v[176:177], v[180:181]
    s_cmp_eq_u32 s56, 3
    s_cbranch_scc1 Lz_33
    v_pk_add_f32 v[176:177], v[176:177], v[182:183]
Lz_33:
    buffer_store_dwordx2 v[176:177], v10, s[44:47], s60 offen sc1
Lz_34:
    s_waitcnt lgkmcnt(0)
    s_barrier
    s_waitcnt lgkmcnt(0)
    s_barrier
    s_waitcnt vmcnt(0)
    s_cmp_eq_u32 s52, 7
    s_cbranch_scc0 Lz_35
    s_lshl_b32 s60, s53, 7
    s_lshl_b32 s61, s54, 2
    s_add_u32 s60, s60, s61
    s_add_u32 s60, s60, 1024
    v_mov_b32 v11, 1
    v_mov_b32 v10, 0
    s_mov_b64 exec, 1
    buffer_store_dword v11, v10, s[44:47], s60 offen sc1
    s_mov_b64 exec, -1
Lz_35:
    s_cmp_lg_u32 s57, 0
    s_cbranch_scc0 Lz_36
    v_mov_b32 v11, s95
    v_mov_b32 v10, 0
    s_mov_b64 exec, 1
    buffer_store_dword v11, v10, s[44:47], s94 offen sc1
    s_mov_b64 exec, -1
Lz_36:
    s_waitcnt lgkmcnt(0)
    s_barrier
    s_waitcnt lgkmcnt(0)
    s_barrier
    s_waitcnt lgkmcnt(0)
    s_barrier
    s_add_u32 m0, s93, 114688
    s_add_u32 s60, s92, s90
    buffer_load_dwordx4 v245, s[20:23], s60 offen lds
    s_add_u32 s90, s90, 110592
    s_add_u32 m0, s93, 122880
    s_add_u32 s60, s92, s90
    buffer_load_dwordx4 v245, s[20:23], s60 offen lds
    s_add_u32 s90, s90, 110592
    s_cmp_eq_u32 s90, 2211840
    s_cselect_b32 s90, 0, s90
    s_waitcnt lgkmcnt(0)
    s_barrier
    s_add_u32 m0, s93, 131072
    s_add_u32 s60, s92, s90
    buffer_load_dwordx4 v245, s[20:23], s60 offen lds
    s_add_u32 s90, s90, 110592
    s_add_u32 m0, s93, 139264
    s_add_u32 s60, s92, s90
    buffer_load_dwordx4 v245, s[20:23], s60 offen lds
    s_add_u32 s90, s90, 110592
    s_cmp_eq_u32 s90, 2211840
    s_cselect_b32 s90, 0, s90
    v_lshlrev_b32 v4, 2, v2
    s_lshl_b32 s62, s53, 7
    s_add_u32 s62, s62, 1024
    buffer_load_dword v12, v4, s[44:47], s62 offen sc1
    s_waitcnt lgkmcnt(0)
    s_barrier
    s_add_u32 m0, s93, 81920
    s_add_u32 s60, s92, s90
    buffer_load_dwordx4 v245, s[20:23], s60 offen lds
    s_add_u32 s90, s90, 110592
    s_add_u32 m0, s93, 90112
    s_add_u32 s60, s92, s90
    buffer_load_dwordx4 v245, s[20:23], s60 offen lds
    s_add_u32 s90, s90, 110592
    s_cmp_eq_u32 s90, 2211840
    s_cselect_b32 s90, 0, s90
    s_waitcnt lgkmcnt(0)
    s_barrier
    s_add_u32 m0, s93, 98304
    s_add_u32 s60, s92, s90
    buffer_load_dwordx4 v245, s[20:23], s60 offen lds
    s_add_u32 s90, s90, 110592
    s_add_u32 m0, s93, 106496
    s_add_u32 s60, s92, s90
    buffer_load_dwordx4 v245, s[20:23], s60 offen lds
    s_add_u32 s90, s90, 110592
    s_cmp_eq_u32 s90, 2211840
    s_cselect_b32 s90, 0, s90
    s_mov_b64 s[4:5], 0xff
    s_mov_b32 s3, 0x20000
    s_waitcnt vmcnt(4)
    s_branch Lpollc_39
Lpoll_38:
    buffer_load_dword v12, v4, s[44:47], s62 offen sc1
    s_waitcnt vmcnt(0)
Lpollc_39:
    v_cmp_ne_u32 vcc, 0, v12
    s_nop 0
    s_and_b64 s[6:7], vcc, s[4:5]
    s_cmp_eq_u64 s[6:7], s[4:5]
    s_cbranch_scc1 Lpolld_40
    s_sub_u32 s3, s3, 1
    s_cbranch_scc1 Lpolld_40
    s_sleep 2
    s_branch Lpoll_38
Lpolld_40:
    s_lshl_b32 s60, s58, 8
    v_lshl_add_u32 v5, v2, 3, s60
    v_lshl_add_u32 v5, v3, 11, v5
    s_lshl_b32 s60, s53, 12
    s_add_u32 s60, s60, 0x8000
    buffer_load_dwordx2 v[248:249], v5, s[44:47], s60 offen offset:0 sc1
    buffer_load_dwordx2 v[250:251], v5, s[44:47], s60 offen offset:512 sc1
    buffer_load_dwordx2 v[252:253], v5, s[44:47], s60 offen offset:1024 sc1
    buffer_load_dwordx2 v[254:255], v5, s[44:47], s60 offen offset:1536 sc1
    s_branch L_qdone
L_q0:
    s_waitcnt lgkmcnt(0)
    s_barrier
    v_mfma_f32_32x32x16_bf16 v[208:223], v[176:179], v[16:19], 0
    ds_read_b64_tr_b16 v[192:193], v244 offset:10240
    ds_read_b64_tr_b16 v[194:195], v244 offset:10400
    ds_read_b64_tr_b16 v[196:197], v244 offset:12800
    ds_read_b64_tr_b16 v[198:199], v244 offset:12960
    v_mfma_f32_32x32x16_bf16 v[208:223], v[180:183], v[20:23], v[208:223]
    ds_read_b64_tr_b16 v[200:201], v244 offset:15360
    ds_read_b64_tr_b16 v[202:203], v244 offset:15520
    ds_read_b64_tr_b16 v[204:205], v244 offset:17920
    ds_read_b64_tr_b16 v[206:207], v244 offset:18080
    v_mfma_f32_32x32x16_bf16 v[208:223], v[184:187], v[24:27], v[208:223]
    v_mfma_f32_32x32x16_bf16 v[208:223], v[188:191], v[28:31], v[208:223]
    s_waitcnt lgkmcnt(0)
    s_barrier
    v_mfma_f32_32x32x16_bf16 v[208:223], v[192:195], v[32:35], v[208:223]
    ds_read_b64_tr_b16 v[176:177], v244 offset:20480
    ds_read_b64_tr_b16 v[178:179], v244 offset:20640
    ds_read_b64_tr_b16 v[180:181], v244 offset:23040
    ds_read_b64_tr_b16 v[182:183], v244 offset:23200
    v_mfma_f32_32x32x16_bf16 v[208:223], v[196:199], v[36:39], v[208:223]
    ds_read_b64_tr_b16 v[184:185], v244 offset:25600
    ds_read_b64_tr_b16 v[186:187], v244 offset:25760
    ds_read_b64_tr_b16 v[188:189], v244 offset:28160
    ds_read_b64_tr_b16 v[190:191], v244 offset:28320
    v_mfma_f32_32x32x16_bf16 v[208:223], v[200:203], v[40:43], v[208:223]
    v_mfma_f32_32x32x16_bf16 v[208:223], v[204:207], v[44:47], v[208:223]
    s_waitcnt lgkmcnt(0)
    s_barrier
    v_mfma_f32_32x32x16_bf16 v[208:223], v[176:179], v[48:51], v[208:223]
    ds_read_b64_tr_b16 v[192:193], v244 offset:30720
    ds_read_b64_tr_b16 v[194:195], v244 offset:30880
    ds_read_b64_tr_b16 v[196:197], v244 offset:33280
    ds_read_b64_tr_b16 v[198:199], v244 offset:33440
    v_mfma_f32_32x32x16_bf16 v[208:223], v[180:183], v[52:55], v[208:223]
    ds_read_b64_tr_b16 v[200:201], v244 offset:35840
    ds_read_b64_tr_b16 v[202:203], v244 offset:36000
    ds_read_b64_tr_b16 v[204:205], v244 offset:38400
    ds_read_b64_tr_b16 v[206:207], v244 offset:38560
    v_mfma_f32_32x32x16_bf16 v[208:223], v[184:187], v[56:59], v[208:223]
    v_mfma_f32_32x32x16_bf16 v[208:223], v[188:191], v[60:63], v[208:223]
    s_cmp_lg_u32 s57, 0
    s_cbranch_scc0 Lz_41
    s_waitcnt vmcnt(0)
    v_mov_b32 v11, s95
    v_mov_b32 v10, 0
    s_mov_b64 exec, 1
    buffer_store_dword v11, v10, s[44:47], s94 offen sc1
    s_mov_b64 exec, -1
Lz_41:
    s_waitcnt lgkmcnt(0)
    s_barrier
    v_mfma_f32_32x32x16_bf16 v[208:223], v[192:195], v[64:67], v[208:223]
    ds_read_b64_tr_b16 v[176:177], v244 offset:40960
    ds_read_b64_tr_b16 v[178:179], v244 offset:41120
    ds_read_b64_tr_b16 v[180:181], v244 offset:43520
    ds_read_b64_tr_b16 v[182:183], v244 offset:43680
    v_mfma_f32_32x32x16_bf16 v[208:223], v[196:199], v[68:71], v[208:223]
    ds_read_b64_tr_b16 v[184:185], v244 offset:46080
    ds_read_b64_tr_b16 v[186:187], v244 offset:46240
    ds_read_b64_tr_b16 v[188:189], v244 offset:48640
    ds_read_b64_tr_b16 v[190:191], v244 offset:48800
    v_mfma_f32_32x32x16_bf16 v[208:223], v[200:203], v[72:75], v[208:223]
    v_mfma_f32_32x32x16_bf16 v[208:223], v[204:207], v[76:79], v[208:223]
    s_waitcnt lgkmcnt(0)
    s_barrier
    v_mfma_f32_32x32x16_bf16 v[208:223], v[176:179], v[80:83], v[208:223]
    ds_read_b64_tr_b16 v[192:193], v244 offset:0
    ds_read_b64_tr_b16 v[194:195], v244 offset:160
    ds_read_b64_tr_b16 v[196:197], v244 offset:2560
    ds_read_b64_tr_b16 v[198:199], v244 offset:2720
    v_mfma_f32_32x32x16_bf16 v[208:223], v[180:183], v[84:87], v[208:223]
    ds_read_b64_tr_b16 v[200:201], v244 offset:5120
    ds_read_b64_tr_b16 v[202:203], v244 offset:5280
    ds_read_b64_tr_b16 v[204:205], v244 offset:7680
    ds_read_b64_tr_b16 v[206:207], v244 offset:7840
    v_mfma_f32_32x32x16_bf16 v[208:223], v[184:187], v[88:91], v[208:223]
    v_mfma_f32_32x32x16_bf16 v[208:223], v[188:191], v[92:95], v[208:223]
    s_waitcnt lgkmcnt(0)
    s_barrier
    v_mfma_f32_32x32x16_bf16 v[208:223], v[192:195], v[96:99], v[208:223]
    ds_read_b64_tr_b16 v[176:177], v244 offset:10240
    ds_read_b64_tr_b16 v[178:179], v244 offset:10400
    ds_read_b64_tr_b16 v[180:181], v244 offset:12800
    ds_read_b64_tr_b16 v[182:183], v244 offset:12960
    v_mfma_f32_32x32x16_bf16 v[208:223], v[196:199], v[100:103], v[208:223]
    ds_read_b64_tr_b16 v[184:185], v244 offset:15360
    ds_read_b64_tr_b16 v[186:187], v244 offset:15520
    ds_read_b64_tr_b16 v[188:189], v244 offset:17920
    ds_read_b64_tr_b16 v[190:191], v244 offset:18080
    s_add_u32 m0, s93, 114688
    s_add_u32 s60, s92, s90
    buffer_load_dwordx4 v245, s[20:23], s60 offen lds
    s_add_u32 s90, s90, 110592
    v_mfma_f32_32x32x16_bf16 v[208:223], v[200:203], v[104:107], v[208:223]
    s_add_u32 m0, s93, 122880
    s_add_u32 s60, s92, s90
    buffer_load_dwordx4 v245, s[20:23], s60 offen lds
    s_add_u32 s90, s90, 110592
    s_cmp_eq_u32 s90, 2211840
    s_cselect_b32 s90, 0, s90
    v_mfma_f32_32x32x16_bf16 v[208:223], v[204:207], v[108:111], v[208:223]
    s_waitcnt lgkmcnt(0)
    s_barrier
    v_mfma_f32_32x32x16_bf16 v[208:223], v[176:179], v[112:115], v[208:223]
    ds_read_b64_tr_b16 v[192:193], v244 offset:20480
    ds_read_b64_tr_b16 v[194:195], v244 offset:20640
    ds_read_b64_tr_b16 v[196:197], v244 offset:23040
    ds_read_b64_tr_b16 v[198:199], v244 offset:23200
    v_mfma_f32_32x32x16_bf16 v[208:223], v[180:183], v[116:119], v[208:223]
    ds_read_b64_tr_b16 v[200:201], v244 offset:25600
    ds_read_b64_tr_b16 v[202:203], v244 offset:25760
    ds_read_b64_tr_b16 v[204:205], v244 offset:28160
    ds_read_b64_tr_b16 v[206:207], v244 offset:28320
    s_add_u32 m0, s93, 131072
    s_add_u32 s60, s92, s90
    buffer_load_dwordx4 v245, s[20:23], s60 offen lds
    s_add_u32 s90, s90, 110592
    v_mfma_f32_32x32x16_bf16 v[208:223], v[184:187], v[120:123], v[208:223]
    s_add_u32 m0, s93, 139264
    s_add_u32 s60, s92, s90
    buffer_load_dwordx4 v245, s[20:23], s60 offen lds
    s_add_u32 s90, s90, 110592
    s_cmp_eq_u32 s90, 2211840
    s_cselect_b32 s90, 0, s90
    v_mfma_f32_32x32x16_bf16 v[208:223], v[188:191], v[124:127], v[208:223]
    v_lshlrev_b32 v4, 2, v2
    s_lshl_b32 s62, s53, 7
    s_add_u32 s62, s62, 1024
    buffer_load_dword v12, v4, s[44:47], s62 offen sc1
    s_waitcnt lgkmcnt(0)
    s_barrier
    v_mfma_f32_32x32x16_bf16 v[208:223], v[192:195], v[128:131], v[208:223]
    ds_read_b64_tr_b16 v[176:177], v244 offset:30720
    ds_read_b64_tr_b16 v[178:179], v244 offset:30880
    ds_read_b64_tr_b16 v[180:181], v244 offset:33280
    ds_read_b64_tr_b16 v[182:183], v244 offset:33440
    v_mfma_f32_32x32x16_bf16 v[208:223], v[196:199], v[132:135], v[208:223]
    ds_read_b64_tr_b16 v[184:185], v244 offset:35840
    ds_read_b64_tr_b16 v[186:187], v244 offset:36000
    ds_read_b64_tr_b16 v[188:189], v244 offset:38400
    ds_read_b64_tr_b16 v[190:191], v244 offset:38560
    s_add_u32 m0, s93, 81920
    s_add_u32 s60, s92, s90
    buffer_load_dwordx4 v245, s[20:23], s60 offen lds
    s_add_u32 s90, s90, 110592
    v_mfma_f32_32x32x16_bf16 v[208:223], v[200:203], v[136:139], v[208:223]
    s_add_u32 m0, s93, 90112
    s_add_u32 s60, s92, s90
    buffer_load_dwordx4 v245, s[20:23], s60 offen lds
    s_add_u32 s90, s90, 110592
    s_cmp_eq_u32 s90, 2211840
    s_cselect_b32 s90, 0, s90
    v_mfma_f32_32x32x16_bf16 v[208:223], v[204:207], v[140:143], v[208:223]
    s_waitcnt lgkmcnt(0)
    s_barrier
    v_mfma_f32_32x32x16_bf16 v[208:223], v[176:179], v[144:147], v[208:223]
    ds_read_b64_tr_b16 v[192:193], v244 offset:40960
    ds_read_b64_tr_b16 v[194:195], v244 offset:41120
    ds_read_b64_tr_b16 v[196:197], v244 offset:43520
    ds_read_b64_tr_b16 v[198:199], v244 offset:43680
    v_mfma_f32_32x32x16_bf16 v[208:223], v[180:183], v[148:151], v[208:223]
    ds_read_b64_tr_b16 v[200:201], v244 offset:46080
    ds_read_b64_tr_b16 v[202:203], v244 offset:46240
    ds_read_b64_tr_b16 v[204:205], v244 offset:48640
    ds_read_b64_tr_b16 v[206:207], v244 offset:48800
    s_add_u32 m0, s93, 98304
    s_add_u32 s60, s92, s90
    buffer_load_dwordx4 v245, s[20:23], s60 offen lds
    s_add_u32 s90, s90, 110592
    v_mfma_f32_32x32x16_bf16 v[208:223], v[184:187], v[152:155], v[208:223]
    s_add_u32 m0, s93, 106496
    s_add_u32 s60, s92, s90
    buffer_load_dwordx4 v245, s[20:23], s60 offen lds
    s_add_u32 s90, s90, 110592
    s_cmp_eq_u32 s90, 2211840
    s_cselect_b32 s90, 0, s90
    v_mfma_f32_32x32x16_bf16 v[208:223], v[188:191], v[156:159], v[208:223]
    s_mov_b64 s[4:5], 0xff
    s_mov_b32 s3, 0x20000
    s_waitcnt vmcnt(4)
    s_branch Lpollc_43
Lpoll_42:
    buffer_load_dword v12, v4, s[44:47], s62 offen sc1
    s_waitcnt vmcnt(0)
Lpollc_43:
    v_cmp_ne_u32 vcc, 0, v12
    s_nop 0
    s_and_b64 s[6:7], vcc, s[4:5]
    s_cmp_eq_u64 s[6:7], s[4:5]
    s_cbranch_scc1 Lpolld_44
    s_sub_u32 s3, s3, 1
    s_cbranch_scc1 Lpolld_44
    s_sleep 2
    s_branch Lpoll_42
Lpolld_44:
    s_lshl_b32 s60, s58, 8
    v_lshl_add_u32 v5, v2, 3, s60
    v_lshl_add_u32 v5, v3, 11, v5
    s_lshl_b32 s60, s53, 12
    s_add_u32 s60, s60, 0x8000
    buffer_load_dwordx2 v[248:249], v5, s[44:47], s60 offen offset:0 sc1
    buffer_load_dwordx2 v[250:251], v5, s[44:47], s60 offen offset:512 sc1
    buffer_load_dwordx2 v[252:253], v5, s[44:47], s60 offen offset:1024 sc1
    buffer_load_dwordx2 v[254:255], v5, s[44:47], s60 offen offset:1536 sc1
    s_branch L_qdone
L_qW:
    s_waitcnt vmcnt(6)
    s_waitcnt lgkmcnt(0)
    s_barrier
    v_mfma_f32_32x32x16_bf16 v[208:223], v[176:179], v[16:19], 0
    ds_read_b64_tr_b16 v[192:193], v244 offset:10240
    ds_read_b64_tr_b16 v[194:195], v244 offset:10400
    ds_read_b64_tr_b16 v[196:197], v244 offset:12800
    ds_read_b64_tr_b16 v[198:199], v244 offset:12960
    v_mfma_f32_32x32x16_bf16 v[208:223], v[180:183], v[20:23], v[208:223]
    ds_read_b64_tr_b16 v[200:201], v244 offset:15360
    ds_read_b64_tr_b16 v[202:203], v244 offset:15520
    ds_read_b64_tr_b16 v[204:205], v244 offset:17920
    ds_read_b64_tr_b16 v[206:207], v244 offset:18080
    s_add_u32 m0, s36, 0
    s_add_u32 s60, s96, s38
    buffer_load_dwordx4 v8, s[12:15], s60 offen lds
    s_add_u32 s38, s38, 40960
Ls_45:
    v_mfma_f32_32x32x16_bf16 v[208:223], v[184:187], v[24:27], v[208:223]
    s_add_u32 m0, s36, 5120
    s_add_u32 s60, s96, s38
    buffer_load_dwordx4 v8, s[12:15], s60 offen lds
    s_add_u32 s38, s38, 40960
    s_cmp_eq_u32 s38, 819200
    s_cselect_b32 s38, 0, s38
Ls_46:
    v_mfma_f32_32x32x16_bf16 v[208:223], v[188:191], v[28:31], v[208:223]
    s_waitcnt vmcnt(6)
    s_waitcnt lgkmcnt(0)
    s_barrier
    v_mfma_f32_32x32x16_bf16 v[208:223], v[192:195], v[32:35], v[208:223]
    ds_read_b64_tr_b16 v[176:177], v244 offset:20480
    ds_read_b64_tr_b16 v[178:179], v244 offset:20640
    ds_read_b64_tr_b16 v[180:181], v244 offset:23040
    ds_read_b64_tr_b16 v[182:183], v244 offset:23200
    v_mfma_f32_32x32x16_bf16 v[208:223], v[196:199], v[36:39], v[208:223]
    ds_read_b64_tr_b16 v[184:185], v244 offset:25600
    ds_read_b64_tr_b16 v[186:187], v244 offset:25760
    ds_read_b64_tr_b16 v[188:189], v244 offset:28160
    ds_read_b64_tr_b16 v[190:191], v244 offset:28320
    s_add_u32 m0, s36, 10240
    s_add_u32 s60, s96, s38
    buffer_load_dwordx4 v8, s[12:15], s60 offen lds
    s_add_u32 s38, s38, 40960
Ls_47:
    v_mfma_f32_32x32x16_bf16 v[208:223], v[200:203], v[40:43], v[208:223]
    s_add_u32 m0, s36, 15360
    s_add_u32 s60, s96, s38
    buffer_load_dwordx4 v8, s[12:15], s60 offen lds
    s_add_u32 s38, s38, 40960
    s_cmp_eq_u32 s38, 819200
    s_cselect_b32 s38, 0, s38
Ls_48:
    v_mfma_f32_32x32x16_bf16 v[208:223], v[204:207], v[44:47], v[208:223]
    s_waitcnt vmcnt(6)
    s_waitcnt lgkmcnt(0)
    s_barrier
    v_mfma_f32_32x32x16_bf16 v[208:223], v[176:179], v[48:51], v[208:223]
    ds_read_b64_tr_b16 v[192:193], v244 offset:30720
    ds_read_b64_tr_b16 v[194:195], v244 offset:30880
    ds_read_b64_tr_b16 v[196:197], v244 offset:33280
    ds_read_b64_tr_b16 v[198:199], v244 offset:33440
    v_mfma_f32_32x32x16_bf16 v[208:223], v[180:183], v[52:55], v[208:223]
    ds_read_b64_tr_b16 v[200:201], v244 offset:35840
    ds_read_b64_tr_b16 v[202:203], v244 offset:36000
    ds_read_b64_tr_b16 v[204:205], v244 offset:38400
    ds_read_b64_tr_b16 v[206:207], v244 offset:38560
    s_add_u32 m0, s36, 20480
    s_add_u32 s60, s96, s38
    buffer_load_dwordx4 v8, s[12:15], s60 offen lds
    s_add_u32 s38, s38, 40960
Ls_49:
    v_mfma_f32_32x32x16_bf16 v[208:223], v[184:187], v[56:59], v[208:223]
    s_add_u32 m0, s36, 25600
    s_add_u32 s60, s96, s38
    buffer_load_dwordx4 v8, s[12:15], s60 offen lds
    s_add_u32 s38, s38, 40960
    s_cmp_eq_u32 s38, 819200
    s_cselect_b32 s38, 0, s38
Ls_50:
    v_mfma_f32_32x32x16_bf16 v[208:223], v[188:191], v[60:63], v[208:223]
    s_cmp_lg_u32 s57, 0
    s_cbranch_scc0 Lz_51
    s_waitcnt vmcnt(6)
    v_mov_b32 v11, s95
    v_mov_b32 v10, 0
    s_mov_b64 exec, 1
    buffer_store_dword v11, v10, s[44:47], s94 offen sc1
    s_mov_b64 exec, -1
Lz_51:
    s_waitcnt vmcnt(6)
    s_waitcnt lgkmcnt(0)
    s_barrier
    v_mfma_f32_32x32x16_bf16 v[208:223], v[192:195], v[64:67], v[208:223]
    ds_read_b64_tr_b16 v[176:177], v244 offset:40960
    ds_read_b64_tr_b16 v[178:179], v244 offset:41120
    ds_read_b64_tr_b16 v[180:181], v244 offset:43520
    ds_read_b64_tr_b16 v[182:183], v244 offset:43680
    v_mfma_f32_32x32x16_bf16 v[208:223], v[196:199], v[68:71], v[208:223]
    ds_read_b64_tr_b16 v[184:185], v244 offset:46080
    ds_read_b64_tr_b16 v[186:187], v244 offset:46240
    ds_read_b64_tr_b16 v[188:189], v244 offset:48640
    ds_read_b64_tr_b16 v[190:191], v244 offset:48800
    s_add_u32 m0, s36, 30720
    s_add_u32 s60, s96, s38
    buffer_load_dwordx4 v8, s[12:15], s60 offen lds
    s_add_u32 s38, s38, 40960
Ls_52:
    v_mfma_f32_32x32x16_bf16 v[208:223], v[200:203], v[72:75], v[208:223]
    s_add_u32 m0, s36, 35840
    s_add_u32 s60, s96, s38
    buffer_load_dwordx4 v8, s[12:15], s60 offen lds
    s_add_u32 s38, s38, 40960
    s_cmp_eq_u32 s38, 819200
    s_cselect_b32 s38, 0, s38
Ls_53:
    v_mfma_f32_32x32x16_bf16 v[208:223], v[204:207], v[76:79], v[208:223]
    s_waitcnt vmcnt(6)
    s_waitcnt lgkmcnt(0)
    s_barrier
    v_mfma_f32_32x32x16_bf16 v[208:223], v[176:179], v[80:83], v[208:223]
    ds_read_b64_tr_b16 v[192:193], v244 offset:0
    ds_read_b64_tr_b16 v[194:195], v244 offset:160
    ds_read_b64_tr_b16 v[196:197], v244 offset:2560
    ds_read_b64_tr_b16 v[198:199], v244 offset:2720
    v_mfma_f32_32x32x16_bf16 v[208:223], v[180:183], v[84:87], v[208:223]
    ds_read_b64_tr_b16 v[200:201], v244 offset:5120
    ds_read_b64_tr_b16 v[202:203], v244 offset:5280
    ds_read_b64_tr_b16 v[204:205], v244 offset:7680
    ds_read_b64_tr_b16 v[206:207], v244 offset:7840
    s_add_u32 m0, s36, 40960
    s_add_u32 s60, s96, s38
    buffer_load_dwordx4 v8, s[12:15], s60 offen lds
    s_add_u32 s38, s38, 40960
Ls_54:
    v_mfma_f32_32x32x16_bf16 v[208:223], v[184:187], v[88:91], v[208:223]
    s_add_u32 m0, s36, 46080
    s_add_u32 s60, s96, s38
    buffer_load_dwordx4 v8, s[12:15], s60 offen lds
    s_add_u32 s38, s38, 40960
    s_cmp_eq_u32 s38, 819200
    s_cselect_b32 s38, 0, s38
Ls_55:
    v_mfma_f32_32x32x16_bf16 v[208:223], v[188:191], v[92:95], v[208:223]
    s_waitcnt vmcnt(6)
    s_waitcnt lgkmcnt(0)
    s_barrier
    v_mfma_f32_32x32x16_bf16 v[208:223], v[192:195], v[96:99], v[208:223]
    ds_read_b64_tr_b16 v[176:177], v244 offset:10240
    ds_read_b64_tr_b16 v[178:179], v244 offset:10400
    ds_read_b64_tr_b16 v[180:181], v244 offset:12800
    ds_read_b64_tr_b16 v[182:183], v244 offset:12960
    v_mfma_f32_32x32x16_bf16 v[208:223], v[196:199], v[100:103], v[208:223]
    ds_read_b64_tr_b16 v[184:185], v244 offset:15360
    ds_read_b64_tr_b16 v[186:187], v244 offset:15520
    ds_read_b64_tr_b16 v[188:189], v244 offset:17920
    ds_read_b64_tr_b16 v[190:191], v244 offset:18080
    s_add_u32 m0, s93, 114688
    s_add_u32 s60, s92, s90
    buffer_load_dwordx4 v245, s[20:23], s60 offen lds
    s_add_u32 s90, s90, 110592
    v_mfma_f32_32x32x16_bf16 v[208:223], v[200:203], v[104:107], v[208:223]
    s_add_u32 m0, s93, 122880
    s_add_u32 s60, s92, s90
    buffer_load_dwordx4 v245, s[20:23], s60 offen lds
    s_add_u32 s90, s90, 110592
    s_cmp_eq_u32 s90, 2211840
    s_cselect_b32 s90, 0, s90
    v_mfma_f32_32x32x16_bf16 v[208:223], v[204:207], v[108:111], v[208:223]
    s_waitcnt vmcnt(6)
    s_waitcnt lgkmcnt(0)
    s_barrier
    v_mfma_f32_32x32x16_bf16 v[208:223], v[176:179], v[112:115], v[208:223]
    ds_read_b64_tr_b16 v[192:193], v244 offset:20480
    ds_read_b64_tr_b16 v[194:195], v244 offset:20640
    ds_read_b64_tr_b16 v[196:197], v244 offset:23040
    ds_read_b64_tr_b16 v[198:199], v244 offset:23200
    v_mfma_f32_32x32x16_bf16 v[208:223], v[180:183], v[116:119], v[208:223]
    ds_read_b64_tr_b16 v[200:201], v244 offset:25600
    ds_read_b64_tr_b16 v[202:203], v244 offset:25760
    ds_read_b64_tr_b16 v[204:205], v244 offset:28160
    ds_read_b64_tr_b16 v[206:207], v244 offset:28320
    s_add_u32 m0, s93, 131072
    s_add_u32 s60, s92, s90
    buffer_load_dwordx4 v245, s[20:23], s60 offen lds
    s_add_u32 s90, s90, 110592
    v_mfma_f32_32x32x16_bf16 v[208:223], v[184:187], v[120:123], v[208:223]
    s_add_u32 m0, s93, 139264
    s_add_u32 s60, s92, s90
    buffer_load_dwordx4 v245, s[20:23], s60 offen lds
    s_add_u32 s90, s90, 110592
    s_cmp_eq_u32 s90, 2211840
    s_cselect_b32 s90, 0, s90
    v_mfma_f32_32x32x16_bf16 v[208:223], v[188:191], v[124:127], v[208:223]
    v_lshlrev_b32 v4, 2, v2
    s_lshl_b32 s62, s53, 7
    s_add_u32 s62, s62, 1024
    buffer_load_dword v12, v4, s[44:47], s62 offen sc1
    s_waitcnt vmcnt(7)
    s_waitcnt lgkmcnt(0)
    s_barrier
    v_mfma_f32_32x32x16_bf16 v[208:223], v[192:195], v[128:131], v[208:223]
    ds_read_b64_tr_b16 v[176:177], v244 offset:30720
    ds_read_b64_tr_b16 v[178:179], v244 offset:30880
    ds_read_b64_tr_b16 v[180:181], v244 offset:33280
    ds_read_b64_tr_b16 v[182:183], v244 offset:33440
    v_mfma_f32_32x32x16_bf16 v[208:223], v[196:199], v[132:135], v[208:223]
    ds_read_b64_tr_b16 v[184:185], v244 offset:35840
    ds_read_b64_tr_b16 v[186:187], v244 offset:36000
    ds_read_b64_tr_b16 v[188:189], v244 offset:38400
    ds_read_b64_tr_b16 v[190:191], v244 offset:38560
    s_add_u32 m0, s93, 81920
    s_add_u32 s60, s92, s90
    buffer_load_dwordx4 v245, s[20:23], s60 offen lds
    s_add_u32 s90, s90, 110592
    v_mfma_f32_32x32x16_bf16 v[208:223], v[200:203], v[136:139], v[208:223]
    s_add_u32 m0, s93, 90112
    s_add_u32 s60, s92, s90
    buffer_load_dwordx4 v245, s[20:23], s60 offen lds
    s_add_u32 s90, s90, 110592
    s_cmp_eq_u32 s90, 2211840
    s_cselect_b32 s90, 0, s90
    v_mfma_f32_32x32x16_bf16 v[208:223], v[204:207], v[140:143], v[208:223]
    s_waitcnt vmcnt(7)
    s_waitcnt lgkmcnt(0)
    s_barrier
    v_mfma_f32_32x32x16_bf16 v[208:223], v[176:179], v[144:147], v[208:223]
    ds_read_b64_tr_b16 v[192:193], v244 offset:40960
    ds_read_b64_tr_b16 v[194:195], v244 offset:41120
    ds_read_b64_tr_b16 v[196:197], v244 offset:43520
    ds_read_b64_tr_b16 v[198:199], v244 offset:43680
    v_mfma_f32_32x32x16_bf16 v[208:223], v[180:183], v[148:151], v[208:223]
    ds_read_b64_tr_b16 v[200:201], v244 offset:46080
    ds_read_b64_tr_b16 v[202:203], v244 offset:46240
    ds_read_b64_tr_b16 v[204:205], v244 offset:48640
    ds_read_b64_tr_b16 v[206:207], v244 offset:48800
    s_add_u32 m0, s93, 98304
    s_add_u32 s60, s92, s90
    buffer_load_dwordx4 v245, s[20:23], s60 offen lds
    s_add_u32 s90, s90, 110592
    v_mfma_f32_32x32x16_bf16 v[208:223], v[184:187], v[152:155], v[208:223]
    s_add_u32 m0, s93, 106496
    s_add_u32 s60, s92, s90
    buffer_load_dwordx4 v245, s[20:23], s60 offen lds
    s_add_u32 s90, s90, 110592
    s_cmp_eq_u32 s90, 2211840
    s_cselect_b32 s90, 0, s90
    v_mfma_f32_32x32x16_bf16 v[208:223], v[188:191], v[156:159], v[208:223]
    s_mov_b64 s[4:5], 0xff
    s_mov_b32 s3, 0x20000
    s_waitcnt vmcnt(4)
    s_branch Lpollc_57
Lpoll_56:
    buffer_load_dword v12, v4, s[44:47], s62 offen sc1
    s_waitcnt vmcnt(0)
Lpollc_57:
    v_cmp_ne_u32 vcc, 0, v12
    s_nop 0
    s_and_b64 s[6:7], vcc, s[4:5]
    s_cmp_eq_u64 s[6:7], s[4:5]
    s_cbranch_scc1 Lpolld_58
    s_sub_u32 s3, s3, 1
    s_cbranch_scc1 Lpolld_58
    s_sleep 2
    s_branch Lpoll_56
Lpolld_58:
    s_lshl_b32 s60, s58, 8
    v_lshl_add_u32 v5, v2, 3, s60
    v_lshl_add_u32 v5, v3, 11, v5
    s_lshl_b32 s60, s53, 12
    s_add_u32 s60, s60, 0x8000
    buffer_load_dwordx2 v[248:249], v5, s[44:47], s60 offen offset:0 sc1
    buffer_load_dwordx2 v[250:251], v5, s[44:47], s60 offen offset:512 sc1
    buffer_load_dwordx2 v[252:253], v5, s[44:47], s60 offen offset:1024 sc1
    buffer_load_dwordx2 v[254:255], v5, s[44:47], s60 offen offset:1536 sc1
L_qdone:
    s_waitcnt vmcnt(11)
    s_waitcnt lgkmcnt(0)
    s_barrier
    v_mfma_f32_32x32x16_bf16 v[208:223], v[192:195], v[160:163], v[208:223]
    ds_read_b64_tr_b16 v[176:177], v246 offset:32768
    ds_read_b64_tr_b16 v[178:179], v246 offset:33792
    ds_read_b64_tr_b16 v[180:181], v246 offset:36864
    ds_read_b64_tr_b16 v[182:183], v246 offset:37888
    s_add_u32 s62, s55, s99
    s_add_u32 s62, s62, 1
    v_mfma_f32_32x32x16_bf16 v[208:223], v[196:199], v[164:167], v[208:223]
    ds_read_b64_tr_b16 v[184:185], v246 offset:40960
    ds_read_b64_tr_b16 v[186:187], v246 offset:41984
    ds_read_b64_tr_b16 v[188:189], v246 offset:45056
    ds_read_b64_tr_b16 v[190:191], v246 offset:46080
    s_cmp_ge_u32 s62, 27
    s_cselect_b32 s62, 0, s62
    s_lshl_b32 s62, s62, 17
    v_mfma_f32_32x32x16_bf16 v[208:223], v[200:203], v[168:171], v[208:223]
    s_lshl_b32 s61, s53, 1
    s_add_u32 s61, s61, s58
    s_lshl_b32 s61, s61, 11
    s_add_u32 s62, s62, s61
    s_add_u32 s62, s62, 0x100000
    v_mfma_f32_32x32x16_bf16 v[208:223], v[204:207], v[172:175], v[208:223]
    s_waitcnt vmcnt(0)
    v_pk_add_f32 v[248:249], v[248:249], v[250:251]
    v_pk_add_f32 v[252:253], v[252:253], v[254:255]
    v_pk_add_f32 v[4:5], v[248:249], v[252:253]
    v_mov_b32 v10, v4
    v_mov_b32 v11, v5
    s_nop 0
    v_permlane32_swap_b32 v4, v10
    v_permlane32_swap_b32 v5, v11
    v_pk_add_f32 v[4:5], v[4:5], v[10:11]
    v_mul_f32 v4, 0x3a97b426, v4
    v_mul_f32 v5, 0x3a97b426, v5
    v_fma_f32 v5, -v4, v4, v5
    v_max_f32 v5, 0, v5
    v_add_f32 v5, 0x3727c5ac, v5
    v_rsq_f32 v10, v5
    s_nop 0
    v_mul_f32_e64 v11, -v4, v10
    v_pk_fma_f32 v[224:225], v[224:225], v[10:11], v[10:11] op_sel:[0,0,1] op_sel_hi:[1,0,1]
    v_pk_fma_f32 v[226:227], v[226:227], v[10:11], v[10:11] op_sel:[0,0,1] op_sel_hi:[1,0,1]
    v_pk_fma_f32 v[228:229], v[228:229], v[10:11], v[10:11] op_sel:[0,0,1] op_sel_hi:[1,0,1]
    v_pk_fma_f32 v[230:231], v[230:231], v[10:11], v[10:11] op_sel:[0,0,1] op_sel_hi:[1,0,1]
    v_pk_fma_f32 v[232:233], v[232:233], v[10:11], v[10:11] op_sel:[0,0,1] op_sel_hi:[1,0,1]
    v_pk_fma_f32 v[234:235], v[234:235], v[10:11], v[10:11] op_sel:[0,0,1] op_sel_hi:[1,0,1]
    v_pk_fma_f32 v[236:237], v[236:237], v[10:11], v[10:11] op_sel:[0,0,1] op_sel_hi:[1,0,1]
    v_pk_fma_f32 v[238:239], v[238:239], v[10:11], v[10:11] op_sel:[0,0,1] op_sel_hi:[1,0,1]
    v_cvt_pk_bf16_f32 v248, v224, v225
    v_cvt_pk_bf16_f32 v249, v226, v227
    v_cvt_pk_bf16_f32 v250, v228, v229
    v_cvt_pk_bf16_f32 v251, v230, v231
    v_cvt_pk_bf16_f32 v252, v232, v233
    v_cvt_pk_bf16_f32 v253, v234, v235
    v_cvt_pk_bf16_f32 v254, v236, v237
    v_cvt_pk_bf16_f32 v255, v238, v239
    ds_write_b64 v14, v[248:249] offset:0
    ds_write_b64 v14, v[250:251] offset:16
    ds_write_b64 v14, v[252:253] offset:32
    ds_write_b64 v14, v[254:255] offset:48
    ds_read_b64_tr_b16 v[248:249], v15 offset:0
    ds_read_b64_tr_b16 v[250:251], v15 offset:288
    ds_read_b64_tr_b16 v[252:253], v15 offset:1152
    ds_read_b64_tr_b16 v[254:255], v15 offset:1440
    s_cmp_eq_u32 s99, 3
    s_cbranch_scc1 Le_61
    v_pk_mul_f32 v[224:225], v[208:209], v[208:209]
    v_pk_mul_f32 v[226:227], v[212:213], v[212:213]
    v_pk_mul_f32 v[228:229], v[216:217], v[216:217]
    v_pk_mul_f32 v[230:231], v[220:221], v[220:221]
    v_pk_fma_f32 v[224:225], v[210:211], v[210:211], v[224:225]
    v_pk_fma_f32 v[226:227], v[214:215], v[214:215], v[226:227]
    v_pk_fma_f32 v[228:229], v[218:219], v[218:219], v[228:229]
    v_pk_fma_f32 v[230:231], v[222:223], v[222:223], v[230:231]
    v_cvt_pk_bf16_f32 v208, v208, v209
    v_cvt_pk_bf16_f32 v209, v210, v211
    v_cvt_pk_bf16_f32 v210, v212, v213
    v_cvt_pk_bf16_f32 v211, v214, v215
    v_cvt_pk_bf16_f32 v212, v216, v217
    v_cvt_pk_bf16_f32 v213, v218, v219
    v_cvt_pk_bf16_f32 v214, v220, v221
    v_cvt_pk_bf16_f32 v215, v222, v223
    v_add_f32 v224, v224, v225
    v_add_f32 v226, v226, v227
    v_add_f32 v228, v228, v229
    v_add_f32 v230, v230, v231
    ds_write_b64 v247, v[208:209]
    ds_write_b64 v247, v[210:211] offset:16
    v_max_u32 v10, v224, v226
    s_cmp_eq_u32 s99, 2
    s_cbranch_scc1 Le_59
    v_max3_u32 v10, v10, v228, v230
    ds_write_b64 v247, v[212:213] offset:32
    ds_write_b64 v247, v[214:215] offset:48
Le_59:
    v_max_u32_dpp v10, v10, v10 row_shr:1 row_mask:0xf bank_mask:0xf
    s_nop 1
    v_max_u32_dpp v10, v10, v10 row_shr:2 row_mask:0xf bank_mask:0xf
    s_nop 1
    v_max_u32_dpp v10, v10, v10 row_shr:4 row_mask:0xf bank_mask:0xf
    s_nop 1
    v_max_u32_dpp v10, v10, v10 row_shr:8 row_mask:0xf bank_mask:0xf
    v_mov_b32 v4, 0x27e20
    s_mov_b32 exec_lo, 0x80008000
    s_mov_b32 exec_hi, 0x80008000
    ds_max_u32 v4, v10
    s_mov_b64 exec, -1
    s_branch Le_60
Le_61:
    s_cmp_lt_u32 s100, 47
    s_cbranch_scc0 Le_60
    v_lshrrev_b32 v10, 4, v1
    v_bfe_u32 v11, v1, 2, 2
    v_and_b32 v12, 3, v1
    v_lshrrev_b32 v9, 1, v10
    v_lshlrev_b32 v9, 4, v9
    v_and_b32 v10, 1, v10
    v_lshl_add_u32 v9, v10, 2, v9
    v_add_u32 v9, v9, v11
    v_mul_u32_u24 v9, 160, v9
    v_lshl_add_u32 v9, v12, 3, v9
    s_mul_i32 s61, s58, 5120
    s_add_u32 s61, s61, 51200
    v_add_u32 v9, s61, v9
    ds_read_b64_tr_b16 v[224:225], v9 offset:0
    ds_read_b64_tr_b16 v[226:227], v9 offset:1280
    ds_read_b64_tr_b16 v[228:229], v9 offset:32
    ds_read_b64_tr_b16 v[230:231], v9 offset:1312
    ds_read_b64_tr_b16 v[232:233], v9 offset:64
    ds_read_b64_tr_b16 v[234:235], v9 offset:1344
    ds_read_b64_tr_b16 v[236:237], v9 offset:96
    ds_read_b64_tr_b16 v[238:239], v9 offset:1376
    ds_read_b64_tr_b16 v[240:241], v9 offset:128
    ds_read_b64_tr_b16 v[242:243], v9 offset:1408
    s_mul_i32 s60, s54, 48
    s_add_u32 s60, s60, s100
    s_mul_i32 s60, s60, 5120
    s_add_u32 s60, s60, 0xf00000
    s_add_u32 s61, s60, 4096
    s_waitcnt lgkmcnt(0)
    buffer_store_dwordx4 v[224:227], v7, s[44:47], s60 offen offset:0 sc1
    buffer_store_dwordx4 v[228:231], v7, s[44:47], s60 offen offset:1024 sc1
    buffer_store_dwordx4 v[232:235], v7, s[44:47], s60 offen offset:2048 sc1
    buffer_store_dwordx4 v[236:239], v7, s[44:47], s60 offen offset:3072 sc1
    buffer_store_dwordx4 v[240:243], v7, s[44:47], s61 offen sc1
Le_60:
    s_cmp_ge_u32 s99, s56
    s_cbranch_scc1 Lz_62
    s_waitcnt lgkmcnt(0)
    buffer_store_dwordx4 v[248:251], v7, s[44:47], s62 offen offset:0 sc1
    buffer_store_dwordx4 v[252:255], v7, s[44:47], s62 offen offset:1024 sc1
Lz_62:
    s_cmp_ge_u32 s52, 4
    s_cbranch_scc1 L_roleB
    s_waitcnt vmcnt(9)
    s_waitcnt lgkmcnt(0)
    s_barrier
    v_mfma_f32_32x32x16_bf16 v[224:239], v[176:179], v[16:19], 0
    ds_read_b64_tr_b16 v[192:193], v246 offset:49152
    ds_read_b64_tr_b16 v[194:195], v246 offset:50176
    ds_read_b64_tr_b16 v[196:197], v246 offset:53248
    ds_read_b64_tr_b16 v[198:199], v246 offset:54272
    v_mfma_f32_32x32x16_bf16 v[224:239], v[180:183], v[20:23], v[224:239]
    ds_read_b64_tr_b16 v[200:201], v246 offset:57344
    ds_read_b64_tr_b16 v[202:203], v246 offset:58368
    ds_read_b64_tr_b16 v[204:205], v246 offset:61440
    ds_read_b64_tr_b16 v[206:207], v246 offset:62464
    s_add_u32 m0, s93, 114688
    s_add_u32 s60, s92, s90
    buffer_load_dwordx4 v245, s[20:23], s60 offen lds
    s_add_u32 s90, s90, 110592
    v_mfma_f32_32x32x16_bf16 v[224:239], v[184:187], v[24:27], v[224:239]
    s_add_u32 m0, s93, 122880
    s_add_u32 s60, s92, s90
    buffer_load_dwordx4 v245, s[20:23], s60 offen lds
    s_add_u32 s90, s90, 110592
    s_cmp_eq_u32 s90, 2211840
    s_cselect_b32 s90, 0, s90
    v_mfma_f32_32x32x16_bf16 v[224:239], v[188:191], v[28:31], v[224:239]
    s_waitcnt vmcnt(8)
    s_waitcnt lgkmcnt(0)
    s_barrier
    v_mfma_f32_32x32x16_bf16 v[224:239], v[192:195], v[32:35], v[224:239]
    ds_read_b64_tr_b16 v[176:177], v246 offset:0
    ds_read_b64_tr_b16 v[178:179], v246 offset:1024
    ds_read_b64_tr_b16 v[180:181], v246 offset:4096
    ds_read_b64_tr_b16 v[182:183], v246 offset:5120
    v_mfma_f32_32x32x16_bf16 v[224:239], v[196:199], v[36:39], v[224:239]
    ds_read_b64_tr_b16 v[184:185], v246 offset:8192
    ds_read_b64_tr_b16 v[186:187], v246 offset:9216
    ds_read_b64_tr_b16 v[188:189], v246 offset:12288
    ds_read_b64_tr_b16 v[190:191], v246 offset:13312
    s_add_u32 m0, s93, 131072
    s_add_u32 s60, s92, s90
    buffer_load_dwordx4 v245, s[20:23], s60 offen lds
    s_add_u32 s90, s90, 110592
    v_mfma_f32_32x32x16_bf16 v[224:239], v[200:203], v[40:43], v[224:239]
    s_add_u32 m0, s93, 139264
    s_add_u32 s60, s92, s90
    buffer_load_dwordx4 v245, s[20:23], s60 offen lds
    s_add_u32 s90, s90, 110592
    s_cmp_eq_u32 s90, 2211840
    s_cselect_b32 s90, 0, s90
    v_mfma_f32_32x32x16_bf16 v[224:239], v[204:207], v[44:47], v[224:239]
    s_waitcnt vmcnt(8)
    s_waitcnt lgkmcnt(0)
    s_barrier
    v_mfma_f32_32x32x16_bf16 v[224:239], v[176:179], v[48:51], v[224:239]
    ds_read_b64_tr_b16 v[192:193], v246 offset:16384
    ds_read_b64_tr_b16 v[194:195], v246 offset:17408
    ds_read_b64_tr_b16 v[196:197], v246 offset:20480
    ds_read_b64_tr_b16 v[198:199], v246 offset:21504
    v_mfma_f32_32x32x16_bf16 v[224:239], v[180:183], v[52:55], v[224:239]
    ds_read_b64_tr_b16 v[200:201], v246 offset:24576
    ds_read_b64_tr_b16 v[202:203], v246 offset:25600
    ds_read_b64_tr_b16 v[204:205], v246 offset:28672
    ds_read_b64_tr_b16 v[206:207], v246 offset:29696
    s_add_u32 m0, s93, 81920
    s_add_u32 s60, s92, s90
    buffer_load_dwordx4 v245, s[20:23], s60 offen lds
    s_add_u32 s90, s90, 110592
    v_mfma_f32_32x32x16_bf16 v[224:239], v[184:187], v[56:59], v[224:239]
    s_add_u32 m0, s93, 90112
    s_add_u32 s60, s92, s90
    buffer_load_dwordx4 v245, s[20:23], s60 offen lds
    s_add_u32 s90, s90, 110592
    s_cmp_eq_u32 s90, 2211840
    s_cselect_b32 s90, 0, s90
    v_mfma_f32_32x32x16_bf16 v[224:239], v[188:191], v[60:63], v[224:239]
    s_waitcnt vmcnt(6)
    v_mov_b32 v11, 1
    s_cmp_lt_u32 s100, 47
    s_cbranch_scc0 Lz_64
    s_lshl_b32 s60, s54, 6
    s_add_u32 s60, s60, s100
    s_lshl_b32 s60, s60, 2
    s_add_u32 s60, s60, 9216
    v_mov_b32 v10, 0
    s_mov_b64 exec, 1
    buffer_store_dword v11, v10, s[44:47], s60 offen sc1
    s_mov_b64 exec, -1
Lz_64:
    v_lshlrev_b32 v4, 2, v1
    buffer_load_dword v12, v4, s[44:47], 0 offen sc1
    buffer_load_dword v13, v4, s[44:47], 0 offen offset:256 sc1
    s_waitcnt vmcnt(6)
    s_waitcnt lgkmcnt(0)
    s_barrier
    v_mfma_f32_32x32x16_bf16 v[224:239], v[192:195], v[64:67], v[224:239]
    ds_read_b64_tr_b16 v[176:177], v246 offset:32768
    ds_read_b64_tr_b16 v[178:179], v246 offset:33792
    ds_read_b64_tr_b16 v[180:181], v246 offset:36864
    ds_read_b64_tr_b16 v[182:183], v246 offset:37888
    s_cmp_eq_u32 s52, 1
    s_cbranch_scc0 Lz_65
    v_add_u32 v16, s54, v1
    v_and_b32 v16, 7, v16
    v_lshlrev_b32 v16, 7, v16
    v_lshl_add_u32 v16, v1, 2, v16
    s_lshr_b32 s61, s53, 3
    s_lshl_b32 s61, s61, 10
    s_and_b32 s62, s53, 7
    s_lshl_b32 s62, s62, 3
    s_add_u32 s61, s61, s62
    s_add_u32 s61, s61, 5120
    v_mov_b32 v17, 1
    s_mov_b64 exec, 3
    buffer_store_dword v17, v16, s[44:47], s61 offen sc1
    s_mov_b64 exec, -1
Lz_65:
    s_mul_i32 s62, s54, 10
    s_and_b32 s61, s52, 2
    s_lshl_b32 s61, s61, 1
    s_add_u32 s61, s61, s62
    s_and_b32 s63, s52, 1
    s_lshl_b32 s63, s63, 11
    v_lshrrev_b32 v17, 4, v2
    v_lshlrev_b32 v17, 10, v17
    v_mfma_f32_32x32x16_bf16 v[224:239], v[196:199], v[68:71], v[224:239]
    ds_read_b64_tr_b16 v[184:185], v246 offset:40960
    ds_read_b64_tr_b16 v[186:187], v246 offset:41984
    ds_read_b64_tr_b16 v[188:189], v246 offset:45056
    ds_read_b64_tr_b16 v[190:191], v246 offset:46080
    s_add_u32 m0, s93, 98304
    s_add_u32 s60, s92, s90
    buffer_load_dwordx4 v245, s[20:23], s60 offen lds
    s_add_u32 s90, s90, 110592
    v_and_b32 v16, 15, v2
    v_lshl_add_u32 v17, v16, 4, v17
    v_add_u32 v17, s63, v17
    v_add_u32 v16, s61, v3
    v_lshrrev_b32 v8, 2, v16
    v_lshl_add_u32 v8, v8, 12, v17
    v_and_b32 v16, 3, v16
    v_lshl_add_u32 v8, v16, 8, v8
    v_mfma_f32_32x32x16_bf16 v[224:239], v[200:203], v[72:75], v[224:239]
    s_add_u32 m0, s93, 106496
    s_add_u32 s60, s92, s90
    buffer_load_dwordx4 v245, s[20:23], s60 offen lds
    s_add_u32 s90, s90, 110592
    s_cmp_eq_u32 s90, 2211840
    s_cselect_b32 s90, 0, s90
    s_add_u32 s61, s61, 2
    v_add_u32 v16, s61, v3
    v_lshrrev_b32 v9, 2, v16
    v_lshl_add_u32 v9, v9, 12, v17
    v_and_b32 v16, 3, v16
    v_lshl_add_u32 v9, v16, 8, v9
    s_add_u32 s61, s61, 2
    s_lshr_b32 s61, s52, 1
    s_add_u32 s61, s61, s62
    s_add_u32 s61, s61, 8
    s_lshr_b32 s62, s61, 2
    s_lshl_b32 s62, s62, 12
    s_and_b32 s61, s61, 3
    s_lshl_b32 s61, s61, 8
    s_add_u32 s62, s62, s61
    v_add_u32 v10, s62, v17
    v_lshlrev_b32 v5, 3, v2
    v_mfma_f32_32x32x16_bf16 v[224:239], v[204:207], v[76:79], v[224:239]
    s_waitcnt vmcnt(6)
    s_waitcnt lgkmcnt(0)
    s_barrier
    v_mfma_f32_32x32x16_bf16 v[224:239], v[176:179], v[80:83], v[224:239]
    ds_read_b64_tr_b16 v[192:193], v246 offset:49152
    ds_read_b64_tr_b16 v[194:195], v246 offset:50176
    ds_read_b64_tr_b16 v[196:197], v246 offset:53248
    ds_read_b64_tr_b16 v[198:199], v246 offset:54272
    v_mfma_f32_32x32x16_bf16 v[224:239], v[180:183], v[84:87], v[224:239]
    ds_read_b64_tr_b16 v[200:201], v246 offset:57344
    ds_read_b64_tr_b16 v[202:203], v246 offset:58368
    ds_read_b64_tr_b16 v[204:205], v246 offset:61440
    ds_read_b64_tr_b16 v[206:207], v246 offset:62464
    s_add_u32 m0, s93, 114688
    s_add_u32 s60, s92, s90
    buffer_load_dwordx4 v245, s[20:23], s60 offen lds
    s_add_u32 s90, s90, 110592
    v_mfma_f32_32x32x16_bf16 v[224:239], v[184:187], v[88:91], v[224:239]
    s_add_u32 m0, s93, 122880
    s_add_u32 s60, s92, s90
    buffer_load_dwordx4 v245, s[20:23], s60 offen lds
    s_add_u32 s90, s90, 110592
    s_cmp_eq_u32 s90, 2211840
    s_cselect_b32 s90, 0, s90
    v_mfma_f32_32x32x16_bf16 v[224:239], v[188:191], v[92:95], v[224:239]
    s_mov_b64 s[4:5], -1
    s_mov_b32 s3, 0x20000
    s_waitcnt vmcnt(5)
    s_branch Lpollc_67
Lpoll_66:
    buffer_load_dword v12, v4, s[44:47], 0 offen sc1
    s_waitcnt vmcnt(0)
Lpollc_67:
    v_cmp_ne_u32 vcc, 0, v12
    s_nop 0
    s_and_b64 s[6:7], vcc, s[4:5]
    s_cmp_eq_u64 s[6:7], s[4:5]
    s_cbranch_scc1 Lpolld_68
    s_sub_u32 s3, s3, 1
    s_cbranch_scc1 Lpolld_68
    s_sleep 2
    s_branch Lpoll_66
Lpolld_68:
    s_mov_b32 s60, 256
    s_mov_b32 s3, 0x20000
    s_waitcnt vmcnt(4)
    s_branch Lpollc_70
Lpoll_69:
    buffer_load_dword v13, v4, s[44:47], s60 offen sc1
    s_waitcnt vmcnt(0)
Lpollc_70:
    v_cmp_ne_u32 vcc, 0, v13
    s_nop 0
    s_and_b64 s[6:7], vcc, s[4:5]
    s_cmp_eq_u64 s[6:7], s[4:5]
    s_cbranch_scc1 Lpolld_71
    s_sub_u32 s3, s3, 1
    s_cbranch_scc1 Lpolld_71
    s_sleep 2
    s_branch Lpoll_69
Lpolld_71:
    s_lshr_b32 s60, s2, 4
    s_lshl_b32 s60, s60, 12
    s_and_b32 s60, s60, 0xffff
    s_add_u32 s91, s60, 4096
    s_and_b32 s91, s91, 0xffff
    buffer_load_dwordx4 v[52:55], v7, s[16:19], s60 offen sc1
    buffer_load_dwordx2 v[64:65], v5, s[16:19], s60 offen offset:3072 sc1
    buffer_load_dwordx4 v[56:59], v7, s[16:19], s60 offen offset:1024 sc1
    buffer_load_dwordx4 v[60:63], v7, s[16:19], s60 offen offset:2048 sc1
    buffer_load_dwordx4 v[66:69], v7, s[16:19], s91 offen sc1
    buffer_load_dwordx2 v[78:79], v5, s[16:19], s91 offen offset:3072 sc1
    s_waitcnt vmcnt(12)
    s_waitcnt lgkmcnt(0)
    s_barrier
    v_mfma_f32_32x32x16_bf16 v[224:239], v[192:195], v[96:99], v[224:239]
    ds_read_b64_tr_b16 v[176:177], v246 offset:0
    ds_read_b64_tr_b16 v[178:179], v246 offset:1024
    ds_read_b64_tr_b16 v[180:181], v246 offset:4096
    ds_read_b64_tr_b16 v[182:183], v246 offset:5120
    v_mfma_f32_32x32x16_bf16 v[224:239], v[196:199], v[100:103], v[224:239]
    ds_read_b64_tr_b16 v[184:185], v246 offset:8192
    ds_read_b64_tr_b16 v[186:187], v246 offset:9216
    ds_read_b64_tr_b16 v[188:189], v246 offset:12288
    ds_read_b64_tr_b16 v[190:191], v246 offset:13312
    s_add_u32 m0, s93, 131072
    s_add_u32 s60, s92, s90
    buffer_load_dwordx4 v245, s[20:23], s60 offen lds
    s_add_u32 s90, s90, 110592
    v_mfma_f32_32x32x16_bf16 v[224:239], v[200:203], v[104:107], v[224:239]
    s_add_u32 m0, s93, 139264
    s_add_u32 s60, s92, s90
    buffer_load_dwordx4 v245, s[20:23], s60 offen lds
    s_add_u32 s90, s90, 110592
    s_cmp_eq_u32 s90, 2211840
    s_cselect_b32 s90, 0, s90
    v_mfma_f32_32x32x16_bf16 v[224:239], v[204:207], v[108:111], v[224:239]
    s_waitcnt vmcnt(10)
    s_waitcnt lgkmcnt(0)
    s_barrier
    v_mfma_f32_32x32x16_bf16 v[224:239], v[176:179], v[112:115], v[224:239]
    ds_read_b64_tr_b16 v[192:193], v246 offset:16384
    ds_read_b64_tr_b16 v[194:195], v246 offset:17408
    ds_read_b64_tr_b16 v[196:197], v246 offset:20480
    ds_read_b64_tr_b16 v[198:199], v246 offset:21504
    v_mfma_f32_32x32x16_bf16 v[224:239], v[180:183], v[116:119], v[224:239]
    ds_read_b64_tr_b16 v[200:201], v246 offset:24576
    ds_read_b64_tr_b16 v[202:203], v246 offset:25600
    ds_read_b64_tr_b16 v[204:205], v246 offset:28672
    ds_read_b64_tr_b16 v[206:207], v246 offset:29696
    v_mfma_f32_32x32x16_bf16 v[224:239], v[184:187], v[120:123], v[224:239]
    v_mfma_f32_32x32x16_bf16 v[224:239], v[188:191], v[124:127], v[224:239]
    s_waitcnt vmcnt(8)
    s_waitcnt lgkmcnt(0)
    s_barrier
    v_mfma_f32_32x32x16_bf16 v[224:239], v[192:195], v[128:131], v[224:239]
    ds_read_b64_tr_b16 v[176:177], v246 offset:32768
    ds_read_b64_tr_b16 v[178:179], v246 offset:33792
    ds_read_b64_tr_b16 v[180:181], v246 offset:36864
    ds_read_b64_tr_b16 v[182:183], v246 offset:37888
    v_mul_u32_u24 v18, 168, v2
    v_add_u32 v18, 0x24000, v18
    v_lshl_add_u32 v19, v3, 3, v18
    s_add_u32 s60, s52, 0
    s_and_b32 s61, s60, 1
    s_mul_i32 s61, s61, 5376
    s_and_b32 s60, s60, 2
    s_mul_i32 s60, s60, 40
    s_add_u32 s60, s60, s61
    v_add_u32 v20, s60, v19
    v_add_u32 v21, s60, v18
    ds_read2_b64 v[80:83], v20 offset0:0 offset1:2
    ds_read_b64 v[84:85], v21 offset:32
    v_mfma_f32_32x32x16_bf16 v[224:239], v[196:199], v[132:135], v[224:239]
    ds_read_b64_tr_b16 v[184:185], v246 offset:40960
    ds_read_b64_tr_b16 v[186:187], v246 offset:41984
    ds_read_b64_tr_b16 v[188:189], v246 offset:45056
    ds_read_b64_tr_b16 v[190:191], v246 offset:46080
    ds_read2_b64 v[86:89], v20 offset0:5 offset1:7
    ds_read_b64 v[90:91], v21 offset:72
    s_add_u32 s60, s52, 1
    s_and_b32 s61, s60, 1
    s_mul_i32 s61, s61, 5376
    s_and_b32 s60, s60, 2
    s_mul_i32 s60, s60, 40
    s_add_u32 s60, s60, s61
    v_add_u32 v20, s60, v19
    v_add_u32 v21, s60, v18
    ds_read2_b64 v[92:95], v20 offset0:0 offset1:2
    ds_read_b64 v[96:97], v21 offset:32
    ds_read2_b64 v[98:101], v20 offset0:5 offset1:7
    v_mfma_f32_32x32x16_bf16 v[224:239], v[200:203], v[136:139], v[224:239]
    ds_read_b64 v[102:103], v21 offset:72
    s_add_u32 s60, s52, 2
    s_and_b32 s61, s60, 1
    s_mul_i32 s61, s61, 5376
    s_and_b32 s60, s60, 2
    s_mul_i32 s60, s60, 40
    s_add_u32 s60, s60, s61
    v_add_u32 v20, s60, v19
    v_add_u32 v21, s60, v18
    ds_read2_b64 v[104:107], v20 offset0:0 offset1:2
    ds_read_b64 v[108:109], v21 offset:32
    ds_read2_b64 v[110:113], v20 offset0:5 offset1:7
    ds_read_b64 v[114:115], v21 offset:72
    s_add_u32 s60, s52, 3
    s_and_b32 s61, s60, 1
    s_mul_i32 s61, s61, 5376
    s_and_b32 s60, s60, 2
    s_mul_i32 s60, s60, 40
    s_add_u32 s60, s60, s61
    v_add_u32 v20, s60, v19
    v_add_u32 v21, s60, v18
    ds_read2_b64 v[116:119], v20 offset0:0 offset1:2
    ds_read_b64 v[120:121], v21 offset:32
    ds_read2_b64 v[122:125], v20 offset0:5 offset1:7
    ds_read_b64 v[126:127], v21 offset:72
    v_mov_b32 v22, 0x27e20
    ds_read_b32 v22, v22
    v_mfma_f32_32x32x16_bf16 v[224:239], v[204:207], v[140:143], v[224:239]
    s_waitcnt vmcnt(0)
    s_waitcnt lgkmcnt(0)
    s_barrier
    v_mfma_f32_32x32x16_bf16 v[224:239], v[176:179], v[144:147], v[224:239]
    ds_read_b64_tr_b16 v[192:193], v246 offset:49152
    ds_read_b64_tr_b16 v[194:195], v246 offset:50176
    ds_read_b64_tr_b16 v[196:197], v246 offset:53248
    ds_read_b64_tr_b16 v[198:199], v246 offset:54272
    v_cmp_eq_u32 vcc, 0, v3
    s_nop 1
    v_cndmask_b32 v84, 0, v84, vcc
    v_cndmask_b32 v85, 0, v85, vcc
    v_cndmask_b32 v90, 0, v90, vcc
    v_cndmask_b32 v91, 0, v91, vcc
    v_cndmask_b32 v96, 0, v96, vcc
    v_cndmask_b32 v97, 0, v97, vcc
    v_cndmask_b32 v102, 0, v102, vcc
    v_cndmask_b32 v103, 0, v103, vcc
    v_cndmask_b32 v108, 0, v108, vcc
    v_mfma_f32_32x32x16_bf16 v[224:239], v[180:183], v[148:151], v[224:239]
    ds_read_b64_tr_b16 v[200:201], v246 offset:57344
    ds_read_b64_tr_b16 v[202:203], v246 offset:58368
    ds_read_b64_tr_b16 v[204:205], v246 offset:61440
    ds_read_b64_tr_b16 v[206:207], v246 offset:62464
    v_cndmask_b32 v109, 0, v109, vcc
    v_cndmask_b32 v114, 0, v114, vcc
    v_cndmask_b32 v115, 0, v115, vcc
    v_cndmask_b32 v120, 0, v120, vcc
    v_cndmask_b32 v121, 0, v121, vcc
    v_cndmask_b32 v126, 0, v126, vcc
    v_cndmask_b32 v127, 0, v127, vcc
    v_max_u32_dpp v12, v12, v12 row_shr:1 row_mask:0xf bank_mask:0xf
    s_nop 1
    v_max_u32_dpp v12, v12, v12 row_shr:2 row_mask:0xf bank_mask:0xf
    s_nop 1
    v_max_u32_dpp v12, v12, v12 row_shr:4 row_mask:0xf bank_mask:0xf
    v_mfma_f32_32x32x16_bf16 v[224:239], v[184:187], v[152:155], v[224:239]
    s_nop 0
    v_max_u32_dpp v12, v12, v12 row_shr:8 row_mask:0xf bank_mask:0xf
    s_nop 1
    v_max_u32_dpp v12, v12, v12 row_bcast:15 row_mask:0xa bank_mask:0xf
    s_nop 1
    v_max_u32_dpp v12, v12, v12 row_bcast:31 row_mask:0xc bank_mask:0xf
    v_max_u32_dpp v13, v13, v13 row_shr:1 row_mask:0xf bank_mask:0xf
    s_nop 1
    v_max_u32_dpp v13, v13, v13 row_shr:2 row_mask:0xf bank_mask:0xf
    s_nop 1
    v_max_u32_dpp v13, v13, v13 row_shr:4 row_mask:0xf bank_mask:0xf
    s_nop 1
    v_max_u32_dpp v13, v13, v13 row_shr:8 row_mask:0xf bank_mask:0xf
    s_nop 1
    v_max_u32_dpp v13, v13, v13 row_bcast:15 row_mask:0xa bank_mask:0xf
    s_nop 1
    v_max_u32_dpp v13, v13, v13 row_bcast:31 row_mask:0xc bank_mask:0xf
    v_readlane_b32 s62, v12, 63
    v_readlane_b32 s63, v13, 63
    s_nop 0
    v_mul_f32 v22, s62, v22
    v_mov_b32 v23, 0x44f51919
    v_cmp_nle_f32 s[6:7], v22, v23
    s_cmp_gt_u32 s63, 0x46800000
    s_cselect_b32 s60, 1, 0
    s_or_b32 s6, s6, s60
    s_lshl_b32 s60, s52, 12
    s_add_u32 s60, s60, 114688
    v_add_u32 v11, s60, v7
    v_mfma_f32_32x32x16_bf16 v[224:239], v[188:191], v[156:159], v[224:239]
    s_waitcnt lgkmcnt(0)
    s_barrier
    v_mfma_f32_32x32x16_bf16 v[224:239], v[192:195], v[160:163], v[224:239]
    v_mfma_f32_32x32x16_bf16 v[224:239], v[196:199], v[164:167], v[224:239]
    v_mfma_f32_32x32x16_bf16 v[224:239], v[200:203], v[168:171], v[224:239]
    v_mfma_f32_32x32x16_bf16 v[224:239], v[204:207], v[172:175], v[224:239]
    s_waitcnt vmcnt(2)
    v_mfma_f32_32x32x16_bf16 v[20:35], v[52:55], v[80:83], 0
    v_mfma_f32_32x32x8_bf16 v[20:35], v[64:65], v[84:85], v[20:35]
    s_nop 8
    ds_write_b128 v11, v[224:227] offset:0
    ds_write_b128 v11, v[228:231] offset:1024
    ds_write_b128 v11, v[232:235] offset:2048
    ds_write_b128 v11, v[236:239] offset:3072
    v_mov_b32 v12, 0x27e04
    v_mov_b32 v13, 1
    s_mov_b64 exec, 1
    ds_add_u32 v12, v13
    s_mov_b64 exec, -1
    s_cmp_lg_u64 s[6:7], 0
    s_cbranch_scc1 L_fallback
    s_mov_b32 s92, 1
    v_mfma_f32_32x32x16_bf16 v[36:51], v[52:55], v[86:89], 0
    v_exp_f32 v20, v20
    v_exp_f32 v21, v21
    v_exp_f32 v22, v22
    v_mfma_f32_32x32x8_bf16 v[36:51], v[64:65], v[90:91], v[36:51]
    v_exp_f32 v23, v23
    v_exp_f32 v24, v24
    v_exp_f32 v25, v25
    v_exp_f32 v26, v26
    v_exp_f32 v27, v27
    v_cvt_pk_bf16_f32 v12, v20, v21
    v_cvt_pk_bf16_f32 v13, v22, v23
    v_cvt_pk_bf16_f32 v14, v24, v25
    v_cvt_pk_bf16_f32 v15, v26, v27
    s_setprio 3
    buffer_load_dwordx4 v[70:73], v7, s[16:19], s91 offen offset:1024 sc1
    buffer_load_dwordx4 v[74:77], v7, s[16:19], s91 offen offset:2048 sc1
    s_setprio 0
    s_add_u32 s91, s91, 4096
    s_and_b32 s91, s91, 0xffff
    v_exp_f32 v28, v28
    v_exp_f32 v29, v29
    v_exp_f32 v30, v30
    s_waitcnt vmcnt(4)
    v_mfma_f32_32x32x16_bf16 v[128:143], v[56:59], v[12:15], 0
    v_exp_f32 v31, v31
    v_exp_f32 v32, v32
    v_exp_f32 v33, v33
    v_exp_f32 v34, v34
    v_exp_f32 v35, v35
    v_cvt_pk_bf16_f32 v16, v28, v29
    v_cvt_pk_bf16_f32 v17, v30, v31
    v_cvt_pk_bf16_f32 v18, v32, v33
    v_cvt_pk_bf16_f32 v19, v34, v35
    v_mfma_f32_32x32x16_bf16 v[20:35], v[52:55], v[92:95], 0
    v_exp_f32 v36, v36
    v_exp_f32 v37, v37
    v_exp_f32 v38, v38
    v_mfma_f32_32x32x8_bf16 v[20:35], v[64:65], v[96:97], v[20:35]
    v_exp_f32 v39, v39
    v_exp_f32 v40, v40
    v_exp_f32 v41, v41
    v_exp_f32 v42, v42
    v_exp_f32 v43, v43
    v_cvt_pk_bf16_f32 v12, v36, v37
    v_cvt_pk_bf16_f32 v13, v38, v39
    v_cvt_pk_bf16_f32 v14, v40, v41
    v_cvt_pk_bf16_f32 v15, v42, v43
    v_mfma_f32_32x32x16_bf16 v[128:143], v[60:63], v[16:19], v[128:143]
    v_exp_f32 v44, v44
    v_exp_f32 v45, v45
    v_exp_f32 v46, v46
    v_mfma_f32_32x32x16_bf16 v[144:159], v[56:59], v[12:15], 0
    v_exp_f32 v47, v47
    v_exp_f32 v48, v48
    v_exp_f32 v49, v49
    v_exp_f32 v50, v50
    v_exp_f32 v51, v51
    v_cvt_pk_bf16_f32 v16, v44, v45
    v_cvt_pk_bf16_f32 v17, v46, v47
    v_cvt_pk_bf16_f32 v18, v48, v49
    v_cvt_pk_bf16_f32 v19, v50, v51
    v_mfma_f32_32x32x16_bf16 v[36:51], v[52:55], v[98:101], 0
    v_exp_f32 v20, v20
    v_exp_f32 v21, v21
    v_exp_f32 v22, v22
    v_mfma_f32_32x32x8_bf16 v[36:51], v[64:65], v[102:103], v[36:51]
    v_exp_f32 v23, v23
    v_exp_f32 v24, v24
    v_exp_f32 v25, v25
    v_exp_f32 v26, v26
    v_exp_f32 v27, v27
    v_cvt_pk_bf16_f32 v12, v20, v21
    v_cvt_pk_bf16_f32 v13, v22, v23
    v_cvt_pk_bf16_f32 v14, v24, v25
    v_cvt_pk_bf16_f32 v15, v26, v27
    v_mfma_f32_32x32x16_bf16 v[144:159], v[60:63], v[16:19], v[144:159]
    v_exp_f32 v28, v28
    v_exp_f32 v29, v29
    v_exp_f32 v30, v30
    v_mfma_f32_32x32x16_bf16 v[160:175], v[56:59], v[12:15], 0
    v_exp_f32 v31, v31
    v_exp_f32 v32, v32
    v_exp_f32 v33, v33
    v_exp_f32 v34, v34
    v_exp_f32 v35, v35
    v_cvt_pk_bf16_f32 v16, v28, v29
    v_cvt_pk_bf16_f32 v17, v30, v31
    v_cvt_pk_bf16_f32 v18, v32, v33
    v_cvt_pk_bf16_f32 v19, v34, v35
    v_mfma_f32_32x32x16_bf16 v[20:35], v[52:55], v[104:107], 0
    v_exp_f32 v36, v36
    v_exp_f32 v37, v37
    v_exp_f32 v38, v38
    v_mfma_f32_32x32x8_bf16 v[20:35], v[64:65], v[108:109], v[20:35]
    v_exp_f32 v39, v39
    v_exp_f32 v40, v40
    v_exp_f32 v41, v41
    v_exp_f32 v42, v42
    v_exp_f32 v43, v43
    v_cvt_pk_bf16_f32 v12, v36, v37
    v_cvt_pk_bf16_f32 v13, v38, v39
    v_cvt_pk_bf16_f32 v14, v40, v41
    v_cvt_pk_bf16_f32 v15, v42, v43
    v_mfma_f32_32x32x16_bf16 v[160:175], v[60:63], v[16:19], v[160:175]
    v_exp_f32 v44, v44
    v_exp_f32 v45, v45
    v_exp_f32 v46, v46
    v_mfma_f32_32x32x16_bf16 v[176:191], v[56:59], v[12:15], 0
    v_exp_f32 v47, v47
    v_exp_f32 v48, v48
    v_exp_f32 v49, v49
    v_exp_f32 v50, v50
    v_exp_f32 v51, v51
    v_cvt_pk_bf16_f32 v16, v44, v45
    v_cvt_pk_bf16_f32 v17, v46, v47
    v_cvt_pk_bf16_f32 v18, v48, v49
    v_cvt_pk_bf16_f32 v19, v50, v51
    v_mfma_f32_32x32x16_bf16 v[36:51], v[52:55], v[110:113], 0
    v_exp_f32 v20, v20
    v_exp_f32 v21, v21
    v_exp_f32 v22, v22
    v_mfma_f32_32x32x8_bf16 v[36:51], v[64:65], v[114:115], v[36:51]
    v_exp_f32 v23, v23
    v_exp_f32 v24, v24
    v_exp_f32 v25, v25
    v_exp_f32 v26, v26
    v_exp_f32 v27, v27
    v_cvt_pk_bf16_f32 v12, v20, v21
    v_cvt_pk_bf16_f32 v13, v22, v23
    v_cvt_pk_bf16_f32 v14, v24, v25
    v_cvt_pk_bf16_f32 v15, v26, v27
    v_mfma_f32_32x32x16_bf16 v[176:191], v[60:63], v[16:19], v[176:191]
    v_exp_f32 v28, v28
    v_exp_f32 v29, v29
    v_exp_f32 v30, v30
    v_mfma_f32_32x32x16_bf16 v[192:207], v[56:59], v[12:15], 0
    v_exp_f32 v31, v31
    v_exp_f32 v32, v32
    v_exp_f32 v33, v33
    v_exp_f32 v34, v34
    v_exp_f32 v35, v35
    v_cvt_pk_bf16_f32 v16, v28, v29
    v_cvt_pk_bf16_f32 v17, v30, v31
    v_cvt_pk_bf16_f32 v18, v32, v33
    v_cvt_pk_bf16_f32 v19, v34, v35
    v_mfma_f32_32x32x16_bf16 v[20:35], v[52:55], v[116:119], 0
    v_exp_f32 v36, v36
    v_exp_f32 v37, v37
    v_exp_f32 v38, v38
    v_mfma_f32_32x32x8_bf16 v[20:35], v[64:65], v[120:121], v[20:35]
    v_exp_f32 v39, v39
    v_exp_f32 v40, v40
    v_exp_f32 v41, v41
    v_exp_f32 v42, v42
    v_exp_f32 v43, v43
    v_cvt_pk_bf16_f32 v12, v36, v37
    v_cvt_pk_bf16_f32 v13, v38, v39
    v_cvt_pk_bf16_f32 v14, v40, v41
    v_cvt_pk_bf16_f32 v15, v42, v43
    v_mfma_f32_32x32x16_bf16 v[192:207], v[60:63], v[16:19], v[192:207]
    v_exp_f32 v44, v44
    v_exp_f32 v45, v45
    v_exp_f32 v46, v46
    v_mfma_f32_32x32x16_bf16 v[208:223], v[56:59], v[12:15], 0
    v_exp_f32 v47, v47
    v_exp_f32 v48, v48
    v_exp_f32 v49, v49
    v_exp_f32 v50, v50
    v_exp_f32 v51, v51
    v_cvt_pk_bf16_f32 v16, v44, v45
    v_cvt_pk_bf16_f32 v17, v46, v47
    v_cvt_pk_bf16_f32 v18, v48, v49
    v_cvt_pk_bf16_f32 v19, v50, v51
    v_mfma_f32_32x32x16_bf16 v[36:51], v[52:55], v[122:125], 0
    v_exp_f32 v20, v20
    v_exp_f32 v21, v21
    v_exp_f32 v22, v22
    v_mfma_f32_32x32x8_bf16 v[36:51], v[64:65], v[126:127], v[36:51]
    v_exp_f32 v23, v23
    v_exp_f32 v24, v24
    v_exp_f32 v25, v25
    v_exp_f32 v26, v26
    v_exp_f32 v27, v27
    v_cvt_pk_bf16_f32 v12, v20, v21
    v_cvt_pk_bf16_f32 v13, v22, v23
    v_cvt_pk_bf16_f32 v14, v24, v25
    v_cvt_pk_bf16_f32 v15, v26, v27
    v_mfma_f32_32x32x16_bf16 v[208:223], v[60:63], v[16:19], v[208:223]
    v_exp_f32 v28, v28
    v_exp_f32 v29, v29
    v_exp_f32 v30, v30
    v_mfma_f32_32x32x16_bf16 v[224:239], v[56:59], v[12:15], 0
    v_exp_f32 v31, v31
    v_exp_f32 v32, v32
    v_exp_f32 v33, v33
    v_exp_f32 v34, v34
    v_exp_f32 v35, v35
    v_cvt_pk_bf16_f32 v16, v28, v29
    v_cvt_pk_bf16_f32 v17, v30, v31
    v_cvt_pk_bf16_f32 v18, v32, v33
    v_cvt_pk_bf16_f32 v19, v34, v35
    s_waitcnt vmcnt(2)
    v_mfma_f32_32x32x16_bf16 v[20:35], v[66:69], v[80:83], 0
    s_setprio 3
    buffer_load_dwordx4 v[52:55], v7, s[16:19], s91 offen sc1
    buffer_load_dwordx2 v[64:65], v5, s[16:19], s91 offen offset:3072 sc1
    s_setprio 0
    v_exp_f32 v36, v36
    v_exp_f32 v37, v37
    v_exp_f32 v38, v38
    v_mfma_f32_32x32x8_bf16 v[20:35], v[78:79], v[84:85], v[20:35]
    v_exp_f32 v39, v39
    v_exp_f32 v40, v40
    v_exp_f32 v41, v41
    v_exp_f32 v42, v42
    v_exp_f32 v43, v43
    v_cvt_pk_bf16_f32 v12, v36, v37
    v_cvt_pk_bf16_f32 v13, v38, v39
    v_cvt_pk_bf16_f32 v14, v40, v41
    v_cvt_pk_bf16_f32 v15, v42, v43
    v_mfma_f32_32x32x16_bf16 v[224:239], v[60:63], v[16:19], v[224:239]
    v_exp_f32 v44, v44
    v_exp_f32 v45, v45
    v_exp_f32 v46, v46
    v_mfma_f32_32x32x16_bf16 v[240:255], v[56:59], v[12:15], 0
    v_exp_f32 v47, v47
    v_exp_f32 v48, v48
    v_exp_f32 v49, v49
    v_exp_f32 v50, v50
    v_exp_f32 v51, v51
    v_cvt_pk_bf16_f32 v16, v44, v45
    v_cvt_pk_bf16_f32 v17, v46, v47
    v_cvt_pk_bf16_f32 v18, v48, v49
    v_cvt_pk_bf16_f32 v19, v50, v51
    .p2align 3
L_att:
    v_mfma_f32_32x32x16_bf16 v[36:51], v[66:69], v[86:89], 0
    v_exp_f32 v20, v20
    v_exp_f32 v21, v21
    v_exp_f32 v22, v22
    v_mfma_f32_32x32x8_bf16 v[36:51], v[78:79], v[90:91], v[36:51]
    v_exp_f32 v23, v23
    v_exp_f32 v24, v24
    v_exp_f32 v25, v25
    v_exp_f32 v26, v26
    v_exp_f32 v27, v27
    v_cvt_pk_bf16_f32 v12, v20, v21
    v_cvt_pk_bf16_f32 v13, v22, v23
    v_cvt_pk_bf16_f32 v14, v24, v25
    v_cvt_pk_bf16_f32 v15, v26, v27
    v_mfma_f32_32x32x16_bf16 v[240:255], v[60:63], v[16:19], v[240:255]
    s_setprio 3
    buffer_load_dwordx4 v[56:59], v7, s[16:19], s91 offen offset:1024 sc1
    buffer_load_dwordx4 v[60:63], v7, s[16:19], s91 offen offset:2048 sc1
    s_setprio 0
    s_add_u32 s91, s91, 4096
    s_and_b32 s91, s91, 0xffff
    v_exp_f32 v28, v28
    v_exp_f32 v29, v29
    v_exp_f32 v30, v30
    s_waitcnt vmcnt(4)
    v_mfma_f32_32x32x16_bf16 v[128:143], v[70:73], v[12:15], v[128:143]
    v_exp_f32 v31, v31
    v_exp_f32 v32, v32
    v_exp_f32 v33, v33
    v_exp_f32 v34, v34
    v_exp_f32 v35, v35
    v_cvt_pk_bf16_f32 v16, v28, v29
    v_cvt_pk_bf16_f32 v17, v30, v31
    v_cvt_pk_bf16_f32 v18, v32, v33
    v_cvt_pk_bf16_f32 v19, v34, v35
    v_mfma_f32_32x32x16_bf16 v[20:35], v[66:69], v[92:95], 0
    v_exp_f32 v36, v36
    v_exp_f32 v37, v37
    v_exp_f32 v38, v38
    v_mfma_f32_32x32x8_bf16 v[20:35], v[78:79], v[96:97], v[20:35]
    v_exp_f32 v39, v39
    v_exp_f32 v40, v40
    v_exp_f32 v41, v41
    v_exp_f32 v42, v42
    v_exp_f32 v43, v43
    v_cvt_pk_bf16_f32 v12, v36, v37
    v_cvt_pk_bf16_f32 v13, v38, v39
    v_cvt_pk_bf16_f32 v14, v40, v41
    v_cvt_pk_bf16_f32 v15, v42, v43
    v_mfma_f32_32x32x16_bf16 v[128:143], v[74:77], v[16:19], v[128:143]
    v_exp_f32 v44, v44
    v_exp_f32 v45, v45
    v_exp_f32 v46, v46
    v_mfma_f32_32x32x16_bf16 v[144:159], v[70:73], v[12:15], v[144:159]
    v_exp_f32 v47, v47
    v_exp_f32 v48, v48
    v_exp_f32 v49, v49
    v_exp_f32 v50, v50
    v_exp_f32 v51, v51
    v_cvt_pk_bf16_f32 v16, v44, v45
    v_cvt_pk_bf16_f32 v17, v46, v47
    v_cvt_pk_bf16_f32 v18, v48, v49
    v_cvt_pk_bf16_f32 v19, v50, v51
    v_mfma_f32_32x32x16_bf16 v[36:51], v[66:69], v[98:101], 0
    v_exp_f32 v20, v20
    v_exp_f32 v21, v21
    v_exp_f32 v22, v22
    v_mfma_f32_32x32x8_bf16 v[36:51], v[78:79], v[102:103], v[36:51]
    v_exp_f32 v23, v23
    v_exp_f32 v24, v24
    v_exp_f32 v25, v25
    v_exp_f32 v26, v26
    v_exp_f32 v27, v27
    v_cvt_pk_bf16_f32 v12, v20, v21
    v_cvt_pk_bf16_f32 v13, v22, v23
    v_cvt_pk_bf16_f32 v14, v24, v25
    v_cvt_pk_bf16_f32 v15, v26, v27
    v_mfma_f32_32x32x16_bf16 v[144:159], v[74:77], v[16:19], v[144:159]
    v_exp_f32 v28, v28
    v_exp_f32 v29, v29
    v_exp_f32 v30, v30
    v_mfma_f32_32x32x16_bf16 v[160:175], v[70:73], v[12:15], v[160:175]
    v_exp_f32 v31, v31
    v_exp_f32 v32, v32
    v_exp_f32 v33, v33
    v_exp_f32 v34, v34
    v_exp_f32 v35, v35
    v_cvt_pk_bf16_f32 v16, v28, v29
    v_cvt_pk_bf16_f32 v17, v30, v31
    v_cvt_pk_bf16_f32 v18, v32, v33
    v_cvt_pk_bf16_f32 v19, v34, v35
    v_mfma_f32_32x32x16_bf16 v[20:35], v[66:69], v[104:107], 0
    v_exp_f32 v36, v36
    v_exp_f32 v37, v37
    v_exp_f32 v38, v38
    v_mfma_f32_32x32x8_bf16 v[20:35], v[78:79], v[108:109], v[20:35]
    v_exp_f32 v39, v39
    v_exp_f32 v40, v40
    v_exp_f32 v41, v41
    v_exp_f32 v42, v42
    v_exp_f32 v43, v43
    v_cvt_pk_bf16_f32 v12, v36, v37
    v_cvt_pk_bf16_f32 v13, v38, v39
    v_cvt_pk_bf16_f32 v14, v40, v41
    v_cvt_pk_bf16_f32 v15, v42, v43
    v_mfma_f32_32x32x16_bf16 v[160:175], v[74:77], v[16:19], v[160:175]
    v_exp_f32 v44, v44
    v_exp_f32 v45, v45
    v_exp_f32 v46, v46
    v_mfma_f32_32x32x16_bf16 v[176:191], v[70:73], v[12:15], v[176:191]
    v_exp_f32 v47, v47
    v_exp_f32 v48, v48
    v_exp_f32 v49, v49
    v_exp_f32 v50, v50
    v_exp_f32 v51, v51
    v_cvt_pk_bf16_f32 v16, v44, v45
    v_cvt_pk_bf16_f32 v17, v46, v47
    v_cvt_pk_bf16_f32 v18, v48, v49
    v_cvt_pk_bf16_f32 v19, v50, v51
    v_mfma_f32_32x32x16_bf16 v[36:51], v[66:69], v[110:113], 0
    v_exp_f32 v20, v20
    v_exp_f32 v21, v21
    v_exp_f32 v22, v22
    v_mfma_f32_32x32x8_bf16 v[36:51], v[78:79], v[114:115], v[36:51]
    v_exp_f32 v23, v23
    v_exp_f32 v24, v24
    v_exp_f32 v25, v25
    v_exp_f32 v26, v26
    v_exp_f32 v27, v27
    v_cvt_pk_bf16_f32 v12, v20, v21
    v_cvt_pk_bf16_f32 v13, v22, v23
    v_cvt_pk_bf16_f32 v14, v24, v25
    v_cvt_pk_bf16_f32 v15, v26, v27
    v_mfma_f32_32x32x16_bf16 v[176:191], v[74:77], v[16:19], v[176:191]
    v_exp_f32 v28, v28
    v_exp_f32 v29, v29
    v_exp_f32 v30, v30
    v_mfma_f32_32x32x16_bf16 v[192:207], v[70:73], v[12:15], v[192:207]
    v_exp_f32 v31, v31
    v_exp_f32 v32, v32
    v_exp_f32 v33, v33
    v_exp_f32 v34, v34
    v_exp_f32 v35, v35
    v_cvt_pk_bf16_f32 v16, v28, v29
    v_cvt_pk_bf16_f32 v17, v30, v31
    v_cvt_pk_bf16_f32 v18, v32, v33
    v_cvt_pk_bf16_f32 v19, v34, v35
    v_mfma_f32_32x32x16_bf16 v[20:35], v[66:69], v[116:119], 0
    v_exp_f32 v36, v36
    v_exp_f32 v37, v37
    v_exp_f32 v38, v38
    v_mfma_f32_32x32x8_bf16 v[20:35], v[78:79], v[120:121], v[20:35]
    v_exp_f32 v39, v39
    v_exp_f32 v40, v40
    v_exp_f32 v41, v41
    v_exp_f32 v42, v42
    v_exp_f32 v43, v43
    v_cvt_pk_bf16_f32 v12, v36, v37
    v_cvt_pk_bf16_f32 v13, v38, v39
    v_cvt_pk_bf16_f32 v14, v40, v41
    v_cvt_pk_bf16_f32 v15, v42, v43
    v_mfma_f32_32x32x16_bf16 v[192:207], v[74:77], v[16:19], v[192:207]
    v_exp_f32 v44, v44
    v_exp_f32 v45, v45
    v_exp_f32 v46, v46
    v_mfma_f32_32x32x16_bf16 v[208:223], v[70:73], v[12:15], v[208:223]
    v_exp_f32 v47, v47
    v_exp_f32 v48, v48
    v_exp_f32 v49, v49
    v_exp_f32 v50, v50
    v_exp_f32 v51, v51
    v_cvt_pk_bf16_f32 v16, v44, v45
    v_cvt_pk_bf16_f32 v17, v46, v47
    v_cvt_pk_bf16_f32 v18, v48, v49
    v_cvt_pk_bf16_f32 v19, v50, v51
    v_mfma_f32_32x32x16_bf16 v[36:51], v[66:69], v[122:125], 0
    v_exp_f32 v20, v20
    v_exp_f32 v21, v21
    v_exp_f32 v22, v22
    v_mfma_f32_32x32x8_bf16 v[36:51], v[78:79], v[126:127], v[36:51]
    v_exp_f32 v23, v23
    v_exp_f32 v24, v24
    v_exp_f32 v25, v25
    v_exp_f32 v26, v26
    v_exp_f32 v27, v27
    v_cvt_pk_bf16_f32 v12, v20, v21
    v_cvt_pk_bf16_f32 v13, v22, v23
    v_cvt_pk_bf16_f32 v14, v24, v25
    v_cvt_pk_bf16_f32 v15, v26, v27
    v_mfma_f32_32x32x16_bf16 v[208:223], v[74:77], v[16:19], v[208:223]
    v_exp_f32 v28, v28
    v_exp_f32 v29, v29
    v_exp_f32 v30, v30
    v_mfma_f32_32x32x16_bf16 v[224:239], v[70:73], v[12:15], v[224:239]
    v_exp_f32 v31, v31
    v_exp_f32 v32, v32
    v_exp_f32 v33, v33
    v_exp_f32 v34, v34
    v_exp_f32 v35, v35
    v_cvt_pk_bf16_f32 v16, v28, v29
    v_cvt_pk_bf16_f32 v17, v30, v31
    v_cvt_pk_bf16_f32 v18, v32, v33
    v_cvt_pk_bf16_f32 v19, v34, v35
    s_waitcnt vmcnt(2)
    v_mfma_f32_32x32x16_bf16 v[20:35], v[52:55], v[80:83], 0
    s_setprio 3
    buffer_load_dwordx4 v[66:69], v7, s[16:19], s91 offen sc1
    buffer_load_dwordx2 v[78:79], v5, s[16:19], s91 offen offset:3072 sc1
    s_setprio 0
    v_exp_f32 v36, v36
    v_exp_f32 v37, v37
    v_exp_f32 v38, v38
    v_mfma_f32_32x32x8_bf16 v[20:35], v[64:65], v[84:85], v[20:35]
    v_exp_f32 v39, v39
    v_exp_f32 v40, v40
    v_exp_f32 v41, v41
    v_exp_f32 v42, v42
    v_exp_f32 v43, v43
    v_cvt_pk_bf16_f32 v12, v36, v37
    v_cvt_pk_bf16_f32 v13, v38, v39
    v_cvt_pk_bf16_f32 v14, v40, v41
    v_cvt_pk_bf16_f32 v15, v42, v43
    v_mfma_f32_32x32x16_bf16 v[224:239], v[74:77], v[16:19], v[224:239]
    v_exp_f32 v44, v44
    v_exp_f32 v45, v45
    v_exp_f32 v46, v46
    v_mfma_f32_32x32x16_bf16 v[240:255], v[70:73], v[12:15], v[240:255]
    v_exp_f32 v47, v47
    v_exp_f32 v48, v48
    v_exp_f32 v49, v49
    v_exp_f32 v50, v50
    v_exp_f32 v51, v51
    v_cvt_pk_bf16_f32 v16, v44, v45
    v_cvt_pk_bf16_f32 v17, v46, v47
    v_cvt_pk_bf16_f32 v18, v48, v49
    v_cvt_pk_bf16_f32 v19, v50, v51
    v_mfma_f32_32x32x16_bf16 v[36:51], v[52:55], v[86:89], 0
    v_exp_f32 v20, v20
    v_exp_f32 v21, v21
    v_exp_f32 v22, v22
    v_mfma_f32_32x32x8_bf16 v[36:51], v[64:65], v[90:91], v[36:51]
    v_exp_f32 v23, v23
    v_exp_f32 v24, v24
    v_exp_f32 v25, v25
    v_exp_f32 v26, v26
    v_exp_f32 v27, v27
    v_cvt_pk_bf16_f32 v12, v20, v21
    v_cvt_pk_bf16_f32 v13, v22, v23
    v_cvt_pk_bf16_f32 v14, v24, v25
    v_cvt_pk_bf16_f32 v15, v26, v27
    v_mfma_f32_32x32x16_bf16 v[240:255], v[74:77], v[16:19], v[240:255]
    s_setprio 3
    buffer_load_dwordx4 v[70:73], v7, s[16:19], s91 offen offset:1024 sc1
    buffer_load_dwordx4 v[74:77], v7, s[16:19], s91 offen offset:2048 sc1
    s_setprio 0
    s_add_u32 s91, s91, 4096
    s_and_b32 s91, s91, 0xffff
    v_exp_f32 v28, v28
    v_exp_f32 v29, v29
    v_exp_f32 v30, v30
    s_waitcnt vmcnt(4)
    v_mfma_f32_32x32x16_bf16 v[128:143], v[56:59], v[12:15], v[128:143]
    v_exp_f32 v31, v31
    v_exp_f32 v32, v32
    v_exp_f32 v33, v33
    v_exp_f32 v34, v34
    v_exp_f32 v35, v35
    v_cvt_pk_bf16_f32 v16, v28, v29
    v_cvt_pk_bf16_f32 v17, v30, v31
    v_cvt_pk_bf16_f32 v18, v32, v33
    v_cvt_pk_bf16_f32 v19, v34, v35
    v_mfma_f32_32x32x16_bf16 v[20:35], v[52:55], v[92:95], 0
    v_exp_f32 v36, v36
    v_exp_f32 v37, v37
    v_exp_f32 v38, v38
    v_mfma_f32_32x32x8_bf16 v[20:35], v[64:65], v[96:97], v[20:35]
    v_exp_f32 v39, v39
    v_exp_f32 v40, v40
    v_exp_f32 v41, v41
    v_exp_f32 v42, v42
    v_exp_f32 v43, v43
    v_cvt_pk_bf16_f32 v12, v36, v37
    v_cvt_pk_bf16_f32 v13, v38, v39
    v_cvt_pk_bf16_f32 v14, v40, v41
    v_cvt_pk_bf16_f32 v15, v42, v43
    v_mfma_f32_32x32x16_bf16 v[128:143], v[60:63], v[16:19], v[128:143]
    v_exp_f32 v44, v44
    v_exp_f32 v45, v45
    v_exp_f32 v46, v46
    v_mfma_f32_32x32x16_bf16 v[144:159], v[56:59], v[12:15], v[144:159]
    v_exp_f32 v47, v47
    v_exp_f32 v48, v48
    v_exp_f32 v49, v49
    v_exp_f32 v50, v50
    v_exp_f32 v51, v51
    v_cvt_pk_bf16_f32 v16, v44, v45
    v_cvt_pk_bf16_f32 v17, v46, v47
    v_cvt_pk_bf16_f32 v18, v48, v49
    v_cvt_pk_bf16_f32 v19, v50, v51
    v_mfma_f32_32x32x16_bf16 v[36:51], v[52:55], v[98:101], 0
    v_exp_f32 v20, v20
    v_exp_f32 v21, v21
    v_exp_f32 v22, v22
    v_mfma_f32_32x32x8_bf16 v[36:51], v[64:65], v[102:103], v[36:51]
    v_exp_f32 v23, v23
    v_exp_f32 v24, v24
    v_exp_f32 v25, v25
    v_exp_f32 v26, v26
    v_exp_f32 v27, v27
    v_cvt_pk_bf16_f32 v12, v20, v21
    v_cvt_pk_bf16_f32 v13, v22, v23
    v_cvt_pk_bf16_f32 v14, v24, v25
    v_cvt_pk_bf16_f32 v15, v26, v27
    v_mfma_f32_32x32x16_bf16 v[144:159], v[60:63], v[16:19], v[144:159]
    v_exp_f32 v28, v28
    v_exp_f32 v29, v29
    v_exp_f32 v30, v30
    v_mfma_f32_32x32x16_bf16 v[160:175], v[56:59], v[12:15], v[160:175]
    v_exp_f32 v31, v31
    v_exp_f32 v32, v32
    v_exp_f32 v33, v33
    v_exp_f32 v34, v34
    v_exp_f32 v35, v35
    v_cvt_pk_bf16_f32 v16, v28, v29
    v_cvt_pk_bf16_f32 v17, v30, v31
    v_cvt_pk_bf16_f32 v18, v32, v33
    v_cvt_pk_bf16_f32 v19, v34, v35
    v_mfma_f32_32x32x16_bf16 v[20:35], v[52:55], v[104:107], 0
    v_exp_f32 v36, v36
    v_exp_f32 v37, v37
    v_exp_f32 v38, v38
    v_mfma_f32_32x32x8_bf16 v[20:35], v[64:65], v[108:109], v[20:35]
    v_exp_f32 v39, v39
    v_exp_f32 v40, v40
    v_exp_f32 v41, v41
    v_exp_f32 v42, v42
    v_exp_f32 v43, v43
    v_cvt_pk_bf16_f32 v12, v36, v37
    v_cvt_pk_bf16_f32 v13, v38, v39
    v_cvt_pk_bf16_f32 v14, v40, v41
    v_cvt_pk_bf16_f32 v15, v42, v43
    v_mfma_f32_32x32x16_bf16 v[160:175], v[60:63], v[16:19], v[160:175]
    v_exp_f32 v44, v44
    v_exp_f32 v45, v45
    v_exp_f32 v46, v46
    v_mfma_f32_32x32x16_bf16 v[176:191], v[56:59], v[12:15], v[176:191]
    v_exp_f32 v47, v47
    v_exp_f32 v48, v48
    v_exp_f32 v49, v49
    v_exp_f32 v50, v50
    v_exp_f32 v51, v51
    v_cvt_pk_bf16_f32 v16, v44, v45
    v_cvt_pk_bf16_f32 v17, v46, v47
    v_cvt_pk_bf16_f32 v18, v48, v49
    v_cvt_pk_bf16_f32 v19, v50, v51
    v_mfma_f32_32x32x16_bf16 v[36:51], v[52:55], v[110:113], 0
    v_exp_f32 v20, v20
    v_exp_f32 v21, v21
    v_exp_f32 v22, v22
    v_mfma_f32_32x32x8_bf16 v[36:51], v[64:65], v[114:115], v[36:51]
    v_exp_f32 v23, v23
    v_exp_f32 v24, v24
    v_exp_f32 v25, v25
    v_exp_f32 v26, v26
    v_exp_f32 v27, v27
    v_cvt_pk_bf16_f32 v12, v20, v21
    v_cvt_pk_bf16_f32 v13, v22, v23
    v_cvt_pk_bf16_f32 v14, v24, v25
    v_cvt_pk_bf16_f32 v15, v26, v27
    v_mfma_f32_32x32x16_bf16 v[176:191], v[60:63], v[16:19], v[176:191]
    v_exp_f32 v28, v28
    v_exp_f32 v29, v29
    v_exp_f32 v30, v30
    v_mfma_f32_32x32x16_bf16 v[192:207], v[56:59], v[12:15], v[192:207]
    v_exp_f32 v31, v31
    v_exp_f32 v32, v32
    v_exp_f32 v33, v33
    v_exp_f32 v34, v34
    v_exp_f32 v35, v35
    v_cvt_pk_bf16_f32 v16, v28, v29
    v_cvt_pk_bf16_f32 v17, v30, v31
    v_cvt_pk_bf16_f32 v18, v32, v33
    v_cvt_pk_bf16_f32 v19, v34, v35
    v_mfma_f32_32x32x16_bf16 v[20:35], v[52:55], v[116:119], 0
    v_exp_f32 v36, v36
    v_exp_f32 v37, v37
    v_exp_f32 v38, v38
    v_mfma_f32_32x32x8_bf16 v[20:35], v[64:65], v[120:121], v[20:35]
    v_exp_f32 v39, v39
    v_exp_f32 v40, v40
    v_exp_f32 v41, v41
    v_exp_f32 v42, v42
    v_exp_f32 v43, v43
    v_cvt_pk_bf16_f32 v12, v36, v37
    v_cvt_pk_bf16_f32 v13, v38, v39
    v_cvt_pk_bf16_f32 v14, v40, v41
    v_cvt_pk_bf16_f32 v15, v42, v43
    v_mfma_f32_32x32x16_bf16 v[192:207], v[60:63], v[16:19], v[192:207]
    v_exp_f32 v44, v44
    v_exp_f32 v45, v45
    v_exp_f32 v46, v46
    v_mfma_f32_32x32x16_bf16 v[208:223], v[56:59], v[12:15], v[208:223]
    v_exp_f32 v47, v47
    v_exp_f32 v48, v48
    v_exp_f32 v49, v49
    v_exp_f32 v50, v50
    v_exp_f32 v51, v51
    v_cvt_pk_bf16_f32 v16, v44, v45
    v_cvt_pk_bf16_f32 v17, v46, v47
    v_cvt_pk_bf16_f32 v18, v48, v49
    v_cvt_pk_bf16_f32 v19, v50, v51
    v_mfma_f32_32x32x16_bf16 v[36:51], v[52:55], v[122:125], 0
    v_exp_f32 v20, v20
    v_exp_f32 v21, v21
    v_exp_f32 v22, v22
    v_mfma_f32_32x32x8_bf16 v[36:51], v[64:65], v[126:127], v[36:51]
    v_exp_f32 v23, v23
    v_exp_f32 v24, v24
    v_exp_f32 v25, v25
    v_exp_f32 v26, v26
    v_exp_f32 v27, v27
    v_cvt_pk_bf16_f32 v12, v20, v21
    v_cvt_pk_bf16_f32 v13, v22, v23
    v_cvt_pk_bf16_f32 v14, v24, v25
    v_cvt_pk_bf16_f32 v15, v26, v27
    v_mfma_f32_32x32x16_bf16 v[208:223], v[60:63], v[16:19], v[208:223]
    v_exp_f32 v28, v28
    v_exp_f32 v29, v29
    v_exp_f32 v30, v30
    v_mfma_f32_32x32x16_bf16 v[224:239], v[56:59], v[12:15], v[224:239]
    v_exp_f32 v31, v31
    v_exp_f32 v32, v32
    v_exp_f32 v33, v33
    v_exp_f32 v34, v34
    v_exp_f32 v35, v35
    v_cvt_pk_bf16_f32 v16, v28, v29
    v_cvt_pk_bf16_f32 v17, v30, v31
    v_cvt_pk_bf16_f32 v18, v32, v33
    v_cvt_pk_bf16_f32 v19, v34, v35
    s_waitcnt vmcnt(2)
    v_mfma_f32_32x32x16_bf16 v[20:35], v[66:69], v[80:83], 0
    s_setprio 3
    buffer_load_dwordx4 v[52:55], v7, s[16:19], s91 offen sc1
    buffer_load_dwordx2 v[64:65], v5, s[16:19], s91 offen offset:3072 sc1
    s_setprio 0
    v_exp_f32 v36, v36
    v_exp_f32 v37, v37
    v_exp_f32 v38, v38
    v_mfma_f32_32x32x8_bf16 v[20:35], v[78:79], v[84:85], v[20:35]
    v_exp_f32 v39, v39
    v_exp_f32 v40, v40
    v_exp_f32 v41, v41
    v_exp_f32 v42, v42
    v_exp_f32 v43, v43
    v_cvt_pk_bf16_f32 v12, v36, v37
    v_cvt_pk_bf16_f32 v13, v38, v39
    v_cvt_pk_bf16_f32 v14, v40, v41
    v_cvt_pk_bf16_f32 v15, v42, v43
    v_mfma_f32_32x32x16_bf16 v[224:239], v[60:63], v[16:19], v[224:239]
    v_exp_f32 v44, v44
    v_exp_f32 v45, v45
    v_exp_f32 v46, v46
    v_mfma_f32_32x32x16_bf16 v[240:255], v[56:59], v[12:15], v[240:255]
    v_exp_f32 v47, v47
    v_exp_f32 v48, v48
    v_exp_f32 v49, v49
    v_exp_f32 v50, v50
    v_exp_f32 v51, v51
    v_cvt_pk_bf16_f32 v16, v44, v45
    v_cvt_pk_bf16_f32 v17, v46, v47
    v_cvt_pk_bf16_f32 v18, v48, v49
    v_cvt_pk_bf16_f32 v19, v50, v51
    s_add_u32 s92, s92, 1
    s_cmp_lt_u32 s92, 8
    s_cbranch_scc1 L_att
    v_mfma_f32_32x32x16_bf16 v[36:51], v[66:69], v[86:89], 0
    v_exp_f32 v20, v20
    v_exp_f32 v21, v21
    v_exp_f32 v22, v22
    v_mfma_f32_32x32x8_bf16 v[36:51], v[78:79], v[90:91], v[36:51]
    v_exp_f32 v23, v23
    v_exp_f32 v24, v24
    v_exp_f32 v25, v25
    v_exp_f32 v26, v26
    v_exp_f32 v27, v27
    v_cvt_pk_bf16_f32 v12, v20, v21
    v_cvt_pk_bf16_f32 v13, v22, v23
    v_cvt_pk_bf16_f32 v14, v24, v25
    v_cvt_pk_bf16_f32 v15, v26, v27
    v_mfma_f32_32x32x16_bf16 v[240:255], v[60:63], v[16:19], v[240:255]
    v_exp_f32 v28, v28
    v_exp_f32 v29, v29
    v_exp_f32 v30, v30
    s_waitcnt vmcnt(2)
    v_mfma_f32_32x32x16_bf16 v[128:143], v[70:73], v[12:15], v[128:143]
    v_exp_f32 v31, v31
    v_exp_f32 v32, v32
    v_exp_f32 v33, v33
    v_exp_f32 v34, v34
    v_exp_f32 v35, v35
    v_cvt_pk_bf16_f32 v16, v28, v29
    v_cvt_pk_bf16_f32 v17, v30, v31
    v_cvt_pk_bf16_f32 v18, v32, v33
    v_cvt_pk_bf16_f32 v19, v34, v35
    v_mfma_f32_32x32x16_bf16 v[20:35], v[66:69], v[92:95], 0
    v_exp_f32 v36, v36
    v_exp_f32 v37, v37
    v_exp_f32 v38, v38
    v_mfma_f32_32x32x8_bf16 v[20:35], v[78:79], v[96:97], v[20:35]
    v_exp_f32 v39, v39
    v_exp_f32 v40, v40
    v_exp_f32 v41, v41
    v_exp_f32 v42, v42
    v_exp_f32 v43, v43
    v_cvt_pk_bf16_f32 v12, v36, v37
    v_cvt_pk_bf16_f32 v13, v38, v39
    v_cvt_pk_bf16_f32 v14, v40, v41
    v_cvt_pk_bf16_f32 v15, v42, v43
    v_mfma_f32_32x32x16_bf16 v[128:143], v[74:77], v[16:19], v[128:143]
    v_exp_f32 v44, v44
    v_exp_f32 v45, v45
    v_exp_f32 v46, v46
    v_mfma_f32_32x32x16_bf16 v[144:159], v[70:73], v[12:15], v[144:159]
    v_exp_f32 v47, v47
    v_exp_f32 v48, v48
    v_exp_f32 v49, v49
    v_exp_f32 v50, v50
    v_exp_f32 v51, v51
    v_cvt_pk_bf16_f32 v16, v44, v45
    v_cvt_pk_bf16_f32 v17, v46, v47
    v_cvt_pk_bf16_f32 v18, v48, v49
    v_cvt_pk_bf16_f32 v19, v50, v51
    v_mfma_f32_32x32x16_bf16 v[36:51], v[66:69], v[98:101], 0
    v_exp_f32 v20, v20
    v_exp_f32 v21, v21
    v_exp_f32 v22, v22
    v_mfma_f32_32x32x8_bf16 v[36:51], v[78:79], v[102:103], v[36:51]
    v_exp_f32 v23, v23
    v_exp_f32 v24, v24
    v_exp_f32 v25, v25
    v_exp_f32 v26, v26
    v_exp_f32 v27, v27
    v_cvt_pk_bf16_f32 v12, v20, v21
    v_cvt_pk_bf16_f32 v13, v22, v23
    v_cvt_pk_bf16_f32 v14, v24, v25
    v_cvt_pk_bf16_f32 v15, v26, v27
    v_mfma_f32_32x32x16_bf16 v[144:159], v[74:77], v[16:19], v[144:159]
    v_exp_f32 v28, v28
    v_exp_f32 v29, v29
    v_exp_f32 v30, v30
    v_mfma_f32_32x32x16_bf16 v[160:175], v[70:73], v[12:15], v[160:175]
    v_exp_f32 v31, v31
    v_exp_f32 v32, v32
    v_exp_f32 v33, v33
    v_exp_f32 v34, v34
    v_exp_f32 v35, v35
    v_cvt_pk_bf16_f32 v16, v28, v29
    v_cvt_pk_bf16_f32 v17, v30, v31
    v_cvt_pk_bf16_f32 v18, v32, v33
    v_cvt_pk_bf16_f32 v19, v34, v35
    v_mfma_f32_32x32x16_bf16 v[20:35], v[66:69], v[104:107], 0
    v_exp_f32 v36, v36
    v_exp_f32 v37, v37
    v_exp_f32 v38, v38
    v_mfma_f32_32x32x8_bf16 v[20:35], v[78:79], v[108:109], v[20:35]
    v_exp_f32 v39, v39
    v_exp_f32 v40, v40
    v_exp_f32 v41, v41
    v_exp_f32 v42, v42
    v_exp_f32 v43, v43
    v_cvt_pk_bf16_f32 v12, v36, v37
    v_cvt_pk_bf16_f32 v13, v38, v39
    v_cvt_pk_bf16_f32 v14, v40, v41
    v_cvt_pk_bf16_f32 v15, v42, v43
    v_mfma_f32_32x32x16_bf16 v[160:175], v[74:77], v[16:19], v[160:175]
    v_exp_f32 v44, v44
    v_exp_f32 v45, v45
    v_exp_f32 v46, v46
    v_mfma_f32_32x32x16_bf16 v[176:191], v[70:73], v[12:15], v[176:191]
    v_exp_f32 v47, v47
    v_exp_f32 v48, v48
    v_exp_f32 v49, v49
    v_exp_f32 v50, v50
    v_exp_f32 v51, v51
    v_cvt_pk_bf16_f32 v16, v44, v45
    v_cvt_pk_bf16_f32 v17, v46, v47
    v_cvt_pk_bf16_f32 v18, v48, v49
    v_cvt_pk_bf16_f32 v19, v50, v51
    v_mfma_f32_32x32x16_bf16 v[36:51], v[66:69], v[110:113], 0
    v_exp_f32 v20, v20
    v_exp_f32 v21, v21
    v_exp_f32 v22, v22
    v_mfma_f32_32x32x8_bf16 v[36:51], v[78:79], v[114:115], v[36:51]
    v_exp_f32 v23, v23
    v_exp_f32 v24, v24
    v_exp_f32 v25, v25
    v_exp_f32 v26, v26
    v_exp_f32 v27, v27
    v_cvt_pk_bf16_f32 v12, v20, v21
    v_cvt_pk_bf16_f32 v13, v22, v23
    v_cvt_pk_bf16_f32 v14, v24, v25
    v_cvt_pk_bf16_f32 v15, v26, v27
    v_mfma_f32_32x32x16_bf16 v[176:191], v[74:77], v[16:19], v[176:191]
    v_exp_f32 v28, v28
    v_exp_f32 v29, v29
    v_exp_f32 v30, v30
    v_mfma_f32_32x32x16_bf16 v[192:207], v[70:73], v[12:15], v[192:207]
    v_exp_f32 v31, v31
    v_exp_f32 v32, v32
    v_exp_f32 v33, v33
    v_exp_f32 v34, v34
    v_exp_f32 v35, v35
    v_cvt_pk_bf16_f32 v16, v28, v29
    v_cvt_pk_bf16_f32 v17, v30, v31
    v_cvt_pk_bf16_f32 v18, v32, v33
    v_cvt_pk_bf16_f32 v19, v34, v35
    v_mfma_f32_32x32x16_bf16 v[20:35], v[66:69], v[116:119], 0
    v_exp_f32 v36, v36
    v_exp_f32 v37, v37
    v_exp_f32 v38, v38
    v_mfma_f32_32x32x8_bf16 v[20:35], v[78:79], v[120:121], v[20:35]
    v_exp_f32 v39, v39
    v_exp_f32 v40, v40
    v_exp_f32 v41, v41
    v_exp_f32 v42, v42
    v_exp_f32 v43, v43
    v_cvt_pk_bf16_f32 v12, v36, v37
    v_cvt_pk_bf16_f32 v13, v38, v39
    v_cvt_pk_bf16_f32 v14, v40, v41
    v_cvt_pk_bf16_f32 v15, v42, v43
    v_mfma_f32_32x32x16_bf16 v[192:207], v[74:77], v[16:19], v[192:207]
    v_exp_f32 v44, v44
    v_exp_f32 v45, v45
    v_exp_f32 v46, v46
    v_mfma_f32_32x32x16_bf16 v[208:223], v[70:73], v[12:15], v[208:223]
    v_exp_f32 v47, v47
    v_exp_f32 v48, v48
    v_exp_f32 v49, v49
    v_exp_f32 v50, v50
    v_exp_f32 v51, v51
    v_cvt_pk_bf16_f32 v16, v44, v45
    v_cvt_pk_bf16_f32 v17, v46, v47
    v_cvt_pk_bf16_f32 v18, v48, v49
    v_cvt_pk_bf16_f32 v19, v50, v51
    v_mfma_f32_32x32x16_bf16 v[36:51], v[66:69], v[122:125], 0
    v_exp_f32 v20, v20
    v_exp_f32 v21, v21
    v_exp_f32 v22, v22
    v_mfma_f32_32x32x8_bf16 v[36:51], v[78:79], v[126:127], v[36:51]
    v_exp_f32 v23, v23
    v_exp_f32 v24, v24
    v_exp_f32 v25, v25
    v_exp_f32 v26, v26
    v_exp_f32 v27, v27
    v_cvt_pk_bf16_f32 v12, v20, v21
    v_cvt_pk_bf16_f32 v13, v22, v23
    v_cvt_pk_bf16_f32 v14, v24, v25
    v_cvt_pk_bf16_f32 v15, v26, v27
    v_mfma_f32_32x32x16_bf16 v[208:223], v[74:77], v[16:19], v[208:223]
    v_exp_f32 v28, v28
    v_exp_f32 v29, v29
    v_exp_f32 v30, v30
    v_mfma_f32_32x32x16_bf16 v[224:239], v[70:73], v[12:15], v[224:239]
    v_exp_f32 v31, v31
    v_exp_f32 v32, v32
    v_exp_f32 v33, v33
    v_exp_f32 v34, v34
    v_exp_f32 v35, v35
    v_cvt_pk_bf16_f32 v16, v28, v29
    v_cvt_pk_bf16_f32 v17, v30, v31
    v_cvt_pk_bf16_f32 v18, v32, v33
    v_cvt_pk_bf16_f32 v19, v34, v35
    v_exp_f32 v36, v36
    v_exp_f32 v37, v37
    v_exp_f32 v38, v38
    v_exp_f32 v39, v39
    v_exp_f32 v40, v40
    v_exp_f32 v41, v41
    v_exp_f32 v42, v42
    v_exp_f32 v43, v43
    v_cvt_pk_bf16_f32 v12, v36, v37
    v_cvt_pk_bf16_f32 v13, v38, v39
    v_cvt_pk_bf16_f32 v14, v40, v41
    v_cvt_pk_bf16_f32 v15, v42, v43
    v_mfma_f32_32x32x16_bf16 v[224:239], v[74:77], v[16:19], v[224:239]
    v_exp_f32 v44, v44
    v_exp_f32 v45, v45
    v_exp_f32 v46, v46
    v_mfma_f32_32x32x16_bf16 v[240:255], v[70:73], v[12:15], v[240:255]
    v_exp_f32 v47, v47
    v_exp_f32 v48, v48
    v_exp_f32 v49, v49
    v_exp_f32 v50, v50
    v_exp_f32 v51, v51
    v_cvt_pk_bf16_f32 v16, v44, v45
    v_cvt_pk_bf16_f32 v17, v46, v47
    v_cvt_pk_bf16_f32 v18, v48, v49
    v_cvt_pk_bf16_f32 v19, v50, v51
    s_nop 1
    v_mfma_f32_32x32x16_bf16 v[240:255], v[74:77], v[16:19], v[240:255]
    s_mul_i32 s60, s52, 16384
    s_add_u32 s60, s60, 97792
    v_add_u32 v4, s60, v7
    v_lshlrev_b32 v5, 4, v2
    v_lshl_add_u32 v11, v2, 5, s60
L_attdone:
    s_barrier
    ds_write_b128 v4, v[160:163] offset:0
    ds_write_b128 v4, v[164:167] offset:1024
    ds_write_b128 v4, v[176:179] offset:2560
    ds_write_b128 v4, v[180:183] offset:3584
    ds_write_b128 v4, v[192:195] offset:5120
    ds_write_b128 v4, v[196:199] offset:6144
    ds_write_b128 v4, v[208:211] offset:7680
    ds_write_b128 v4, v[212:215] offset:8704
    ds_write_b128 v4, v[224:227] offset:10240
    ds_write_b128 v4, v[228:231] offset:11264
    ds_write_b128 v4, v[240:243] offset:12800
    ds_write_b128 v4, v[244:247] offset:13824
    v_mov_b32 v20, v136
    v_mov_b32 v21, v152
    v_mov_b32 v22, v168
    v_mov_b32 v23, v184
    v_mov_b32 v24, v200
    v_mov_b32 v25, v216
    v_mov_b32 v26, v232
    v_mov_b32 v27, v248
    s_mov_b32 exec_hi, 0
    ds_write_b128 v4, v[168:171] offset:2048
    ds_write_b128 v4, v[184:187] offset:4608
    ds_write_b128 v4, v[200:203] offset:7168
    ds_write_b128 v4, v[216:219] offset:9728
    ds_write_b128 v4, v[232:235] offset:12288
    ds_write_b128 v4, v[248:251] offset:14848
    s_mov_b32 exec_lo, 0
    s_mov_b32 exec_hi, -1
    ds_write_b128 v11, v[20:23] offset:15360
    ds_write_b128 v11, v[24:27] offset:15376
    s_mov_b64 exec, -1
    s_add_u32 s60, s52, 3
    s_and_b32 s60, s60, 3
    s_mul_i32 s60, s60, 16384
    s_add_u32 s60, s60, 97792
    v_add_u32 v12, s60, v7
    v_add_u32 v92, s60, v5
    v_lshl_add_u32 v100, v2, 5, s60
    s_add_u32 s60, s52, 2
    s_and_b32 s60, s60, 3
    s_mul_i32 s60, s60, 16384
    s_add_u32 s60, s60, 97792
    v_add_u32 v13, s60, v7
    v_add_u32 v93, s60, v5
    v_lshl_add_u32 v101, v2, 5, s60
    s_add_u32 s60, s52, 1
    s_and_b32 s60, s60, 3
    s_mul_i32 s60, s60, 16384
    s_add_u32 s60, s60, 97792
    v_add_u32 v14, s60, v7
    v_add_u32 v94, s60, v5
    v_lshl_add_u32 v102, v2, 5, s60
    s_mul_i32 s60, s53, 81920
    s_add_u32 s60, s60, 0x900000
    s_waitcnt vmcnt(0) lgkmcnt(0)
    s_barrier
    ds_read_b64 v[104:105], v11 offset:15360
    ds_read_b64 v[106:107], v100 offset:15368
    ds_read_b64 v[108:109], v101 offset:15376
    ds_read_b64 v[110:111], v102 offset:15384
    ds_read_b128 v[20:23], v12 offset:0
    ds_read_b128 v[24:27], v12 offset:1024
    ds_read_b128 v[28:31], v92 offset:2048
    ds_read_b128 v[44:47], v13 offset:5120
    ds_read_b128 v[48:51], v13 offset:6144
    ds_read_b128 v[52:55], v93 offset:7168
    ds_read_b128 v[68:71], v14 offset:10240
    ds_read_b128 v[72:75], v14 offset:11264
    ds_read_b128 v[76:79], v94 offset:12288
    s_waitcnt lgkmcnt(9)
    v_pk_add_f32 v[104:105], v[104:105], v[106:107]
    v_pk_add_f32 v[108:109], v[108:109], v[110:111]
    v_pk_add_f32 v[104:105], v[104:105], v[108:109]
    v_rcp_f32 v104, v104
    v_rcp_f32 v105, v105
    ds_read_b128 v[32:35], v12 offset:2560
    ds_read_b128 v[36:39], v12 offset:3584
    ds_read_b128 v[40:43], v92 offset:4608
    ds_read_b128 v[56:59], v13 offset:7680
    ds_read_b128 v[60:63], v13 offset:8704
    ds_read_b128 v[64:67], v93 offset:9728
    ds_read_b128 v[80:83], v14 offset:12800
    ds_read_b128 v[84:87], v14 offset:13824
    ds_read_b128 v[88:91], v94 offset:14848
    s_waitcnt lgkmcnt(9)
    v_pk_add_f32 v[20:21], v[20:21], v[44:45]
    v_pk_add_f32 v[128:129], v[128:129], v[68:69]
    v_pk_add_f32 v[22:23], v[22:23], v[46:47]
    v_pk_add_f32 v[130:131], v[130:131], v[70:71]
    v_pk_add_f32 v[24:25], v[24:25], v[48:49]
    v_pk_add_f32 v[132:133], v[132:133], v[72:73]
    v_pk_add_f32 v[26:27], v[26:27], v[50:51]
    v_pk_add_f32 v[134:135], v[134:135], v[74:75]
    v_pk_add_f32 v[28:29], v[28:29], v[52:53]
    v_pk_add_f32 v[136:137], v[136:137], v[76:77]
    v_pk_add_f32 v[30:31], v[30:31], v[54:55]
    v_pk_add_f32 v[138:139], v[138:139], v[78:79]
    v_pk_add_f32 v[128:129], v[128:129], v[20:21]
    v_pk_add_f32 v[130:131], v[130:131], v[22:23]
    v_pk_add_f32 v[132:133], v[132:133], v[24:25]
    v_pk_add_f32 v[134:135], v[134:135], v[26:27]
    v_pk_add_f32 v[136:137], v[136:137], v[28:29]
    v_pk_add_f32 v[138:139], v[138:139], v[30:31]
    v_pk_mul_f32 v[128:129], v[128:129], v[104:105] op_sel:[0,0] op_sel_hi:[1,0]
    v_pk_mul_f32 v[130:131], v[130:131], v[104:105] op_sel:[0,0] op_sel_hi:[1,0]
    v_pk_mul_f32 v[132:133], v[132:133], v[104:105] op_sel:[0,0] op_sel_hi:[1,0]
    v_pk_mul_f32 v[134:135], v[134:135], v[104:105] op_sel:[0,0] op_sel_hi:[1,0]
    v_pk_mul_f32 v[136:137], v[136:137], v[104:105] op_sel:[0,0] op_sel_hi:[1,0]
    v_pk_mul_f32 v[138:139], v[138:139], v[104:105] op_sel:[0,0] op_sel_hi:[1,0]
    v_cvt_pk_bf16_f32 v128, v128, v129
    v_cvt_pk_bf16_f32 v129, v130, v131
    v_cvt_pk_bf16_f32 v130, v132, v133
    v_cvt_pk_bf16_f32 v131, v134, v135
    buffer_store_dwordx4 v[128:131], v8, s[44:47], s60 offen sc1
    v_cvt_pk_bf16_f32 v96, v136, v137
    v_cvt_pk_bf16_f32 v97, v138, v139
    s_waitcnt lgkmcnt(0)
    s_barrier
    v_pk_add_f32 v[32:33], v[32:33], v[56:57]
    v_pk_add_f32 v[144:145], v[144:145], v[80:81]
    v_pk_add_f32 v[34:35], v[34:35], v[58:59]
    v_pk_add_f32 v[146:147], v[146:147], v[82:83]
    v_pk_add_f32 v[36:37], v[36:37], v[60:61]
    v_pk_add_f32 v[148:149], v[148:149], v[84:85]
    v_pk_add_f32 v[38:39], v[38:39], v[62:63]
    v_pk_add_f32 v[150:151], v[150:151], v[86:87]
    v_pk_add_f32 v[40:41], v[40:41], v[64:65]
    v_pk_add_f32 v[152:153], v[152:153], v[88:89]
    v_pk_add_f32 v[42:43], v[42:43], v[66:67]
    v_pk_add_f32 v[154:155], v[154:155], v[90:91]
    v_pk_add_f32 v[144:145], v[144:145], v[32:33]
    v_pk_add_f32 v[146:147], v[146:147], v[34:35]
    v_pk_add_f32 v[148:149], v[148:149], v[36:37]
    v_pk_add_f32 v[150:151], v[150:151], v[38:39]
    v_pk_add_f32 v[152:153], v[152:153], v[40:41]
    v_pk_add_f32 v[154:155], v[154:155], v[42:43]
    v_pk_mul_f32 v[144:145], v[144:145], v[104:105] op_sel:[0,1] op_sel_hi:[1,1]
    v_pk_mul_f32 v[146:147], v[146:147], v[104:105] op_sel:[0,1] op_sel_hi:[1,1]
    v_pk_mul_f32 v[148:149], v[148:149], v[104:105] op_sel:[0,1] op_sel_hi:[1,1]
    v_pk_mul_f32 v[150:151], v[150:151], v[104:105] op_sel:[0,1] op_sel_hi:[1,1]
    v_pk_mul_f32 v[152:153], v[152:153], v[104:105] op_sel:[0,1] op_sel_hi:[1,1]
    v_pk_mul_f32 v[154:155], v[154:155], v[104:105] op_sel:[0,1] op_sel_hi:[1,1]
    v_cvt_pk_bf16_f32 v144, v144, v145
    v_cvt_pk_bf16_f32 v145, v146, v147
    v_cvt_pk_bf16_f32 v146, v148, v149
    v_cvt_pk_bf16_f32 v147, v150, v151
    buffer_store_dwordx4 v[144:147], v9, s[44:47], s60 offen sc1
    v_cvt_pk_bf16_f32 v98, v152, v153
    v_cvt_pk_bf16_f32 v99, v154, v155
    s_mov_b32 exec_hi, 0
    buffer_store_dwordx4 v[96:99], v10, s[44:47], s60 offen sc1
    s_mov_b64 exec, -1
    s_barrier
    s_cmp_eq_u32 s52, 0
    s_cbranch_scc0 Lf_72
    s_lshl_b32 s60, s54, 2
    s_add_u32 s60, s60, 128
    s_lshl_b32 s61, s53, 11
    s_add_u32 s61, s61, s60
    s_add_u32 s61, s61, 0x30000
    v_lshlrev_b32 v16, 8, v1
    v_mov_b32 v17, 1
    s_mov_b64 exec, 0xff
    buffer_store_dword v17, v16, s[44:47], s61 offen sc1
    s_mov_b64 exec, -1
Lf_72:
    s_lshr_b32 s62, s52, 2
    s_mul_i32 s60, s62, 6
    s_bitcmp1_b32 s54, 0
    s_cselect_b32 s95, 3, s60
    s_mul_i32 s60, s62, 10
    s_add_u32 s60, s60, s95
    s_mul_i32 s60, s60, 5120
    v_add_u32 v25, s60, v7
    s_cmp_eq_u32 s95, 6
    s_cselect_b32 s61, -6, 4
    s_mul_i32 s61, s61, 5120
    v_add_u32 v51, s61, v25
    s_cmp_ge_u32 s95, 3
    s_cselect_b32 s61, -3, 7
    s_mul_i32 s61, s61, 5120
    v_add_u32 v55, s61, v25
    s_mul_i32 s60, s54, 48
    s_mul_i32 s61, s62, 10
    s_add_u32 s60, s60, s61
    s_add_u32 s60, s60, 27
    s_mul_i32 s60, s60, 5120
    s_add_u32 s94, s60, 0xf00000
    v_lshlrev_b32 v52, 2, v2
    s_lshl_b32 s60, s53, 3
    s_add_u32 s60, s60, s54
    s_lshl_b32 s60, s60, 8
    s_add_u32 s96, s60, 0x30080
    s_mul_i32 s60, s53, 20
    s_mul_i32 s61, s62, 10
    s_add_u32 s60, s60, s61
    s_lshl_b32 s60, s60, 12
    s_and_b32 s61, s52, 3
    s_lshl_b32 s61, s61, 10
    s_add_u32 s60, s60, s61
    s_add_u32 s90, s60, 0x900000
    s_lshl_b32 s61, s62, 2
    s_lshl_b32 s4, 15, s61
    s_mov_b32 s5, 0
    s_mov_b32 s91, 4096
    ds_read_b128 v[56:59], v25 offset:0
    ds_read_b128 v[60:63], v25 offset:1024
    ds_read_b128 v[64:67], v25 offset:2048
    ds_read_b128 v[68:71], v25 offset:3072
    ds_read_b128 v[72:75], v25 offset:4096
    ds_read_b128 v[76:79], v25 offset:5120
    ds_read_b128 v[80:83], v25 offset:6144
    ds_read_b128 v[84:87], v25 offset:7168
    ds_read_b128 v[88:91], v25 offset:8192
    ds_read_b128 v[92:95], v25 offset:9216
    ds_read_b128 v[96:99], v25 offset:10240
    ds_read_b128 v[100:103], v25 offset:11264
    ds_read_b128 v[104:107], v25 offset:12288
    ds_read_b128 v[108:111], v25 offset:13312
    ds_read_b128 v[112:115], v25 offset:14336
    ds_read_b128 v[116:119], v25 offset:15360
    ds_read_b128 v[120:123], v25 offset:16384
    ds_read_b128 v[124:127], v25 offset:17408
    ds_read_b128 v[128:131], v25 offset:18432
    ds_read_b128 v[132:135], v25 offset:19456
    ds_read_b128 v[136:139], v51 offset:0
    ds_read_b128 v[140:143], v51 offset:1024
    ds_read_b128 v[144:147], v51 offset:2048
    ds_read_b128 v[148:151], v51 offset:3072
    ds_read_b128 v[152:155], v51 offset:4096
    ds_read_b128 v[156:159], v51 offset:5120
    ds_read_b128 v[160:163], v51 offset:6144
    ds_read_b128 v[164:167], v51 offset:7168
    ds_read_b128 v[168:171], v51 offset:8192
    ds_read_b128 v[172:175], v51 offset:9216
    ds_read_b128 v[176:179], v51 offset:10240
    ds_read_b128 v[180:183], v51 offset:11264
    ds_read_b128 v[184:187], v51 offset:12288
    ds_read_b128 v[188:191], v51 offset:13312
    ds_read_b128 v[192:195], v51 offset:14336
    s_branch L_tail
L_fallback:
    s_waitcnt lgkmcnt(0)
    v_mov_b32 v128, 0
    v_mov_b32 v129, 0
    v_mov_b32 v130, 0
    v_mov_b32 v131, 0
    v_mov_b32 v132, 0
    v_mov_b32 v133, 0
    v_mov_b32 v134, 0
    v_mov_b32 v135, 0
    v_mov_b32 v136, 0
    v_mov_b32 v137, 0
    v_mov_b32 v138, 0
    v_mov_b32 v139, 0
    v_mov_b32 v140, 0
    v_mov_b32 v141, 0
    v_mov_b32 v142, 0
    v_mov_b32 v143, 0
    v_mov_b32 v144, 0
    v_mov_b32 v145, 0
    v_mov_b32 v146, 0
    v_mov_b32 v147, 0
    v_mov_b32 v148, 0
    v_mov_b32 v149, 0
    v_mov_b32 v150, 0
    v_mov_b32 v151, 0
    v_mov_b32 v152, 0
    v_mov_b32 v153, 0
    v_mov_b32 v154, 0
    v_mov_b32 v155, 0
    v_mov_b32 v156, 0
    v_mov_b32 v157, 0
    v_mov_b32 v158, 0
    v_mov_b32 v159, 0
    v_mov_b32 v160, 0
    v_mov_b32 v161, 0
    v_mov_b32 v162, 0
    v_mov_b32 v163, 0
    v_mov_b32 v164, 0
    v_mov_b32 v165, 0
    v_mov_b32 v166, 0
    v_mov_b32 v167, 0
    v_mov_b32 v168, 0
    v_mov_b32 v169, 0
    v_mov_b32 v170, 0
    v_mov_b32 v171, 0
    v_mov_b32 v172, 0
    v_mov_b32 v173, 0
    v_mov_b32 v174, 0
    v_mov_b32 v175, 0
    v_mov_b32 v176, 0
    v_mov_b32 v177, 0
    v_mov_b32 v178, 0
    v_mov_b32 v179, 0
    v_mov_b32 v180, 0
    v_mov_b32 v181, 0
    v_mov_b32 v182, 0
    v_mov_b32 v183, 0
    v_mov_b32 v184, 0
    v_mov_b32 v185, 0
    v_mov_b32 v186, 0
    v_mov_b32 v187, 0
    v_mov_b32 v188, 0
    v_mov_b32 v189, 0
    v_mov_b32 v190, 0
    v_mov_b32 v191, 0
    v_mov_b32 v192, 0
    v_mov_b32 v193, 0
    v_mov_b32 v194, 0
    v_mov_b32 v195, 0
    v_mov_b32 v196, 0
    v_mov_b32 v197, 0
    v_mov_b32 v198, 0
    v_mov_b32 v199, 0
    v_mov_b32 v200, 0
    v_mov_b32 v201, 0
    v_mov_b32 v202, 0
    v_mov_b32 v203, 0
    v_mov_b32 v204, 0
    v_mov_b32 v205, 0
    v_mov_b32 v206, 0
    v_mov_b32 v207, 0
    v_mov_b32 v208, 0
    v_mov_b32 v209, 0
    v_mov_b32 v210, 0
    v_mov_b32 v211, 0
    v_mov_b32 v212, 0
    v_mov_b32 v213, 0
    v_mov_b32 v214, 0
    v_mov_b32 v215, 0
    v_mov_b32 v216, 0
    v_mov_b32 v217, 0
    v_mov_b32 v218, 0
    v_mov_b32 v219, 0
    v_mov_b32 v220, 0
    v_mov_b32 v221, 0
    v_mov_b32 v222, 0
    v_mov_b32 v223, 0
    v_mov_b32 v224, 0
    v_mov_b32 v225, 0
    v_mov_b32 v226, 0
    v_mov_b32 v227, 0
    v_mov_b32 v228, 0
    v_mov_b32 v229, 0
    v_mov_b32 v230, 0
    v_mov_b32 v231, 0
    v_mov_b32 v232, 0
    v_mov_b32 v233, 0
    v_mov_b32 v234, 0
    v_mov_b32 v235, 0
    v_mov_b32 v236, 0
    v_mov_b32 v237, 0
    v_mov_b32 v238, 0
    v_mov_b32 v239, 0
    v_mov_b32 v240, 0
    v_mov_b32 v241, 0
    v_mov_b32 v242, 0
    v_mov_b32 v243, 0
    v_mov_b32 v244, 0
    v_mov_b32 v245, 0
    v_mov_b32 v246, 0
    v_mov_b32 v247, 0
    v_mov_b32 v248, 0
    v_mov_b32 v249, 0
    v_mov_b32 v250, 0
    v_mov_b32 v251, 0
    v_mov_b32 v252, 0
    v_mov_b32 v253, 0
    v_mov_b32 v254, 0
    v_mov_b32 v255, 0
    v_mov_b32 v36, 0xff61b1e6
    v_mov_b32 v37, 0xff61b1e6
    v_mov_b32 v38, 0xff61b1e6
    v_mov_b32 v39, 0xff61b1e6
    v_mov_b32 v40, 0xff61b1e6
    v_mov_b32 v41, 0xff61b1e6
    v_mov_b32 v42, 0xff61b1e6
    v_mov_b32 v43, 0xff61b1e6
    s_mov_b32 s91, 0
    s_mov_b32 s92, 0
L_fb:
    buffer_load_dwordx4 v[52:55], v7, s[16:19], s91 offen sc1
    buffer_load_dwordx2 v[64:65], v5, s[16:19], s91 offen offset:3072 sc1
    buffer_load_dwordx4 v[56:59], v7, s[16:19], s91 offen offset:1024 sc1
    buffer_load_dwordx4 v[60:63], v7, s[16:19], s91 offen offset:2048 sc1
    s_add_u32 s91, s91, 4096
    s_waitcnt vmcnt(0)
    v_mfma_f32_32x32x16_bf16 v[20:35], v[52:55], v[80:83], 0
    v_mfma_f32_32x32x8_bf16 v[20:35], v[64:65], v[84:85], v[20:35]
    s_nop 11
    v_max3_f32 v44, v20, v21, v36
    v_max3_f32 v44, v22, v23, v44
    v_max3_f32 v44, v24, v25, v44
    v_max3_f32 v44, v26, v27, v44
    v_max3_f32 v44, v28, v29, v44
    v_max3_f32 v44, v30, v31, v44
    v_max3_f32 v44, v32, v33, v44
    v_max3_f32 v44, v34, v35, v44
    v_mov_b32 v45, v44
    s_nop 1
    v_permlane32_swap_b32 v44, v45
    v_max_f32 v44, v44, v45
    v_sub_f32 v46, v36, v44
    v_exp_f32 v46, v46
    v_mov_b32 v36, v44
    v_sub_f32 v20, v20, v44
    v_sub_f32 v21, v21, v44
    v_sub_f32 v22, v22, v44
    v_sub_f32 v23, v23, v44
    v_sub_f32 v24, v24, v44
    v_sub_f32 v25, v25, v44
    v_sub_f32 v26, v26, v44
    v_sub_f32 v27, v27, v44
    v_sub_f32 v28, v28, v44
    v_sub_f32 v29, v29, v44
    v_sub_f32 v30, v30, v44
    v_sub_f32 v31, v31, v44
    v_sub_f32 v32, v32, v44
    v_sub_f32 v33, v33, v44
    v_sub_f32 v34, v34, v44
    v_sub_f32 v35, v35, v44
    v_exp_f32 v20, v20
    v_exp_f32 v21, v21
    v_exp_f32 v22, v22
    v_exp_f32 v23, v23
    v_exp_f32 v24, v24
    v_exp_f32 v25, v25
    v_exp_f32 v26, v26
    v_exp_f32 v27, v27
    v_exp_f32 v28, v28
    v_exp_f32 v29, v29
    v_exp_f32 v30, v30
    v_exp_f32 v31, v31
    v_exp_f32 v32, v32
    v_exp_f32 v33, v33
    v_exp_f32 v34, v34
    v_exp_f32 v35, v35
    v_mul_f32 v128, v128, v46
    v_mul_f32 v129, v129, v46
    v_mul_f32 v130, v130, v46
    v_mul_f32 v131, v131, v46
    v_mul_f32 v132, v132, v46
    v_mul_f32 v133, v133, v46
    v_mul_f32 v134, v134, v46
    v_mul_f32 v135, v135, v46
    v_mul_f32 v136, v136, v46
    v_mul_f32 v137, v137, v46
    v_mul_f32 v138, v138, v46
    v_mul_f32 v139, v139, v46
    v_cvt_pk_bf16_f32 v12, v20, v21
    v_cvt_pk_bf16_f32 v13, v22, v23
    v_cvt_pk_bf16_f32 v14, v24, v25
    v_cvt_pk_bf16_f32 v15, v26, v27
    v_cvt_pk_bf16_f32 v16, v28, v29
    v_cvt_pk_bf16_f32 v17, v30, v31
    v_cvt_pk_bf16_f32 v18, v32, v33
    v_cvt_pk_bf16_f32 v19, v34, v35
    v_mfma_f32_32x32x16_bf16 v[128:143], v[56:59], v[12:15], v[128:143]
    s_nop 0
    v_mfma_f32_32x32x16_bf16 v[128:143], v[60:63], v[16:19], v[128:143]
    v_mfma_f32_32x32x16_bf16 v[20:35], v[52:55], v[86:89], 0
    v_mfma_f32_32x32x8_bf16 v[20:35], v[64:65], v[90:91], v[20:35]
    s_nop 11
    v_max3_f32 v44, v20, v21, v37
    v_max3_f32 v44, v22, v23, v44
    v_max3_f32 v44, v24, v25, v44
    v_max3_f32 v44, v26, v27, v44
    v_max3_f32 v44, v28, v29, v44
    v_max3_f32 v44, v30, v31, v44
    v_max3_f32 v44, v32, v33, v44
    v_max3_f32 v44, v34, v35, v44
    v_mov_b32 v45, v44
    s_nop 1
    v_permlane32_swap_b32 v44, v45
    v_max_f32 v44, v44, v45
    v_sub_f32 v46, v37, v44
    v_exp_f32 v46, v46
    v_mov_b32 v37, v44
    v_sub_f32 v20, v20, v44
    v_sub_f32 v21, v21, v44
    v_sub_f32 v22, v22, v44
    v_sub_f32 v23, v23, v44
    v_sub_f32 v24, v24, v44
    v_sub_f32 v25, v25, v44
    v_sub_f32 v26, v26, v44
    v_sub_f32 v27, v27, v44
    v_sub_f32 v28, v28, v44
    v_sub_f32 v29, v29, v44
    v_sub_f32 v30, v30, v44
    v_sub_f32 v31, v31, v44
    v_sub_f32 v32, v32, v44
    v_sub_f32 v33, v33, v44
    v_sub_f32 v34, v34, v44
    v_sub_f32 v35, v35, v44
    v_exp_f32 v20, v20
    v_exp_f32 v21, v21
    v_exp_f32 v22, v22
    v_exp_f32 v23, v23
    v_exp_f32 v24, v24
    v_exp_f32 v25, v25
    v_exp_f32 v26, v26
    v_exp_f32 v27, v27
    v_exp_f32 v28, v28
    v_exp_f32 v29, v29
    v_exp_f32 v30, v30
    v_exp_f32 v31, v31
    v_exp_f32 v32, v32
    v_exp_f32 v33, v33
    v_exp_f32 v34, v34
    v_exp_f32 v35, v35
    v_mul_f32 v144, v144, v46
    v_mul_f32 v145, v145, v46
    v_mul_f32 v146, v146, v46
    v_mul_f32 v147, v147, v46
    v_mul_f32 v148, v148, v46
    v_mul_f32 v149, v149, v46
    v_mul_f32 v150, v150, v46
    v_mul_f32 v151, v151, v46
    v_mul_f32 v152, v152, v46
    v_mul_f32 v153, v153, v46
    v_mul_f32 v154, v154, v46
    v_mul_f32 v155, v155, v46
    v_cvt_pk_bf16_f32 v12, v20, v21
    v_cvt_pk_bf16_f32 v13, v22, v23
    v_cvt_pk_bf16_f32 v14, v24, v25
    v_cvt_pk_bf16_f32 v15, v26, v27
    v_cvt_pk_bf16_f32 v16, v28, v29
    v_cvt_pk_bf16_f32 v17, v30, v31
    v_cvt_pk_bf16_f32 v18, v32, v33
    v_cvt_pk_bf16_f32 v19, v34, v35
    v_mfma_f32_32x32x16_bf16 v[144:159], v[56:59], v[12:15], v[144:159]
    s_nop 0
    v_mfma_f32_32x32x16_bf16 v[144:159], v[60:63], v[16:19], v[144:159]
    v_mfma_f32_32x32x16_bf16 v[20:35], v[52:55], v[92:95], 0
    v_mfma_f32_32x32x8_bf16 v[20:35], v[64:65], v[96:97], v[20:35]
    s_nop 11
    v_max3_f32 v44, v20, v21, v38
    v_max3_f32 v44, v22, v23, v44
    v_max3_f32 v44, v24, v25, v44
    v_max3_f32 v44, v26, v27, v44
    v_max3_f32 v44, v28, v29, v44
    v_max3_f32 v44, v30, v31, v44
    v_max3_f32 v44, v32, v33, v44
    v_max3_f32 v44, v34, v35, v44
    v_mov_b32 v45, v44
    s_nop 1
    v_permlane32_swap_b32 v44, v45
    v_max_f32 v44, v44, v45
    v_sub_f32 v46, v38, v44
    v_exp_f32 v46, v46
    v_mov_b32 v38, v44
    v_sub_f32 v20, v20, v44
    v_sub_f32 v21, v21, v44
    v_sub_f32 v22, v22, v44
    v_sub_f32 v23, v23, v44
    v_sub_f32 v24, v24, v44
    v_sub_f32 v25, v25, v44
    v_sub_f32 v26, v26, v44
    v_sub_f32 v27, v27, v44
    v_sub_f32 v28, v28, v44
    v_sub_f32 v29, v29, v44
    v_sub_f32 v30, v30, v44
    v_sub_f32 v31, v31, v44
    v_sub_f32 v32, v32, v44
    v_sub_f32 v33, v33, v44
    v_sub_f32 v34, v34, v44
    v_sub_f32 v35, v35, v44
    v_exp_f32 v20, v20
    v_exp_f32 v21, v21
    v_exp_f32 v22, v22
    v_exp_f32 v23, v23
    v_exp_f32 v24, v24
    v_exp_f32 v25, v25
    v_exp_f32 v26, v26
    v_exp_f32 v27, v27
    v_exp_f32 v28, v28
    v_exp_f32 v29, v29
    v_exp_f32 v30, v30
    v_exp_f32 v31, v31
    v_exp_f32 v32, v32
    v_exp_f32 v33, v33
    v_exp_f32 v34, v34
    v_exp_f32 v35, v35
    v_mul_f32 v160, v160, v46
    v_mul_f32 v161, v161, v46
    v_mul_f32 v162, v162, v46
    v_mul_f32 v163, v163, v46
    v_mul_f32 v164, v164, v46
    v_mul_f32 v165, v165, v46
    v_mul_f32 v166, v166, v46
    v_mul_f32 v167, v167, v46
    v_mul_f32 v168, v168, v46
    v_mul_f32 v169, v169, v46
    v_mul_f32 v170, v170, v46
    v_mul_f32 v171, v171, v46
    v_cvt_pk_bf16_f32 v12, v20, v21
    v_cvt_pk_bf16_f32 v13, v22, v23
    v_cvt_pk_bf16_f32 v14, v24, v25
    v_cvt_pk_bf16_f32 v15, v26, v27
    v_cvt_pk_bf16_f32 v16, v28, v29
    v_cvt_pk_bf16_f32 v17, v30, v31
    v_cvt_pk_bf16_f32 v18, v32, v33
    v_cvt_pk_bf16_f32 v19, v34, v35
    v_mfma_f32_32x32x16_bf16 v[160:175], v[56:59], v[12:15], v[160:175]
    s_nop 0
    v_mfma_f32_32x32x16_bf16 v[160:175], v[60:63], v[16:19], v[160:175]
    v_mfma_f32_32x32x16_bf16 v[20:35], v[52:55], v[98:101], 0
    v_mfma_f32_32x32x8_bf16 v[20:35], v[64:65], v[102:103], v[20:35]
    s_nop 11
    v_max3_f32 v44, v20, v21, v39
    v_max3_f32 v44, v22, v23, v44
    v_max3_f32 v44, v24, v25, v44
    v_max3_f32 v44, v26, v27, v44
    v_max3_f32 v44, v28, v29, v44
    v_max3_f32 v44, v30, v31, v44
    v_max3_f32 v44, v32, v33, v44
    v_max3_f32 v44, v34, v35, v44
    v_mov_b32 v45, v44
    s_nop 1
    v_permlane32_swap_b32 v44, v45
    v_max_f32 v44, v44, v45
    v_sub_f32 v46, v39, v44
    v_exp_f32 v46, v46
    v_mov_b32 v39, v44
    v_sub_f32 v20, v20, v44
    v_sub_f32 v21, v21, v44
    v_sub_f32 v22, v22, v44
    v_sub_f32 v23, v23, v44
    v_sub_f32 v24, v24, v44
    v_sub_f32 v25, v25, v44
    v_sub_f32 v26, v26, v44
    v_sub_f32 v27, v27, v44
    v_sub_f32 v28, v28, v44
    v_sub_f32 v29, v29, v44
    v_sub_f32 v30, v30, v44
    v_sub_f32 v31, v31, v44
    v_sub_f32 v32, v32, v44
    v_sub_f32 v33, v33, v44
    v_sub_f32 v34, v34, v44
    v_sub_f32 v35, v35, v44
    v_exp_f32 v20, v20
    v_exp_f32 v21, v21
    v_exp_f32 v22, v22
    v_exp_f32 v23, v23
    v_exp_f32 v24, v24
    v_exp_f32 v25, v25
    v_exp_f32 v26, v26
    v_exp_f32 v27, v27
    v_exp_f32 v28, v28
    v_exp_f32 v29, v29
    v_exp_f32 v30, v30
    v_exp_f32 v31, v31
    v_exp_f32 v32, v32
    v_exp_f32 v33, v33
    v_exp_f32 v34, v34
    v_exp_f32 v35, v35
    v_mul_f32 v176, v176, v46
    v_mul_f32 v177, v177, v46
    v_mul_f32 v178, v178, v46
    v_mul_f32 v179, v179, v46
    v_mul_f32 v180, v180, v46
    v_mul_f32 v181, v181, v46
    v_mul_f32 v182, v182, v46
    v_mul_f32 v183, v183, v46
    v_mul_f32 v184, v184, v46
    v_mul_f32 v185, v185, v46
    v_mul_f32 v186, v186, v46
    v_mul_f32 v187, v187, v46
    v_cvt_pk_bf16_f32 v12, v20, v21
    v_cvt_pk_bf16_f32 v13, v22, v23
    v_cvt_pk_bf16_f32 v14, v24, v25
    v_cvt_pk_bf16_f32 v15, v26, v27
    v_cvt_pk_bf16_f32 v16, v28, v29
    v_cvt_pk_bf16_f32 v17, v30, v31
    v_cvt_pk_bf16_f32 v18, v32, v33
    v_cvt_pk_bf16_f32 v19, v34, v35
    v_mfma_f32_32x32x16_bf16 v[176:191], v[56:59], v[12:15], v[176:191]
    s_nop 0
    v_mfma_f32_32x32x16_bf16 v[176:191], v[60:63], v[16:19], v[176:191]
    v_mfma_f32_32x32x16_bf16 v[20:35], v[52:55], v[104:107], 0
    v_mfma_f32_32x32x8_bf16 v[20:35], v[64:65], v[108:109], v[20:35]
    s_nop 11
    v_max3_f32 v44, v20, v21, v40
    v_max3_f32 v44, v22, v23, v44
    v_max3_f32 v44, v24, v25, v44
    v_max3_f32 v44, v26, v27, v44
    v_max3_f32 v44, v28, v29, v44
    v_max3_f32 v44, v30, v31, v44
    v_max3_f32 v44, v32, v33, v44
    v_max3_f32 v44, v34, v35, v44
    v_mov_b32 v45, v44
    s_nop 1
    v_permlane32_swap_b32 v44, v45
    v_max_f32 v44, v44, v45
    v_sub_f32 v46, v40, v44
    v_exp_f32 v46, v46
    v_mov_b32 v40, v44
    v_sub_f32 v20, v20, v44
    v_sub_f32 v21, v21, v44
    v_sub_f32 v22, v22, v44
    v_sub_f32 v23, v23, v44
    v_sub_f32 v24, v24, v44
    v_sub_f32 v25, v25, v44
    v_sub_f32 v26, v26, v44
    v_sub_f32 v27, v27, v44
    v_sub_f32 v28, v28, v44
    v_sub_f32 v29, v29, v44
    v_sub_f32 v30, v30, v44
    v_sub_f32 v31, v31, v44
    v_sub_f32 v32, v32, v44
    v_sub_f32 v33, v33, v44
    v_sub_f32 v34, v34, v44
    v_sub_f32 v35, v35, v44
    v_exp_f32 v20, v20
    v_exp_f32 v21, v21
    v_exp_f32 v22, v22
    v_exp_f32 v23, v23
    v_exp_f32 v24, v24
    v_exp_f32 v25, v25
    v_exp_f32 v26, v26
    v_exp_f32 v27, v27
    v_exp_f32 v28, v28
    v_exp_f32 v29, v29
    v_exp_f32 v30, v30
    v_exp_f32 v31, v31
    v_exp_f32 v32, v32
    v_exp_f32 v33, v33
    v_exp_f32 v34, v34
    v_exp_f32 v35, v35
    v_mul_f32 v192, v192, v46
    v_mul_f32 v193, v193, v46
    v_mul_f32 v194, v194, v46
    v_mul_f32 v195, v195, v46
    v_mul_f32 v196, v196, v46
    v_mul_f32 v197, v197, v46
    v_mul_f32 v198, v198, v46
    v_mul_f32 v199, v199, v46
    v_mul_f32 v200, v200, v46
    v_mul_f32 v201, v201, v46
    v_mul_f32 v202, v202, v46
    v_mul_f32 v203, v203, v46
    v_cvt_pk_bf16_f32 v12, v20, v21
    v_cvt_pk_bf16_f32 v13, v22, v23
    v_cvt_pk_bf16_f32 v14, v24, v25
    v_cvt_pk_bf16_f32 v15, v26, v27
    v_cvt_pk_bf16_f32 v16, v28, v29
    v_cvt_pk_bf16_f32 v17, v30, v31
    v_cvt_pk_bf16_f32 v18, v32, v33
    v_cvt_pk_bf16_f32 v19, v34, v35
    v_mfma_f32_32x32x16_bf16 v[192:207], v[56:59], v[12:15], v[192:207]
    s_nop 0
    v_mfma_f32_32x32x16_bf16 v[192:207], v[60:63], v[16:19], v[192:207]
    v_mfma_f32_32x32x16_bf16 v[20:35], v[52:55], v[110:113], 0
    v_mfma_f32_32x32x8_bf16 v[20:35], v[64:65], v[114:115], v[20:35]
    s_nop 11
    v_max3_f32 v44, v20, v21, v41
    v_max3_f32 v44, v22, v23, v44
    v_max3_f32 v44, v24, v25, v44
    v_max3_f32 v44, v26, v27, v44
    v_max3_f32 v44, v28, v29, v44
    v_max3_f32 v44, v30, v31, v44
    v_max3_f32 v44, v32, v33, v44
    v_max3_f32 v44, v34, v35, v44
    v_mov_b32 v45, v44
    s_nop 1
    v_permlane32_swap_b32 v44, v45
    v_max_f32 v44, v44, v45
    v_sub_f32 v46, v41, v44
    v_exp_f32 v46, v46
    v_mov_b32 v41, v44
    v_sub_f32 v20, v20, v44
    v_sub_f32 v21, v21, v44
    v_sub_f32 v22, v22, v44
    v_sub_f32 v23, v23, v44
    v_sub_f32 v24, v24, v44
    v_sub_f32 v25, v25, v44
    v_sub_f32 v26, v26, v44
    v_sub_f32 v27, v27, v44
    v_sub_f32 v28, v28, v44
    v_sub_f32 v29, v29, v44
    v_sub_f32 v30, v30, v44
    v_sub_f32 v31, v31, v44
    v_sub_f32 v32, v32, v44
    v_sub_f32 v33, v33, v44
    v_sub_f32 v34, v34, v44
    v_sub_f32 v35, v35, v44
    v_exp_f32 v20, v20
    v_exp_f32 v21, v21
    v_exp_f32 v22, v22
    v_exp_f32 v23, v23
    v_exp_f32 v24, v24
    v_exp_f32 v25, v25
    v_exp_f32 v26, v26
    v_exp_f32 v27, v27
    v_exp_f32 v28, v28
    v_exp_f32 v29, v29
    v_exp_f32 v30, v30
    v_exp_f32 v31, v31
    v_exp_f32 v32, v32
    v_exp_f32 v33, v33
    v_exp_f32 v34, v34
    v_exp_f32 v35, v35
    v_mul_f32 v208, v208, v46
    v_mul_f32 v209, v209, v46
    v_mul_f32 v210, v210, v46
    v_mul_f32 v211, v211, v46
    v_mul_f32 v212, v212, v46
    v_mul_f32 v213, v213, v46
    v_mul_f32 v214, v214, v46
    v_mul_f32 v215, v215, v46
    v_mul_f32 v216, v216, v46
    v_mul_f32 v217, v217, v46
    v_mul_f32 v218, v218, v46
    v_mul_f32 v219, v219, v46
    v_cvt_pk_bf16_f32 v12, v20, v21
    v_cvt_pk_bf16_f32 v13, v22, v23
    v_cvt_pk_bf16_f32 v14, v24, v25
    v_cvt_pk_bf16_f32 v15, v26, v27
    v_cvt_pk_bf16_f32 v16, v28, v29
    v_cvt_pk_bf16_f32 v17, v30, v31
    v_cvt_pk_bf16_f32 v18, v32, v33
    v_cvt_pk_bf16_f32 v19, v34, v35
    v_mfma_f32_32x32x16_bf16 v[208:223], v[56:59], v[12:15], v[208:223]
    s_nop 0
    v_mfma_f32_32x32x16_bf16 v[208:223], v[60:63], v[16:19], v[208:223]
    v_mfma_f32_32x32x16_bf16 v[20:35], v[52:55], v[116:119], 0
    v_mfma_f32_32x32x8_bf16 v[20:35], v[64:65], v[120:121], v[20:35]
    s_nop 11
    v_max3_f32 v44, v20, v21, v42
    v_max3_f32 v44, v22, v23, v44
    v_max3_f32 v44, v24, v25, v44
    v_max3_f32 v44, v26, v27, v44
    v_max3_f32 v44, v28, v29, v44
    v_max3_f32 v44, v30, v31, v44
    v_max3_f32 v44, v32, v33, v44
    v_max3_f32 v44, v34, v35, v44
    v_mov_b32 v45, v44
    s_nop 1
    v_permlane32_swap_b32 v44, v45
    v_max_f32 v44, v44, v45
    v_sub_f32 v46, v42, v44
    v_exp_f32 v46, v46
    v_mov_b32 v42, v44
    v_sub_f32 v20, v20, v44
    v_sub_f32 v21, v21, v44
    v_sub_f32 v22, v22, v44
    v_sub_f32 v23, v23, v44
    v_sub_f32 v24, v24, v44
    v_sub_f32 v25, v25, v44
    v_sub_f32 v26, v26, v44
    v_sub_f32 v27, v27, v44
    v_sub_f32 v28, v28, v44
    v_sub_f32 v29, v29, v44
    v_sub_f32 v30, v30, v44
    v_sub_f32 v31, v31, v44
    v_sub_f32 v32, v32, v44
    v_sub_f32 v33, v33, v44
    v_sub_f32 v34, v34, v44
    v_sub_f32 v35, v35, v44
    v_exp_f32 v20, v20
    v_exp_f32 v21, v21
    v_exp_f32 v22, v22
    v_exp_f32 v23, v23
    v_exp_f32 v24, v24
    v_exp_f32 v25, v25
    v_exp_f32 v26, v26
    v_exp_f32 v27, v27
    v_exp_f32 v28, v28
    v_exp_f32 v29, v29
    v_exp_f32 v30, v30
    v_exp_f32 v31, v31
    v_exp_f32 v32, v32
    v_exp_f32 v33, v33
    v_exp_f32 v34, v34
    v_exp_f32 v35, v35
    v_mul_f32 v224, v224, v46
    v_mul_f32 v225, v225, v46
    v_mul_f32 v226, v226, v46
    v_mul_f32 v227, v227, v46
    v_mul_f32 v228, v228, v46
    v_mul_f32 v229, v229, v46
    v_mul_f32 v230, v230, v46
    v_mul_f32 v231, v231, v46
    v_mul_f32 v232, v232, v46
    v_mul_f32 v233, v233, v46
    v_mul_f32 v234, v234, v46
    v_mul_f32 v235, v235, v46
    v_cvt_pk_bf16_f32 v12, v20, v21
    v_cvt_pk_bf16_f32 v13, v22, v23
    v_cvt_pk_bf16_f32 v14, v24, v25
    v_cvt_pk_bf16_f32 v15, v26, v27
    v_cvt_pk_bf16_f32 v16, v28, v29
    v_cvt_pk_bf16_f32 v17, v30, v31
    v_cvt_pk_bf16_f32 v18, v32, v33
    v_cvt_pk_bf16_f32 v19, v34, v35
    v_mfma_f32_32x32x16_bf16 v[224:239], v[56:59], v[12:15], v[224:239]
    s_nop 0
    v_mfma_f32_32x32x16_bf16 v[224:239], v[60:63], v[16:19], v[224:239]
    v_mfma_f32_32x32x16_bf16 v[20:35], v[52:55], v[122:125], 0
    v_mfma_f32_32x32x8_bf16 v[20:35], v[64:65], v[126:127], v[20:35]
    s_nop 11
    v_max3_f32 v44, v20, v21, v43
    v_max3_f32 v44, v22, v23, v44
    v_max3_f32 v44, v24, v25, v44
    v_max3_f32 v44, v26, v27, v44
    v_max3_f32 v44, v28, v29, v44
    v_max3_f32 v44, v30, v31, v44
    v_max3_f32 v44, v32, v33, v44
    v_max3_f32 v44, v34, v35, v44
    v_mov_b32 v45, v44
    s_nop 1
    v_permlane32_swap_b32 v44, v45
    v_max_f32 v44, v44, v45
    v_sub_f32 v46, v43, v44
    v_exp_f32 v46, v46
    v_mov_b32 v43, v44
    v_sub_f32 v20, v20, v44
    v_sub_f32 v21, v21, v44
    v_sub_f32 v22, v22, v44
    v_sub_f32 v23, v23, v44
    v_sub_f32 v24, v24, v44
    v_sub_f32 v25, v25, v44
    v_sub_f32 v26, v26, v44
    v_sub_f32 v27, v27, v44
    v_sub_f32 v28, v28, v44
    v_sub_f32 v29, v29, v44
    v_sub_f32 v30, v30, v44
    v_sub_f32 v31, v31, v44
    v_sub_f32 v32, v32, v44
    v_sub_f32 v33, v33, v44
    v_sub_f32 v34, v34, v44
    v_sub_f32 v35, v35, v44
    v_exp_f32 v20, v20
    v_exp_f32 v21, v21
    v_exp_f32 v22, v22
    v_exp_f32 v23, v23
    v_exp_f32 v24, v24
    v_exp_f32 v25, v25
    v_exp_f32 v26, v26
    v_exp_f32 v27, v27
    v_exp_f32 v28, v28
    v_exp_f32 v29, v29
    v_exp_f32 v30, v30
    v_exp_f32 v31, v31
    v_exp_f32 v32, v32
    v_exp_f32 v33, v33
    v_exp_f32 v34, v34
    v_exp_f32 v35, v35
    v_mul_f32 v240, v240, v46
    v_mul_f32 v241, v241, v46
    v_mul_f32 v242, v242, v46
    v_mul_f32 v243, v243, v46
    v_mul_f32 v244, v244, v46
    v_mul_f32 v245, v245, v46
    v_mul_f32 v246, v246, v46
    v_mul_f32 v247, v247, v46
    v_mul_f32 v248, v248, v46
    v_mul_f32 v249, v249, v46
    v_mul_f32 v250, v250, v46
    v_mul_f32 v251, v251, v46
    v_cvt_pk_bf16_f32 v12, v20, v21
    v_cvt_pk_bf16_f32 v13, v22, v23
    v_cvt_pk_bf16_f32 v14, v24, v25
    v_cvt_pk_bf16_f32 v15, v26, v27
    v_cvt_pk_bf16_f32 v16, v28, v29
    v_cvt_pk_bf16_f32 v17, v30, v31
    v_cvt_pk_bf16_f32 v18, v32, v33
    v_cvt_pk_bf16_f32 v19, v34, v35
    v_mfma_f32_32x32x16_bf16 v[240:255], v[56:59], v[12:15], v[240:255]
    s_nop 0
    v_mfma_f32_32x32x16_bf16 v[240:255], v[60:63], v[16:19], v[240:255]
    s_add_u32 s92, s92, 1
    s_cmp_lt_u32 s92, 16
    s_cbranch_scc1 L_fb
    v_mov_b32 v4, 0x27e04
    s_mov_b32 s3, 0x100000
Lbs_73:
    ds_read_b32 v11, v4
    s_waitcnt lgkmcnt(0)
    v_readfirstlane_b32 s6, v11
    s_nop 0
    s_cmp_ge_u32 s6, 8
    s_cbranch_scc1 Lbsd_74
    s_sub_u32 s3, s3, 1
    s_cbranch_scc1 Lbsd_74
    s_sleep 1
    s_branch Lbs_73
Lbsd_74:
    v_lshlrev_b32 v4, 2, v2
    s_add_u32 s60, s52, 0
    s_and_b32 s60, s60, 3
    s_lshl_b32 s60, s60, 8
    s_add_u32 s94, s60, 158720
    s_lshl_b32 s61, s52, 10
    s_add_u32 s60, s61, s94
    v_add_u32 v11, s60, v4
    ds_write_b32 v11, v36
    ds_write_b32 v11, v37 offset:128
    s_add_u32 s60, s52, 1
    s_and_b32 s60, s60, 3
    s_lshl_b32 s60, s60, 8
    s_add_u32 s95, s60, 158720
    s_lshl_b32 s61, s52, 10
    s_add_u32 s60, s61, s95
    v_add_u32 v11, s60, v4
    ds_write_b32 v11, v38
    ds_write_b32 v11, v39 offset:128
    s_add_u32 s60, s52, 2
    s_and_b32 s60, s60, 3
    s_lshl_b32 s60, s60, 8
    s_add_u32 s96, s60, 158720
    s_lshl_b32 s61, s52, 10
    s_add_u32 s60, s61, s96
    v_add_u32 v11, s60, v4
    ds_write_b32 v11, v40
    ds_write_b32 v11, v41 offset:128
    s_add_u32 s60, s52, 3
    s_and_b32 s60, s60, 3
    s_lshl_b32 s60, s60, 8
    s_add_u32 s97, s60, 158720
    s_lshl_b32 s61, s52, 10
    s_add_u32 s60, s61, s97
    v_add_u32 v11, s60, v4
    ds_write_b32 v11, v42
    ds_write_b32 v11, v43 offset:128
    s_waitcnt lgkmcnt(0)
    v_mov_b32 v12, 0x27e2c
    v_mov_b32 v13, 1
    s_mov_b64 exec, 1
    ds_add_u32 v12, v13
    s_mov_b64 exec, -1
    v_mov_b32 v12, 0x27e2c
    s_mov_b32 s3, 0x100000
Lbs_75:
    ds_read_b32 v13, v12
    s_waitcnt lgkmcnt(0)
    v_readfirstlane_b32 s6, v13
    s_nop 0
    s_cmp_ge_u32 s6, 4
    s_cbranch_scc1 Lbsd_76
    s_sub_u32 s3, s3, 1
    s_cbranch_scc1 Lbsd_76
    s_sleep 1
    s_branch Lbs_75
Lbsd_76:
    v_add_u32 v11, s94, v4
    ds_read_b32 v20, v11 offset:0
    ds_read_b32 v21, v11 offset:1024
    ds_read_b32 v22, v11 offset:2048
    ds_read_b32 v23, v11 offset:3072
    s_waitcnt lgkmcnt(0)
    v_max3_f32 v20, v20, v21, v22
    v_max_f32 v20, v20, v23
    v_sub_f32 v20, v36, v20
    v_exp_f32 v20, v20
    s_nop 0
    v_mul_f32 v128, v128, v20
    v_mul_f32 v129, v129, v20
    v_mul_f32 v130, v130, v20
    v_mul_f32 v131, v131, v20
    v_mul_f32 v132, v132, v20
    v_mul_f32 v133, v133, v20
    v_mul_f32 v134, v134, v20
    v_mul_f32 v135, v135, v20
    v_mul_f32 v136, v136, v20
    v_mul_f32 v137, v137, v20
    v_mul_f32 v138, v138, v20
    v_mul_f32 v139, v139, v20
    ds_read_b32 v20, v11 offset:128
    ds_read_b32 v21, v11 offset:1152
    ds_read_b32 v22, v11 offset:2176
    ds_read_b32 v23, v11 offset:3200
    s_waitcnt lgkmcnt(0)
    v_max3_f32 v20, v20, v21, v22
    v_max_f32 v20, v20, v23
    v_sub_f32 v20, v37, v20
    v_exp_f32 v20, v20
    s_nop 0
    v_mul_f32 v144, v144, v20
    v_mul_f32 v145, v145, v20
    v_mul_f32 v146, v146, v20
    v_mul_f32 v147, v147, v20
    v_mul_f32 v148, v148, v20
    v_mul_f32 v149, v149, v20
    v_mul_f32 v150, v150, v20
    v_mul_f32 v151, v151, v20
    v_mul_f32 v152, v152, v20
    v_mul_f32 v153, v153, v20
    v_mul_f32 v154, v154, v20
    v_mul_f32 v155, v155, v20
    v_add_u32 v11, s95, v4
    ds_read_b32 v20, v11 offset:0
    ds_read_b32 v21, v11 offset:1024
    ds_read_b32 v22, v11 offset:2048
    ds_read_b32 v23, v11 offset:3072
    s_waitcnt lgkmcnt(0)
    v_max3_f32 v20, v20, v21, v22
    v_max_f32 v20, v20, v23
    v_sub_f32 v20, v38, v20
    v_exp_f32 v20, v20
    s_nop 0
    v_mul_f32 v160, v160, v20
    v_mul_f32 v161, v161, v20
    v_mul_f32 v162, v162, v20
    v_mul_f32 v163, v163, v20
    v_mul_f32 v164, v164, v20
    v_mul_f32 v165, v165, v20
    v_mul_f32 v166, v166, v20
    v_mul_f32 v167, v167, v20
    v_mul_f32 v168, v168, v20
    v_mul_f32 v169, v169, v20
    v_mul_f32 v170, v170, v20
    v_mul_f32 v171, v171, v20
    ds_read_b32 v20, v11 offset:128
    ds_read_b32 v21, v11 offset:1152
    ds_read_b32 v22, v11 offset:2176
    ds_read_b32 v23, v11 offset:3200
    s_waitcnt lgkmcnt(0)
    v_max3_f32 v20, v20, v21, v22
    v_max_f32 v20, v20, v23
    v_sub_f32 v20, v39, v20
    v_exp_f32 v20, v20
    s_nop 0
    v_mul_f32 v176, v176, v20
    v_mul_f32 v177, v177, v20
    v_mul_f32 v178, v178, v20
    v_mul_f32 v179, v179, v20
    v_mul_f32 v180, v180, v20
    v_mul_f32 v181, v181, v20
    v_mul_f32 v182, v182, v20
    v_mul_f32 v183, v183, v20
    v_mul_f32 v184, v184, v20
    v_mul_f32 v185, v185, v20
    v_mul_f32 v186, v186, v20
    v_mul_f32 v187, v187, v20
    v_add_u32 v11, s96, v4
    ds_read_b32 v20, v11 offset:0
    ds_read_b32 v21, v11 offset:1024
    ds_read_b32 v22, v11 offset:2048
    ds_read_b32 v23, v11 offset:3072
    s_waitcnt lgkmcnt(0)
    v_max3_f32 v20, v20, v21, v22
    v_max_f32 v20, v20, v23
    v_sub_f32 v20, v40, v20
    v_exp_f32 v20, v20
    s_nop 0
    v_mul_f32 v192, v192, v20
    v_mul_f32 v193, v193, v20
    v_mul_f32 v194, v194, v20
    v_mul_f32 v195, v195, v20
    v_mul_f32 v196, v196, v20
    v_mul_f32 v197, v197, v20
    v_mul_f32 v198, v198, v20
    v_mul_f32 v199, v199, v20
    v_mul_f32 v200, v200, v20
    v_mul_f32 v201, v201, v20
    v_mul_f32 v202, v202, v20
    v_mul_f32 v203, v203, v20
    ds_read_b32 v20, v11 offset:128
    ds_read_b32 v21, v11 offset:1152
    ds_read_b32 v22, v11 offset:2176
    ds_read_b32 v23, v11 offset:3200
    s_waitcnt lgkmcnt(0)
    v_max3_f32 v20, v20, v21, v22
    v_max_f32 v20, v20, v23
    v_sub_f32 v20, v41, v20
    v_exp_f32 v20, v20
    s_nop 0
    v_mul_f32 v208, v208, v20
    v_mul_f32 v209, v209, v20
    v_mul_f32 v210, v210, v20
    v_mul_f32 v211, v211, v20
    v_mul_f32 v212, v212, v20
    v_mul_f32 v213, v213, v20
    v_mul_f32 v214, v214, v20
    v_mul_f32 v215, v215, v20
    v_mul_f32 v216, v216, v20
    v_mul_f32 v217, v217, v20
    v_mul_f32 v218, v218, v20
    v_mul_f32 v219, v219, v20
    v_add_u32 v11, s97, v4
    ds_read_b32 v20, v11 offset:0
    ds_read_b32 v21, v11 offset:1024
    ds_read_b32 v22, v11 offset:2048
    ds_read_b32 v23, v11 offset:3072
    s_waitcnt lgkmcnt(0)
    v_max3_f32 v20, v20, v21, v22
    v_max_f32 v20, v20, v23
    v_sub_f32 v20, v42, v20
    v_exp_f32 v20, v20
    s_nop 0
    v_mul_f32 v224, v224, v20
    v_mul_f32 v225, v225, v20
    v_mul_f32 v226, v226, v20
    v_mul_f32 v227, v227, v20
    v_mul_f32 v228, v228, v20
    v_mul_f32 v229, v229, v20
    v_mul_f32 v230, v230, v20
    v_mul_f32 v231, v231, v20
    v_mul_f32 v232, v232, v20
    v_mul_f32 v233, v233, v20
    v_mul_f32 v234, v234, v20
    v_mul_f32 v235, v235, v20
    ds_read_b32 v20, v11 offset:128
    ds_read_b32 v21, v11 offset:1152
    ds_read_b32 v22, v11 offset:2176
    ds_read_b32 v23, v11 offset:3200
    s_waitcnt lgkmcnt(0)
    v_max3_f32 v20, v20, v21, v22
    v_max_f32 v20, v20, v23
    v_sub_f32 v20, v43, v20
    v_exp_f32 v20, v20
    s_nop 0
    v_mul_f32 v240, v240, v20
    v_mul_f32 v241, v241, v20
    v_mul_f32 v242, v242, v20
    v_mul_f32 v243, v243, v20
    v_mul_f32 v244, v244, v20
    v_mul_f32 v245, v245, v20
    v_mul_f32 v246, v246, v20
    v_mul_f32 v247, v247, v20
    v_mul_f32 v248, v248, v20
    v_mul_f32 v249, v249, v20
    v_mul_f32 v250, v250, v20
    v_mul_f32 v251, v251, v20
    v_mov_b32 v12, 0x27e30
    v_mov_b32 v13, 1
    s_mov_b64 exec, 1
    ds_add_u32 v12, v13
    s_mov_b64 exec, -1
    v_mov_b32 v12, 0x27e30
    s_mov_b32 s3, 0x100000
Lbs_77:
    ds_read_b32 v13, v12
    s_waitcnt lgkmcnt(0)
    v_readfirstlane_b32 s6, v13
    s_nop 0
    s_cmp_ge_u32 s6, 4
    s_cbranch_scc1 Lbsd_78
    s_sub_u32 s3, s3, 1
    s_cbranch_scc1 Lbsd_78
    s_sleep 1
    s_branch Lbs_77
Lbsd_78:
    s_mul_i32 s60, s52, 16384
    s_add_u32 s60, s60, 97792
    v_add_u32 v4, s60, v7
    v_lshlrev_b32 v5, 4, v2
    v_lshl_add_u32 v11, v2, 5, s60
    s_branch L_attdone
L_roleB:
    s_sub_u32 s101, s52, 4
    s_waitcnt vmcnt(9)
    s_waitcnt lgkmcnt(0)
    s_barrier
    v_mfma_f32_32x32x16_bf16 v[224:239], v[176:179], v[16:19], 0
    ds_read_b64_tr_b16 v[192:193], v246 offset:49152
    ds_read_b64_tr_b16 v[194:195], v246 offset:50176
    ds_read_b64_tr_b16 v[196:197], v246 offset:53248
    ds_read_b64_tr_b16 v[198:199], v246 offset:54272
    v_mfma_f32_32x32x16_bf16 v[224:239], v[180:183], v[20:23], v[224:239]
    ds_read_b64_tr_b16 v[200:201], v246 offset:57344
    ds_read_b64_tr_b16 v[202:203], v246 offset:58368
    ds_read_b64_tr_b16 v[204:205], v246 offset:61440
    ds_read_b64_tr_b16 v[206:207], v246 offset:62464
    s_add_u32 m0, s93, 114688
    s_add_u32 s60, s92, s90
    buffer_load_dwordx4 v245, s[20:23], s60 offen lds
    s_add_u32 s90, s90, 110592
    v_mfma_f32_32x32x16_bf16 v[224:239], v[184:187], v[24:27], v[224:239]
    s_add_u32 m0, s93, 122880
    s_add_u32 s60, s92, s90
    buffer_load_dwordx4 v245, s[20:23], s60 offen lds
    s_add_u32 s90, s90, 110592
    s_cmp_eq_u32 s90, 2211840
    s_cselect_b32 s90, 0, s90
    v_mfma_f32_32x32x16_bf16 v[224:239], v[188:191], v[28:31], v[224:239]
    s_waitcnt vmcnt(8)
    s_waitcnt lgkmcnt(0)
    s_barrier
    v_mfma_f32_32x32x16_bf16 v[224:239], v[192:195], v[32:35], v[224:239]
    ds_read_b64_tr_b16 v[176:177], v246 offset:0
    ds_read_b64_tr_b16 v[178:179], v246 offset:1024
    ds_read_b64_tr_b16 v[180:181], v246 offset:4096
    ds_read_b64_tr_b16 v[182:183], v246 offset:5120
    v_mfma_f32_32x32x16_bf16 v[224:239], v[196:199], v[36:39], v[224:239]
    ds_read_b64_tr_b16 v[184:185], v246 offset:8192
    ds_read_b64_tr_b16 v[186:187], v246 offset:9216
    ds_read_b64_tr_b16 v[188:189], v246 offset:12288
    ds_read_b64_tr_b16 v[190:191], v246 offset:13312
    s_add_u32 m0, s93, 131072
    s_add_u32 s60, s92, s90
    buffer_load_dwordx4 v245, s[20:23], s60 offen lds
    s_add_u32 s90, s90, 110592
    v_mfma_f32_32x32x16_bf16 v[224:239], v[200:203], v[40:43], v[224:239]
    s_add_u32 m0, s93, 139264
    s_add_u32 s60, s92, s90
    buffer_load_dwordx4 v245, s[20:23], s60 offen lds
    s_add_u32 s90, s90, 110592
    s_cmp_eq_u32 s90, 2211840
    s_cselect_b32 s90, 0, s90
    v_mfma_f32_32x32x16_bf16 v[224:239], v[204:207], v[44:47], v[224:239]
    s_waitcnt vmcnt(8)
    s_waitcnt lgkmcnt(0)
    s_barrier
    v_mfma_f32_32x32x16_bf16 v[224:239], v[176:179], v[48:51], v[224:239]
    ds_read_b64_tr_b16 v[192:193], v246 offset:16384
    ds_read_b64_tr_b16 v[194:195], v246 offset:17408
    ds_read_b64_tr_b16 v[196:197], v246 offset:20480
    ds_read_b64_tr_b16 v[198:199], v246 offset:21504
    v_mfma_f32_32x32x16_bf16 v[224:239], v[180:183], v[52:55], v[224:239]
    ds_read_b64_tr_b16 v[200:201], v246 offset:24576
    ds_read_b64_tr_b16 v[202:203], v246 offset:25600
    ds_read_b64_tr_b16 v[204:205], v246 offset:28672
    ds_read_b64_tr_b16 v[206:207], v246 offset:29696
    s_add_u32 m0, s93, 81920
    s_add_u32 s60, s92, s90
    buffer_load_dwordx4 v245, s[20:23], s60 offen lds
    s_add_u32 s90, s90, 110592
    v_mfma_f32_32x32x16_bf16 v[224:239], v[184:187], v[56:59], v[224:239]
    s_add_u32 m0, s93, 90112
    s_add_u32 s60, s92, s90
    buffer_load_dwordx4 v245, s[20:23], s60 offen lds
    s_add_u32 s90, s90, 110592
    s_cmp_eq_u32 s90, 2211840
    s_cselect_b32 s90, 0, s90
    v_mfma_f32_32x32x16_bf16 v[224:239], v[188:191], v[60:63], v[224:239]
    s_waitcnt vmcnt(6)
    v_mov_b32 v11, 1
    s_cmp_lt_u32 s100, 47
    s_cbranch_scc0 Lz_80
    s_lshl_b32 s60, s54, 6
    s_add_u32 s60, s60, s100
    s_lshl_b32 s60, s60, 2
    s_add_u32 s60, s60, 9216
    v_mov_b32 v10, 0
    s_mov_b64 exec, 1
    buffer_store_dword v11, v10, s[44:47], s60 offen sc1
    s_mov_b64 exec, -1
Lz_80:
    s_waitcnt vmcnt(4)
    s_waitcnt lgkmcnt(0)
    s_barrier
    v_mfma_f32_32x32x16_bf16 v[224:239], v[192:195], v[64:67], v[224:239]
    ds_read_b64_tr_b16 v[176:177], v246 offset:32768
    ds_read_b64_tr_b16 v[178:179], v246 offset:33792
    ds_read_b64_tr_b16 v[180:181], v246 offset:36864
    ds_read_b64_tr_b16 v[182:183], v246 offset:37888
    v_lshrrev_b32 v8, 3, v1
    v_lshlrev_b32 v8, 12, v8
    v_lshrrev_b32 v9, 4, v1
    v_and_b32 v10, 7, v1
    v_xor_b32 v9, v9, v10
    v_lshl_add_u32 v16, v9, 4, v8
    v_mfma_f32_32x32x16_bf16 v[224:239], v[196:199], v[68:71], v[224:239]
    ds_read_b64_tr_b16 v[184:185], v246 offset:40960
    ds_read_b64_tr_b16 v[186:187], v246 offset:41984
    ds_read_b64_tr_b16 v[188:189], v246 offset:45056
    ds_read_b64_tr_b16 v[190:191], v246 offset:46080
    s_add_u32 m0, s93, 98304
    s_add_u32 s60, s92, s90
    buffer_load_dwordx4 v245, s[20:23], s60 offen lds
    s_add_u32 s90, s90, 110592
    v_xor_b32 v17, 64, v16
    v_lshrrev_b32 v8, 3, v2
    v_lshlrev_b32 v8, 10, v8
    v_and_b32 v9, 7, v2
    v_lshl_add_u32 v8, v9, 7, v8
    v_bfe_u32 v9, v2, 1, 3
    v_mfma_f32_32x32x16_bf16 v[224:239], v[200:203], v[72:75], v[224:239]
    s_add_u32 m0, s93, 106496
    s_add_u32 s60, s92, s90
    buffer_load_dwordx4 v245, s[20:23], s60 offen lds
    s_add_u32 s90, s90, 110592
    s_cmp_eq_u32 s90, 2211840
    s_cselect_b32 s90, 0, s90
    v_xor_b32 v9, v9, v3
    v_lshl_add_u32 v8, v9, 4, v8
    v_add_u32 v18, s32, v8
    v_xor_b32 v19, 32, v18
    v_xor_b32 v20, 64, v18
    v_xor_b32 v21, 96, v18
    v_add_u32 v22, 0x10000, v18
    v_add_u32 v23, 0x10000, v19
    v_add_u32 v24, 0x10000, v20
    v_add_u32 v25, 0x10000, v21
    v_lshlrev_b32 v4, 2, v1
    v_lshlrev_b32 v14, 1, v2
    s_mov_b32 s100, s34
    v_mfma_f32_32x32x16_bf16 v[224:239], v[204:207], v[76:79], v[224:239]
    s_lshl_b32 s60, s53, 7
    buffer_load_ushort v26, v14, s[28:31], s60 offen
    buffer_load_ushort v27, v14, s[28:31], s60 offen offset:64
    s_waitcnt vmcnt(6)
    s_waitcnt lgkmcnt(0)
    s_barrier
    v_mfma_f32_32x32x16_bf16 v[224:239], v[176:179], v[80:83], v[224:239]
    ds_read_b64_tr_b16 v[192:193], v246 offset:49152
    ds_read_b64_tr_b16 v[194:195], v246 offset:50176
    ds_read_b64_tr_b16 v[196:197], v246 offset:53248
    ds_read_b64_tr_b16 v[198:199], v246 offset:54272
    v_lshrrev_b32 v45, 4, v2
    v_lshlrev_b32 v45, 10, v45
    v_mfma_f32_32x32x16_bf16 v[224:239], v[180:183], v[84:87], v[224:239]
    ds_read_b64_tr_b16 v[200:201], v246 offset:57344
    ds_read_b64_tr_b16 v[202:203], v246 offset:58368
    ds_read_b64_tr_b16 v[204:205], v246 offset:61440
    ds_read_b64_tr_b16 v[206:207], v246 offset:62464
    s_add_u32 m0, s93, 114688
    s_add_u32 s60, s92, s90
    buffer_load_dwordx4 v245, s[20:23], s60 offen lds
    s_add_u32 s90, s90, 110592
    v_and_b32 v9, 15, v2
    v_lshl_add_u32 v45, v9, 4, v45
    v_mfma_f32_32x32x16_bf16 v[224:239], v[184:187], v[88:91], v[224:239]
    s_add_u32 m0, s93, 122880
    s_add_u32 s60, s92, s90
    buffer_load_dwordx4 v245, s[20:23], s60 offen lds
    s_add_u32 s90, s90, 110592
    s_cmp_eq_u32 s90, 2211840
    s_cselect_b32 s90, 0, s90
    v_lshl_add_u32 v45, v3, 8, v45
    v_and_b32 v46, 15, v1
    v_mul_u32_u24 v46, 1280, v46
    v_lshrrev_b32 v8, 4, v1
    v_lshl_add_u32 v46, v8, 3, v46
    v_mfma_f32_32x32x16_bf16 v[224:239], v[188:191], v[92:95], v[224:239]
    s_waitcnt vmcnt(6)
    s_waitcnt lgkmcnt(0)
    s_barrier
    v_mfma_f32_32x32x16_bf16 v[224:239], v[192:195], v[96:99], v[224:239]
    ds_read_b64_tr_b16 v[176:177], v246 offset:0
    ds_read_b64_tr_b16 v[178:179], v246 offset:1024
    ds_read_b64_tr_b16 v[180:181], v246 offset:4096
    ds_read_b64_tr_b16 v[182:183], v246 offset:5120
    v_mfma_f32_32x32x16_bf16 v[224:239], v[196:199], v[100:103], v[224:239]
    ds_read_b64_tr_b16 v[184:185], v246 offset:8192
    ds_read_b64_tr_b16 v[186:187], v246 offset:9216
    ds_read_b64_tr_b16 v[188:189], v246 offset:12288
    ds_read_b64_tr_b16 v[190:191], v246 offset:13312
    s_add_u32 m0, s93, 131072
    s_add_u32 s60, s92, s90
    buffer_load_dwordx4 v245, s[20:23], s60 offen lds
    s_add_u32 s90, s90, 110592
    v_mfma_f32_32x32x16_bf16 v[224:239], v[200:203], v[104:107], v[224:239]
    s_add_u32 m0, s93, 139264
    s_add_u32 s60, s92, s90
    buffer_load_dwordx4 v245, s[20:23], s60 offen lds
    s_add_u32 s90, s90, 110592
    s_cmp_eq_u32 s90, 2211840
    s_cselect_b32 s90, 0, s90
    v_mfma_f32_32x32x16_bf16 v[224:239], v[204:207], v[108:111], v[224:239]
    s_waitcnt vmcnt(6)
    s_waitcnt lgkmcnt(0)
    s_barrier
    v_mfma_f32_32x32x16_bf16 v[224:239], v[176:179], v[112:115], v[224:239]
    ds_read_b64_tr_b16 v[192:193], v246 offset:16384
    ds_read_b64_tr_b16 v[194:195], v246 offset:17408
    ds_read_b64_tr_b16 v[196:197], v246 offset:20480
    ds_read_b64_tr_b16 v[198:199], v246 offset:21504
    v_mfma_f32_32x32x16_bf16 v[224:239], v[180:183], v[116:119], v[224:239]
    ds_read_b64_tr_b16 v[200:201], v246 offset:24576
    ds_read_b64_tr_b16 v[202:203], v246 offset:25600
    ds_read_b64_tr_b16 v[204:205], v246 offset:28672
    ds_read_b64_tr_b16 v[206:207], v246 offset:29696
    v_mfma_f32_32x32x16_bf16 v[224:239], v[184:187], v[120:123], v[224:239]
    s_add_u32 m0, s32, 0
    s_add_u32 s61, s59, 0
    s_and_b32 s61, s61, 7
    s_lshl_b32 s61, s61, 7
    s_add_u32 s90, s33, s61
    s_add_u32 s60, s90, 0
    buffer_load_dwordx4 v16, s[24:27], s60 offen lds
    s_add_u32 m0, s32, 1024
    s_add_u32 s60, s90, 32768
    buffer_load_dwordx4 v17, s[24:27], s60 offen lds
    s_add_u32 m0, s32, 2048
    s_add_u32 s60, s90, 65536
    buffer_load_dwordx4 v16, s[24:27], s60 offen lds
    v_mfma_f32_32x32x16_bf16 v[224:239], v[188:191], v[124:127], v[224:239]
    s_waitcnt vmcnt(5)
    s_waitcnt lgkmcnt(0)
    s_barrier
    v_mfma_f32_32x32x16_bf16 v[224:239], v[192:195], v[128:131], v[224:239]
    ds_read_b64_tr_b16 v[176:177], v246 offset:32768
    ds_read_b64_tr_b16 v[178:179], v246 offset:33792
    ds_read_b64_tr_b16 v[180:181], v246 offset:36864
    ds_read_b64_tr_b16 v[182:183], v246 offset:37888
    v_mfma_f32_32x32x16_bf16 v[224:239], v[196:199], v[132:135], v[224:239]
    ds_read_b64_tr_b16 v[184:185], v246 offset:40960
    ds_read_b64_tr_b16 v[186:187], v246 offset:41984
    ds_read_b64_tr_b16 v[188:189], v246 offset:45056
    ds_read_b64_tr_b16 v[190:191], v246 offset:46080
    v_mfma_f32_32x32x16_bf16 v[224:239], v[200:203], v[136:139], v[224:239]
    s_add_u32 m0, s32, 3072
    s_add_u32 s60, s90, 98304
    buffer_load_dwordx4 v17, s[24:27], s60 offen lds
    s_add_u32 m0, s32, 4096
    s_add_u32 s60, s90, 131072
    buffer_load_dwordx4 v16, s[24:27], s60 offen lds
    s_add_u32 m0, s32, 5120
    s_add_u32 s60, s90, 163840
    buffer_load_dwordx4 v17, s[24:27], s60 offen lds
    v_mfma_f32_32x32x16_bf16 v[224:239], v[204:207], v[140:143], v[224:239]
    s_waitcnt vmcnt(6)
    s_waitcnt lgkmcnt(0)
    s_barrier
    v_mfma_f32_32x32x16_bf16 v[224:239], v[176:179], v[144:147], v[224:239]
    ds_read_b64_tr_b16 v[192:193], v246 offset:49152
    ds_read_b64_tr_b16 v[194:195], v246 offset:50176
    ds_read_b64_tr_b16 v[196:197], v246 offset:53248
    ds_read_b64_tr_b16 v[198:199], v246 offset:54272
    v_mfma_f32_32x32x16_bf16 v[224:239], v[180:183], v[148:151], v[224:239]
    ds_read_b64_tr_b16 v[200:201], v246 offset:57344
    ds_read_b64_tr_b16 v[202:203], v246 offset:58368
    ds_read_b64_tr_b16 v[204:205], v246 offset:61440
    ds_read_b64_tr_b16 v[206:207], v246 offset:62464
    v_mfma_f32_32x32x16_bf16 v[224:239], v[184:187], v[152:155], v[224:239]
    s_add_u32 m0, s32, 6144
    s_add_u32 s60, s90, 196608
    buffer_load_dwordx4 v16, s[24:27], s60 offen lds
    s_add_u32 m0, s32, 7168
    s_add_u32 s60, s90, 229376
    buffer_load_dwordx4 v17, s[24:27], s60 offen lds
    v_mfma_f32_32x32x16_bf16 v[224:239], v[188:191], v[156:159], v[224:239]
    s_lshl_b32 s62, s101, 3
    s_add_u32 s62, s62, s54
    s_lshl_b32 s62, s62, 7
    s_add_u32 s62, s62, 5120
    v_lshlrev_b32 v10, 2, v2
    buffer_load_dword v8, v10, s[44:47], s62 offen sc1
    s_mov_b64 s[4:5], 0xffff
    s_mul_i32 s91, s54, 160
    s_mul_i32 s93, s101, 5120
    s_mul_i32 s61, s54, 245760
    s_add_u32 s61, s61, 0xf00000
    s_add_u32 s92, s93, s61
    s_waitcnt lgkmcnt(0)
    s_barrier
    v_mfma_f32_32x32x16_bf16 v[224:239], v[192:195], v[160:163], v[224:239]
    v_mfma_f32_32x32x16_bf16 v[224:239], v[196:199], v[164:167], v[224:239]
    v_mfma_f32_32x32x16_bf16 v[224:239], v[200:203], v[168:171], v[224:239]
    v_mfma_f32_32x32x16_bf16 v[224:239], v[204:207], v[172:175], v[224:239]
    s_setprio 2
    v_mov_b32 v12, 0xbdd2d3e8
    v_mov_b32 v13, 0xc0135761
    s_nop 8
    v_pk_mul_f32 v[240:241], v[224:225], v[224:225]
    v_pk_mul_f32 v[242:243], v[226:227], v[226:227]
    v_pk_mul_f32 v[244:245], v[228:229], v[228:229]
    v_pk_mul_f32 v[246:247], v[230:231], v[230:231]
    v_pk_mul_f32 v[248:249], v[232:233], v[232:233]
    v_pk_mul_f32 v[250:251], v[234:235], v[234:235]
    v_pk_mul_f32 v[252:253], v[236:237], v[236:237]
    v_pk_mul_f32 v[254:255], v[238:239], v[238:239]
    v_pk_fma_f32 v[240:241], v[240:241], v[12:13], v[12:13] op_sel:[0,0,1] op_sel_hi:[1,0,1]
    v_pk_fma_f32 v[242:243], v[242:243], v[12:13], v[12:13] op_sel:[0,0,1] op_sel_hi:[1,0,1]
    v_pk_fma_f32 v[244:245], v[244:245], v[12:13], v[12:13] op_sel:[0,0,1] op_sel_hi:[1,0,1]
    v_pk_fma_f32 v[246:247], v[246:247], v[12:13], v[12:13] op_sel:[0,0,1] op_sel_hi:[1,0,1]
    v_pk_fma_f32 v[248:249], v[248:249], v[12:13], v[12:13] op_sel:[0,0,1] op_sel_hi:[1,0,1]
    v_pk_fma_f32 v[250:251], v[250:251], v[12:13], v[12:13] op_sel:[0,0,1] op_sel_hi:[1,0,1]
    v_pk_fma_f32 v[252:253], v[252:253], v[12:13], v[12:13] op_sel:[0,0,1] op_sel_hi:[1,0,1]
    v_pk_fma_f32 v[254:255], v[254:255], v[12:13], v[12:13] op_sel:[0,0,1] op_sel_hi:[1,0,1]
    v_pk_mul_f32 v[240:241], v[240:241], v[224:225]
    v_pk_mul_f32 v[242:243], v[242:243], v[226:227]
    v_pk_mul_f32 v[244:245], v[244:245], v[228:229]
    v_pk_mul_f32 v[246:247], v[246:247], v[230:231]
    v_pk_mul_f32 v[248:249], v[248:249], v[232:233]
    v_pk_mul_f32 v[250:251], v[250:251], v[234:235]
    v_pk_mul_f32 v[252:253], v[252:253], v[236:237]
    v_pk_mul_f32 v[254:255], v[254:255], v[238:239]
    v_exp_f32 v240, v240
    v_exp_f32 v241, v241
    v_exp_f32 v242, v242
    v_exp_f32 v243, v243
    v_exp_f32 v244, v244
    v_exp_f32 v245, v245
    v_exp_f32 v246, v246
    v_exp_f32 v247, v247
    v_exp_f32 v248, v248
    v_exp_f32 v249, v249
    v_exp_f32 v250, v250
    v_exp_f32 v251, v251
    v_exp_f32 v252, v252
    v_exp_f32 v253, v253
    v_exp_f32 v254, v254
    v_exp_f32 v255, v255
    v_pk_add_f32 v[240:241], v[240:241], 1.0 op_sel_hi:[1,0]
    v_pk_add_f32 v[242:243], v[242:243], 1.0 op_sel_hi:[1,0]
    v_pk_add_f32 v[244:245], v[244:245], 1.0 op_sel_hi:[1,0]
    v_pk_add_f32 v[246:247], v[246:247], 1.0 op_sel_hi:[1,0]
    v_pk_add_f32 v[248:249], v[248:249], 1.0 op_sel_hi:[1,0]
    v_pk_add_f32 v[250:251], v[250:251], 1.0 op_sel_hi:[1,0]
    v_pk_add_f32 v[252:253], v[252:253], 1.0 op_sel_hi:[1,0]
    v_pk_add_f32 v[254:255], v[254:255], 1.0 op_sel_hi:[1,0]
    v_rcp_f32 v240, v240
    v_rcp_f32 v241, v241
    v_rcp_f32 v242, v242
    v_rcp_f32 v243, v243
    v_rcp_f32 v244, v244
    v_rcp_f32 v245, v245
    v_rcp_f32 v246, v246
    v_rcp_f32 v247, v247
    v_rcp_f32 v248, v248
    v_rcp_f32 v249, v249
    v_rcp_f32 v250, v250
    v_rcp_f32 v251, v251
    v_rcp_f32 v252, v252
    v_rcp_f32 v253, v253
    v_rcp_f32 v254, v254
    v_rcp_f32 v255, v255
    v_pk_mul_f32 v[112:113], v[224:225], v[240:241]
    v_pk_mul_f32 v[114:115], v[226:227], v[242:243]
    v_pk_mul_f32 v[116:117], v[228:229], v[244:245]
    v_pk_mul_f32 v[118:119], v[230:231], v[246:247]
    v_pk_mul_f32 v[120:121], v[232:233], v[248:249]
    v_pk_mul_f32 v[122:123], v[234:235], v[250:251]
    v_pk_mul_f32 v[124:125], v[236:237], v[252:253]
    v_pk_mul_f32 v[126:127], v[238:239], v[254:255]
    v_mov_b32 v14, 0x27e04
    s_mov_b32 s3, 0x100000
Lbs_81:
    ds_read_b32 v9, v14
    s_waitcnt lgkmcnt(0)
    v_readfirstlane_b32 s6, v9
    s_nop 0
    s_cmp_ge_u32 s6, 4
    s_cbranch_scc1 Lbsd_82
    s_sub_u32 s3, s3, 1
    s_cbranch_scc1 Lbsd_82
    s_sleep 1
    s_branch Lbs_81
Lbsd_82:
    s_lshl_b32 s60, s101, 12
    s_add_u32 s60, s60, 114688
    v_add_u32 v14, s60, v7
    ds_read_b128 v[96:99], v14 offset:0
    ds_read_b128 v[100:103], v14 offset:1024
    ds_read_b128 v[104:107], v14 offset:2048
    ds_read_b128 v[108:111], v14 offset:3072
    v_lshlrev_b32 v26, 16, v26
    v_lshlrev_b32 v27, 16, v27
    v_mov_b32 v128, v26
    v_mov_b32 v129, v26
    v_mov_b32 v130, v26
    v_mov_b32 v131, v26
    v_mov_b32 v132, v26
    v_mov_b32 v133, v26
    v_mov_b32 v134, v26
    v_mov_b32 v135, v26
    v_mov_b32 v136, v26
    v_mov_b32 v137, v26
    v_mov_b32 v138, v26
    v_mov_b32 v139, v26
    v_mov_b32 v140, v26
    v_mov_b32 v141, v26
    v_mov_b32 v142, v26
    v_mov_b32 v143, v26
    v_mov_b32 v144, v27
    v_mov_b32 v145, v27
    v_mov_b32 v146, v27
    v_mov_b32 v147, v27
    v_mov_b32 v148, v27
    v_mov_b32 v149, v27
    v_mov_b32 v150, v27
    v_mov_b32 v151, v27
    v_mov_b32 v152, v27
    v_mov_b32 v153, v27
    v_mov_b32 v154, v27
    v_mov_b32 v155, v27
    v_mov_b32 v156, v27
    v_mov_b32 v157, v27
    v_mov_b32 v158, v27
    v_mov_b32 v159, v27
    s_waitcnt lgkmcnt(0)
    v_mov_b32 v14, 0x27e04
    v_mov_b32 v9, 1
    s_mov_b64 exec, 1
    ds_add_u32 v14, v9
    s_mov_b64 exec, -1
    s_mov_b32 s3, 0x20000
    s_waitcnt vmcnt(0)
    s_branch Lpollc_84
Lpoll_83:
    buffer_load_dword v8, v10, s[44:47], s62 offen sc1
    s_waitcnt vmcnt(0)
Lpollc_84:
    v_cmp_ne_u32 vcc, 0, v8
    s_nop 0
    s_and_b64 s[6:7], vcc, s[4:5]
    s_cmp_eq_u64 s[6:7], s[4:5]
    s_cbranch_scc1 Lpolld_85
    s_sub_u32 s3, s3, 1
    s_cbranch_scc1 Lpolld_85
    s_sleep 2
    s_branch Lpoll_83
Lpolld_85:
    s_add_u32 s61, s59, 0
    s_and_b32 s61, s61, 7
    s_lshl_b32 s61, s61, 12
    s_add_u32 s28, s48, s61
    buffer_load_dwordx4 v[64:67], v7, s[44:47], s28 offen offset:0 sc1
    s_add_u32 s61, s59, 0
    s_and_b32 s61, s61, 7
    s_lshl_b32 s61, s61, 12
    s_add_u32 s29, s49, s61
    buffer_load_dwordx4 v[68:71], v7, s[44:47], s29 offen offset:0 sc1
    s_add_u32 s61, s59, 0
    s_and_b32 s61, s61, 7
    s_lshl_b32 s61, s61, 12
    s_add_u32 s30, s50, s61
    buffer_load_dwordx4 v[72:75], v7, s[44:47], s30 offen offset:0 sc1
    s_add_u32 s61, s59, 0
    s_and_b32 s61, s61, 7
    s_lshl_b32 s61, s61, 12
    s_add_u32 s31, s51, s61
    buffer_load_dwordx4 v[76:79], v7, s[44:47], s31 offen offset:0 sc1
    buffer_load_dwordx4 v[80:83], v7, s[44:47], s28 offen offset:1024 sc1
    buffer_load_dwordx4 v[84:87], v7, s[44:47], s29 offen offset:1024 sc1
    s_add_u32 m0, s32, 32768
    s_add_u32 s61, s59, 1
    s_and_b32 s61, s61, 7
    s_lshl_b32 s61, s61, 7
    s_add_u32 s90, s33, s61
    s_add_u32 s60, s90, 0
    buffer_load_dwordx4 v16, s[24:27], s60 offen lds
    s_add_u32 m0, s32, 33792
    s_add_u32 s60, s90, 32768
    buffer_load_dwordx4 v17, s[24:27], s60 offen lds
    v_mov_b32 v12, 0xbdd2d3e8
    v_mov_b32 v13, 0xc0135761
    v_pk_mul_f32 v[240:241], v[96:97], v[96:97]
    v_pk_mul_f32 v[242:243], v[98:99], v[98:99]
    v_pk_mul_f32 v[244:245], v[100:101], v[100:101]
    v_pk_mul_f32 v[246:247], v[102:103], v[102:103]
    v_pk_mul_f32 v[248:249], v[104:105], v[104:105]
    v_pk_mul_f32 v[250:251], v[106:107], v[106:107]
    v_pk_mul_f32 v[252:253], v[108:109], v[108:109]
    v_pk_mul_f32 v[254:255], v[110:111], v[110:111]
    v_pk_fma_f32 v[240:241], v[240:241], v[12:13], v[12:13] op_sel:[0,0,1] op_sel_hi:[1,0,1]
    v_pk_fma_f32 v[242:243], v[242:243], v[12:13], v[12:13] op_sel:[0,0,1] op_sel_hi:[1,0,1]
    v_pk_fma_f32 v[244:245], v[244:245], v[12:13], v[12:13] op_sel:[0,0,1] op_sel_hi:[1,0,1]
    v_pk_fma_f32 v[246:247], v[246:247], v[12:13], v[12:13] op_sel:[0,0,1] op_sel_hi:[1,0,1]
    v_pk_fma_f32 v[248:249], v[248:249], v[12:13], v[12:13] op_sel:[0,0,1] op_sel_hi:[1,0,1]
    v_pk_fma_f32 v[250:251], v[250:251], v[12:13], v[12:13] op_sel:[0,0,1] op_sel_hi:[1,0,1]
    v_pk_fma_f32 v[252:253], v[252:253], v[12:13], v[12:13] op_sel:[0,0,1] op_sel_hi:[1,0,1]
    v_pk_fma_f32 v[254:255], v[254:255], v[12:13], v[12:13] op_sel:[0,0,1] op_sel_hi:[1,0,1]
    s_add_u32 m0, s32, 34816
    s_add_u32 s60, s90, 65536
    buffer_load_dwordx4 v16, s[24:27], s60 offen lds
    s_add_u32 m0, s32, 35840
    s_add_u32 s60, s90, 98304
    buffer_load_dwordx4 v17, s[24:27], s60 offen lds
    v_pk_mul_f32 v[240:241], v[240:241], v[96:97]
    v_pk_mul_f32 v[242:243], v[242:243], v[98:99]
    v_pk_mul_f32 v[244:245], v[244:245], v[100:101]
    v_pk_mul_f32 v[246:247], v[246:247], v[102:103]
    v_pk_mul_f32 v[248:249], v[248:249], v[104:105]
    v_pk_mul_f32 v[250:251], v[250:251], v[106:107]
    v_pk_mul_f32 v[252:253], v[252:253], v[108:109]
    v_pk_mul_f32 v[254:255], v[254:255], v[110:111]
    v_exp_f32 v240, v240
    v_exp_f32 v241, v241
    v_exp_f32 v242, v242
    v_exp_f32 v243, v243
    v_exp_f32 v244, v244
    v_exp_f32 v245, v245
    v_exp_f32 v246, v246
    v_exp_f32 v247, v247
    v_exp_f32 v248, v248
    v_exp_f32 v249, v249
    v_exp_f32 v250, v250
    s_add_u32 m0, s32, 36864
    s_add_u32 s60, s90, 131072
    buffer_load_dwordx4 v16, s[24:27], s60 offen lds
    s_add_u32 m0, s32, 37888
    s_add_u32 s60, s90, 163840
    buffer_load_dwordx4 v17, s[24:27], s60 offen lds
    v_exp_f32 v251, v251
    v_exp_f32 v252, v252
    v_exp_f32 v253, v253
    v_exp_f32 v254, v254
    v_exp_f32 v255, v255
    v_pk_add_f32 v[240:241], v[240:241], 1.0 op_sel_hi:[1,0]
    v_pk_add_f32 v[242:243], v[242:243], 1.0 op_sel_hi:[1,0]
    v_pk_add_f32 v[244:245], v[244:245], 1.0 op_sel_hi:[1,0]
    v_pk_add_f32 v[246:247], v[246:247], 1.0 op_sel_hi:[1,0]
    v_pk_add_f32 v[248:249], v[248:249], 1.0 op_sel_hi:[1,0]
    v_pk_add_f32 v[250:251], v[250:251], 1.0 op_sel_hi:[1,0]
    v_pk_add_f32 v[252:253], v[252:253], 1.0 op_sel_hi:[1,0]
    v_pk_add_f32 v[254:255], v[254:255], 1.0 op_sel_hi:[1,0]
    v_rcp_f32 v240, v240
    v_rcp_f32 v241, v241
    v_rcp_f32 v242, v242
    v_rcp_f32 v243, v243
    v_rcp_f32 v244, v244
    s_add_u32 m0, s32, 38912
    s_add_u32 s60, s90, 196608
    buffer_load_dwordx4 v16, s[24:27], s60 offen lds
    s_add_u32 m0, s32, 39936
    s_add_u32 s60, s90, 229376
    buffer_load_dwordx4 v17, s[24:27], s60 offen lds
    v_rcp_f32 v245, v245
    v_rcp_f32 v246, v246
    v_rcp_f32 v247, v247
    v_rcp_f32 v248, v248
    v_rcp_f32 v249, v249
    v_rcp_f32 v250, v250
    v_rcp_f32 v251, v251
    v_rcp_f32 v252, v252
    v_rcp_f32 v253, v253
    v_rcp_f32 v254, v254
    v_rcp_f32 v255, v255
    v_pk_mul_f32 v[96:97], v[96:97], v[240:241]
    v_pk_mul_f32 v[98:99], v[98:99], v[242:243]
    v_pk_mul_f32 v[100:101], v[100:101], v[244:245]
    v_pk_mul_f32 v[102:103], v[102:103], v[246:247]
    v_pk_mul_f32 v[104:105], v[104:105], v[248:249]
    v_pk_mul_f32 v[106:107], v[106:107], v[250:251]
    v_pk_mul_f32 v[108:109], v[108:109], v[252:253]
    v_pk_mul_f32 v[110:111], v[110:111], v[254:255]
    s_cmp_eq_u32 s56, 4
    s_cbranch_scc1 L_sp4
    ds_read_b128 v[48:51], v18 offset:0
    ds_read_b128 v[52:55], v18 offset:4096
    s_setprio 0
    ds_read_b128 v[56:59], v19 offset:0
    ds_read_b128 v[60:63], v19 offset:4096
    s_waitcnt lgkmcnt(2)
    s_waitcnt vmcnt(13)
    s_bitcmp1_b32 s39, 0
    s_cbranch_scc0 Lk_86
    v_mfma_f32_32x32x16_bf16 v[128:143], v[64:67], v[48:51], v[128:143]
    v_mfma_f32_32x32x16_bf16 v[144:159], v[64:67], v[52:55], v[144:159]
Lk_86:
    buffer_load_dwordx4 v[88:91], v7, s[44:47], s30 offen offset:1024 sc1
    s_waitcnt vmcnt(13)
    s_bitcmp1_b32 s39, 1
    s_cbranch_scc0 Lk_87
    v_mfma_f32_32x32x16_bf16 v[160:175], v[68:71], v[48:51], 0
    v_mfma_f32_32x32x16_bf16 v[176:191], v[68:71], v[52:55], 0
Lk_87:
    buffer_load_dwordx4 v[92:95], v7, s[44:47], s31 offen offset:1024 sc1
    s_waitcnt vmcnt(13)
    s_bitcmp1_b32 s39, 2
    s_cbranch_scc0 Lk_88
    v_mfma_f32_32x32x16_bf16 v[192:207], v[72:75], v[48:51], 0
    v_mfma_f32_32x32x16_bf16 v[208:223], v[72:75], v[52:55], 0
Lk_88:
    buffer_load_dwordx4 v[64:67], v7, s[44:47], s28 offen offset:2048 sc1
    s_waitcnt vmcnt(13)
    s_bitcmp1_b32 s39, 3
    s_cbranch_scc0 Lk_89
    v_mfma_f32_32x32x16_bf16 v[224:239], v[76:79], v[48:51], 0
    v_mfma_f32_32x32x16_bf16 v[240:255], v[76:79], v[52:55], 0
Lk_89:
    buffer_load_dwordx4 v[68:71], v7, s[44:47], s29 offen offset:2048 sc1
    ds_read_b128 v[48:51], v20 offset:0
    ds_read_b128 v[52:55], v20 offset:4096
    s_waitcnt lgkmcnt(2)
    s_waitcnt vmcnt(13)
    s_bitcmp1_b32 s39, 0
    s_cbranch_scc0 Lk_90
    v_mfma_f32_32x32x16_bf16 v[128:143], v[80:83], v[56:59], v[128:143]
    v_mfma_f32_32x32x16_bf16 v[144:159], v[80:83], v[60:63], v[144:159]
Lk_90:
    buffer_load_dwordx4 v[72:75], v7, s[44:47], s30 offen offset:2048 sc1
    s_waitcnt vmcnt(13)
    s_bitcmp1_b32 s39, 1
    s_cbranch_scc0 Lk_91
    v_mfma_f32_32x32x16_bf16 v[160:175], v[84:87], v[56:59], v[160:175]
    v_mfma_f32_32x32x16_bf16 v[176:191], v[84:87], v[60:63], v[176:191]
Lk_91:
    buffer_load_dwordx4 v[76:79], v7, s[44:47], s31 offen offset:2048 sc1
    s_waitcnt vmcnt(5)
    s_bitcmp1_b32 s39, 2
    s_cbranch_scc0 Lk_92
    v_mfma_f32_32x32x16_bf16 v[192:207], v[88:91], v[56:59], v[192:207]
    v_mfma_f32_32x32x16_bf16 v[208:223], v[88:91], v[60:63], v[208:223]
Lk_92:
    buffer_load_dwordx4 v[80:83], v7, s[44:47], s28 offen offset:3072 sc1
    s_waitcnt vmcnt(5)
    s_bitcmp1_b32 s39, 3
    s_cbranch_scc0 Lk_93
    v_mfma_f32_32x32x16_bf16 v[224:239], v[92:95], v[56:59], v[224:239]
    v_mfma_f32_32x32x16_bf16 v[240:255], v[92:95], v[60:63], v[240:255]
Lk_93:
    buffer_load_dwordx4 v[84:87], v7, s[44:47], s29 offen offset:3072 sc1
    ds_read_b128 v[56:59], v21 offset:0
    ds_read_b128 v[60:63], v21 offset:4096
    s_waitcnt lgkmcnt(2)
    s_waitcnt vmcnt(5)
    s_bitcmp1_b32 s39, 0
    s_cbranch_scc0 Lk_94
    v_mfma_f32_32x32x16_bf16 v[128:143], v[64:67], v[48:51], v[128:143]
    v_mfma_f32_32x32x16_bf16 v[144:159], v[64:67], v[52:55], v[144:159]
Lk_94:
    buffer_load_dwordx4 v[88:91], v7, s[44:47], s30 offen offset:3072 sc1
    s_waitcnt vmcnt(5)
    s_bitcmp1_b32 s39, 1
    s_cbranch_scc0 Lk_95
    v_mfma_f32_32x32x16_bf16 v[160:175], v[68:71], v[48:51], v[160:175]
    v_mfma_f32_32x32x16_bf16 v[176:191], v[68:71], v[52:55], v[176:191]
Lk_95:
    buffer_load_dwordx4 v[92:95], v7, s[44:47], s31 offen offset:3072 sc1
    s_add_u32 m0, s32, 65536
    s_add_u32 s61, s59, 2
    s_and_b32 s61, s61, 7
    s_lshl_b32 s61, s61, 7
    s_add_u32 s90, s33, s61
    s_add_u32 s60, s90, 0
    buffer_load_dwordx4 v16, s[24:27], s60 offen lds
    s_waitcnt vmcnt(6)
    s_bitcmp1_b32 s39, 2
    s_cbranch_scc0 Lk_96
    v_mfma_f32_32x32x16_bf16 v[192:207], v[72:75], v[48:51], v[192:207]
    v_mfma_f32_32x32x16_bf16 v[208:223], v[72:75], v[52:55], v[208:223]
Lk_96:
    s_add_u32 s61, s59, 1
    s_and_b32 s61, s61, 7
    s_lshl_b32 s61, s61, 12
    s_add_u32 s28, s48, s61
    buffer_load_dwordx4 v[64:67], v7, s[44:47], s28 offen offset:0 sc1
    s_waitcnt vmcnt(6)
    s_bitcmp1_b32 s39, 3
    s_cbranch_scc0 Lk_97
    v_mfma_f32_32x32x16_bf16 v[224:239], v[76:79], v[48:51], v[224:239]
    v_mfma_f32_32x32x16_bf16 v[240:255], v[76:79], v[52:55], v[240:255]
Lk_97:
    s_add_u32 s61, s59, 1
    s_and_b32 s61, s61, 7
    s_lshl_b32 s61, s61, 12
    s_add_u32 s29, s49, s61
    buffer_load_dwordx4 v[68:71], v7, s[44:47], s29 offen offset:0 sc1
    s_add_u32 m0, s32, 66560
    s_add_u32 s60, s90, 32768
    buffer_load_dwordx4 v17, s[24:27], s60 offen lds
    s_waitcnt vmcnt(14)
    ds_read_b128 v[48:51], v18 offset:32768
    ds_read_b128 v[52:55], v18 offset:36864
    s_waitcnt lgkmcnt(2)
    s_waitcnt vmcnt(7)
    s_bitcmp1_b32 s39, 0
    s_cbranch_scc0 Lk_98
    v_mfma_f32_32x32x16_bf16 v[128:143], v[80:83], v[56:59], v[128:143]
    v_mfma_f32_32x32x16_bf16 v[144:159], v[80:83], v[60:63], v[144:159]
Lk_98:
    s_add_u32 s61, s59, 1
    s_and_b32 s61, s61, 7
    s_lshl_b32 s61, s61, 12
    s_add_u32 s30, s50, s61
    buffer_load_dwordx4 v[72:75], v7, s[44:47], s30 offen offset:0 sc1
    s_waitcnt vmcnt(7)
    s_bitcmp1_b32 s39, 1
    s_cbranch_scc0 Lk_99
    v_mfma_f32_32x32x16_bf16 v[160:175], v[84:87], v[56:59], v[160:175]
    v_mfma_f32_32x32x16_bf16 v[176:191], v[84:87], v[60:63], v[176:191]
Lk_99:
    s_add_u32 s61, s59, 1
    s_and_b32 s61, s61, 7
    s_lshl_b32 s61, s61, 12
    s_add_u32 s31, s51, s61
    buffer_load_dwordx4 v[76:79], v7, s[44:47], s31 offen offset:0 sc1
    s_add_u32 m0, s32, 67584
    s_add_u32 s60, s90, 65536
    buffer_load_dwordx4 v16, s[24:27], s60 offen lds
    s_waitcnt vmcnt(8)
    s_bitcmp1_b32 s39, 2
    s_cbranch_scc0 Lk_100
    v_mfma_f32_32x32x16_bf16 v[192:207], v[88:91], v[56:59], v[192:207]
    v_mfma_f32_32x32x16_bf16 v[208:223], v[88:91], v[60:63], v[208:223]
Lk_100:
    buffer_load_dwordx4 v[80:83], v7, s[44:47], s28 offen offset:1024 sc1
    s_waitcnt vmcnt(8)
    s_bitcmp1_b32 s39, 3
    s_cbranch_scc0 Lk_101
    v_mfma_f32_32x32x16_bf16 v[224:239], v[92:95], v[56:59], v[224:239]
    v_mfma_f32_32x32x16_bf16 v[240:255], v[92:95], v[60:63], v[240:255]
Lk_101:
    buffer_load_dwordx4 v[84:87], v7, s[44:47], s29 offen offset:1024 sc1
    s_add_u32 m0, s32, 68608
    s_add_u32 s60, s90, 98304
    buffer_load_dwordx4 v17, s[24:27], s60 offen lds
    s_setprio 0
    ds_read_b128 v[56:59], v19 offset:32768
    ds_read_b128 v[60:63], v19 offset:36864
    s_waitcnt lgkmcnt(2)
    s_waitcnt vmcnt(8)
    s_bitcmp1_b32 s39, 0
    s_cbranch_scc0 Lk_102
    v_mfma_f32_32x32x16_bf16 v[128:143], v[64:67], v[48:51], v[128:143]
    v_mfma_f32_32x32x16_bf16 v[144:159], v[64:67], v[52:55], v[144:159]
Lk_102:
    buffer_load_dwordx4 v[88:91], v7, s[44:47], s30 offen offset:1024 sc1
    s_waitcnt vmcnt(8)
    s_bitcmp1_b32 s39, 1
    s_cbranch_scc0 Lk_103
    v_mfma_f32_32x32x16_bf16 v[160:175], v[68:71], v[48:51], v[160:175]
    v_mfma_f32_32x32x16_bf16 v[176:191], v[68:71], v[52:55], v[176:191]
Lk_103:
    buffer_load_dwordx4 v[92:95], v7, s[44:47], s31 offen offset:1024 sc1
    s_add_u32 m0, s32, 69632
    s_add_u32 s60, s90, 131072
    buffer_load_dwordx4 v16, s[24:27], s60 offen lds
    s_waitcnt vmcnt(8)
    s_bitcmp1_b32 s39, 2
    s_cbranch_scc0 Lk_104
    v_mfma_f32_32x32x16_bf16 v[192:207], v[72:75], v[48:51], v[192:207]
    v_mfma_f32_32x32x16_bf16 v[208:223], v[72:75], v[52:55], v[208:223]
Lk_104:
    buffer_load_dwordx4 v[64:67], v7, s[44:47], s28 offen offset:2048 sc1
    s_waitcnt vmcnt(8)
    s_bitcmp1_b32 s39, 3
    s_cbranch_scc0 Lk_105
    v_mfma_f32_32x32x16_bf16 v[224:239], v[76:79], v[48:51], v[224:239]
    v_mfma_f32_32x32x16_bf16 v[240:255], v[76:79], v[52:55], v[240:255]
Lk_105:
    buffer_load_dwordx4 v[68:71], v7, s[44:47], s29 offen offset:2048 sc1
    s_add_u32 m0, s32, 70656
    s_add_u32 s60, s90, 163840
    buffer_load_dwordx4 v17, s[24:27], s60 offen lds
    ds_read_b128 v[48:51], v20 offset:32768
    ds_read_b128 v[52:55], v20 offset:36864
    s_waitcnt lgkmcnt(2)
    s_waitcnt vmcnt(8)
    s_bitcmp1_b32 s39, 0
    s_cbranch_scc0 Lk_106
    v_mfma_f32_32x32x16_bf16 v[128:143], v[80:83], v[56:59], v[128:143]
    v_mfma_f32_32x32x16_bf16 v[144:159], v[80:83], v[60:63], v[144:159]
Lk_106:
    buffer_load_dwordx4 v[72:75], v7, s[44:47], s30 offen offset:2048 sc1
    s_waitcnt vmcnt(8)
    s_bitcmp1_b32 s39, 1
    s_cbranch_scc0 Lk_107
    v_mfma_f32_32x32x16_bf16 v[160:175], v[84:87], v[56:59], v[160:175]
    v_mfma_f32_32x32x16_bf16 v[176:191], v[84:87], v[60:63], v[176:191]
Lk_107:
    buffer_load_dwordx4 v[76:79], v7, s[44:47], s31 offen offset:2048 sc1
    s_add_u32 m0, s32, 71680
    s_add_u32 s60, s90, 196608
    buffer_load_dwordx4 v16, s[24:27], s60 offen lds
    s_waitcnt vmcnt(8)
    s_bitcmp1_b32 s39, 2
    s_cbranch_scc0 Lk_108
    v_mfma_f32_32x32x16_bf16 v[192:207], v[88:91], v[56:59], v[192:207]
    v_mfma_f32_32x32x16_bf16 v[208:223], v[88:91], v[60:63], v[208:223]
Lk_108:
    buffer_load_dwordx4 v[80:83], v7, s[44:47], s28 offen offset:3072 sc1
    s_waitcnt vmcnt(8)
    s_bitcmp1_b32 s39, 3
    s_cbranch_scc0 Lk_109
    v_mfma_f32_32x32x16_bf16 v[224:239], v[92:95], v[56:59], v[224:239]
    v_mfma_f32_32x32x16_bf16 v[240:255], v[92:95], v[60:63], v[240:255]
Lk_109:
    buffer_load_dwordx4 v[84:87], v7, s[44:47], s29 offen offset:3072 sc1
    s_add_u32 m0, s32, 72704
    s_add_u32 s60, s90, 229376
    buffer_load_dwordx4 v17, s[24:27], s60 offen lds
    ds_read_b128 v[56:59], v21 offset:32768
    ds_read_b128 v[60:63], v21 offset:36864
    s_waitcnt lgkmcnt(2)
    s_waitcnt vmcnt(8)
    s_bitcmp1_b32 s39, 0
    s_cbranch_scc0 Lk_110
    v_mfma_f32_32x32x16_bf16 v[128:143], v[64:67], v[48:51], v[128:143]
    v_mfma_f32_32x32x16_bf16 v[144:159], v[64:67], v[52:55], v[144:159]
Lk_110:
    buffer_load_dwordx4 v[88:91], v7, s[44:47], s30 offen offset:3072 sc1
    s_waitcnt vmcnt(8)
    s_bitcmp1_b32 s39, 1
    s_cbranch_scc0 Lk_111
    v_mfma_f32_32x32x16_bf16 v[160:175], v[68:71], v[48:51], v[160:175]
    v_mfma_f32_32x32x16_bf16 v[176:191], v[68:71], v[52:55], v[176:191]
Lk_111:
    buffer_load_dwordx4 v[92:95], v7, s[44:47], s31 offen offset:3072 sc1
    s_add_u32 m0, s32, 0
    s_add_u32 s61, s59, 3
    s_and_b32 s61, s61, 7
    s_lshl_b32 s61, s61, 7
    s_add_u32 s90, s33, s61
    s_add_u32 s60, s90, 0
    buffer_load_dwordx4 v16, s[24:27], s60 offen lds
    s_waitcnt vmcnt(8)
    s_bitcmp1_b32 s39, 2
    s_cbranch_scc0 Lk_112
    v_mfma_f32_32x32x16_bf16 v[192:207], v[72:75], v[48:51], v[192:207]
    v_mfma_f32_32x32x16_bf16 v[208:223], v[72:75], v[52:55], v[208:223]
Lk_112:
    s_add_u32 s61, s59, 2
    s_and_b32 s61, s61, 7
    s_lshl_b32 s61, s61, 12
    s_add_u32 s28, s48, s61
    buffer_load_dwordx4 v[64:67], v7, s[44:47], s28 offen offset:0 sc1
    s_waitcnt vmcnt(8)
    s_bitcmp1_b32 s39, 3
    s_cbranch_scc0 Lk_113
    v_mfma_f32_32x32x16_bf16 v[224:239], v[76:79], v[48:51], v[224:239]
    v_mfma_f32_32x32x16_bf16 v[240:255], v[76:79], v[52:55], v[240:255]
Lk_113:
    s_add_u32 s61, s59, 2
    s_and_b32 s61, s61, 7
    s_lshl_b32 s61, s61, 12
    s_add_u32 s29, s49, s61
    buffer_load_dwordx4 v[68:71], v7, s[44:47], s29 offen offset:0 sc1
    s_add_u32 m0, s32, 1024
    s_add_u32 s60, s90, 32768
    buffer_load_dwordx4 v17, s[24:27], s60 offen lds
    s_waitcnt vmcnt(6)
    ds_read_b128 v[48:51], v22 offset:0
    ds_read_b128 v[52:55], v22 offset:4096
    s_waitcnt lgkmcnt(2)
    s_waitcnt vmcnt(8)
    s_bitcmp1_b32 s39, 0
    s_cbranch_scc0 Lk_114
    v_mfma_f32_32x32x16_bf16 v[128:143], v[80:83], v[56:59], v[128:143]
    v_mfma_f32_32x32x16_bf16 v[144:159], v[80:83], v[60:63], v[144:159]
Lk_114:
    s_add_u32 s61, s59, 2
    s_and_b32 s61, s61, 7
    s_lshl_b32 s61, s61, 12
    s_add_u32 s30, s50, s61
    buffer_load_dwordx4 v[72:75], v7, s[44:47], s30 offen offset:0 sc1
    s_waitcnt vmcnt(8)
    s_bitcmp1_b32 s39, 1
    s_cbranch_scc0 Lk_115
    v_mfma_f32_32x32x16_bf16 v[160:175], v[84:87], v[56:59], v[160:175]
    v_mfma_f32_32x32x16_bf16 v[176:191], v[84:87], v[60:63], v[176:191]
Lk_115:
    s_add_u32 s61, s59, 2
    s_and_b32 s61, s61, 7
    s_lshl_b32 s61, s61, 12
    s_add_u32 s31, s51, s61
    buffer_load_dwordx4 v[76:79], v7, s[44:47], s31 offen offset:0 sc1
    s_add_u32 m0, s32, 2048
    s_add_u32 s60, s90, 65536
    buffer_load_dwordx4 v16, s[24:27], s60 offen lds
    s_waitcnt vmcnt(8)
    s_bitcmp1_b32 s39, 2
    s_cbranch_scc0 Lk_116
    v_mfma_f32_32x32x16_bf16 v[192:207], v[88:91], v[56:59], v[192:207]
    v_mfma_f32_32x32x16_bf16 v[208:223], v[88:91], v[60:63], v[208:223]
Lk_116:
    buffer_load_dwordx4 v[80:83], v7, s[44:47], s28 offen offset:1024 sc1
    s_waitcnt vmcnt(8)
    s_bitcmp1_b32 s39, 3
    s_cbranch_scc0 Lk_117
    v_mfma_f32_32x32x16_bf16 v[224:239], v[92:95], v[56:59], v[224:239]
    v_mfma_f32_32x32x16_bf16 v[240:255], v[92:95], v[60:63], v[240:255]
Lk_117:
    buffer_load_dwordx4 v[84:87], v7, s[44:47], s29 offen offset:1024 sc1
    s_add_u32 m0, s32, 3072
    s_add_u32 s60, s90, 98304
    buffer_load_dwordx4 v17, s[24:27], s60 offen lds
    s_setprio 0
    ds_read_b128 v[56:59], v23 offset:0
    ds_read_b128 v[60:63], v23 offset:4096
    s_waitcnt lgkmcnt(2)
    s_waitcnt vmcnt(8)
    s_bitcmp1_b32 s39, 0
    s_cbranch_scc0 Lk_118
    v_mfma_f32_32x32x16_bf16 v[128:143], v[64:67], v[48:51], v[128:143]
    v_mfma_f32_32x32x16_bf16 v[144:159], v[64:67], v[52:55], v[144:159]
Lk_118:
    buffer_load_dwordx4 v[88:91], v7, s[44:47], s30 offen offset:1024 sc1
    s_waitcnt vmcnt(8)
    s_bitcmp1_b32 s39, 1
    s_cbranch_scc0 Lk_119
    v_mfma_f32_32x32x16_bf16 v[160:175], v[68:71], v[48:51], v[160:175]
    v_mfma_f32_32x32x16_bf16 v[176:191], v[68:71], v[52:55], v[176:191]
Lk_119:
    buffer_load_dwordx4 v[92:95], v7, s[44:47], s31 offen offset:1024 sc1
    s_add_u32 m0, s32, 4096
    s_add_u32 s60, s90, 131072
    buffer_load_dwordx4 v16, s[24:27], s60 offen lds
    s_waitcnt vmcnt(8)
    s_bitcmp1_b32 s39, 2
    s_cbranch_scc0 Lk_120
    v_mfma_f32_32x32x16_bf16 v[192:207], v[72:75], v[48:51], v[192:207]
    v_mfma_f32_32x32x16_bf16 v[208:223], v[72:75], v[52:55], v[208:223]
Lk_120:
    buffer_load_dwordx4 v[64:67], v7, s[44:47], s28 offen offset:2048 sc1
    s_waitcnt vmcnt(8)
    s_bitcmp1_b32 s39, 3
    s_cbranch_scc0 Lk_121
    v_mfma_f32_32x32x16_bf16 v[224:239], v[76:79], v[48:51], v[224:239]
    v_mfma_f32_32x32x16_bf16 v[240:255], v[76:79], v[52:55], v[240:255]
Lk_121:
    buffer_load_dwordx4 v[68:71], v7, s[44:47], s29 offen offset:2048 sc1
    s_add_u32 m0, s32, 5120
    s_add_u32 s60, s90, 163840
    buffer_load_dwordx4 v17, s[24:27], s60 offen lds
    ds_read_b128 v[48:51], v24 offset:0
    ds_read_b128 v[52:55], v24 offset:4096
    s_waitcnt lgkmcnt(2)
    s_waitcnt vmcnt(8)
    s_bitcmp1_b32 s39, 0
    s_cbranch_scc0 Lk_122
    v_mfma_f32_32x32x16_bf16 v[128:143], v[80:83], v[56:59], v[128:143]
    v_mfma_f32_32x32x16_bf16 v[144:159], v[80:83], v[60:63], v[144:159]
Lk_122:
    buffer_load_dwordx4 v[72:75], v7, s[44:47], s30 offen offset:2048 sc1
    s_waitcnt vmcnt(8)
    s_bitcmp1_b32 s39, 1
    s_cbranch_scc0 Lk_123
    v_mfma_f32_32x32x16_bf16 v[160:175], v[84:87], v[56:59], v[160:175]
    v_mfma_f32_32x32x16_bf16 v[176:191], v[84:87], v[60:63], v[176:191]
Lk_123:
    buffer_load_dwordx4 v[76:79], v7, s[44:47], s31 offen offset:2048 sc1
    s_add_u32 m0, s32, 6144
    s_add_u32 s60, s90, 196608
    buffer_load_dwordx4 v16, s[24:27], s60 offen lds
    s_waitcnt vmcnt(8)
    s_bitcmp1_b32 s39, 2
    s_cbranch_scc0 Lk_124
    v_mfma_f32_32x32x16_bf16 v[192:207], v[88:91], v[56:59], v[192:207]
    v_mfma_f32_32x32x16_bf16 v[208:223], v[88:91], v[60:63], v[208:223]
Lk_124:
    buffer_load_dwordx4 v[80:83], v7, s[44:47], s28 offen offset:3072 sc1
    s_waitcnt vmcnt(8)
    s_bitcmp1_b32 s39, 3
    s_cbranch_scc0 Lk_125
    v_mfma_f32_32x32x16_bf16 v[224:239], v[92:95], v[56:59], v[224:239]
    v_mfma_f32_32x32x16_bf16 v[240:255], v[92:95], v[60:63], v[240:255]
Lk_125:
    buffer_load_dwordx4 v[84:87], v7, s[44:47], s29 offen offset:3072 sc1
    s_add_u32 m0, s32, 7168
    s_add_u32 s60, s90, 229376
    buffer_load_dwordx4 v17, s[24:27], s60 offen lds
    ds_read_b128 v[56:59], v25 offset:0
    ds_read_b128 v[60:63], v25 offset:4096
    s_waitcnt lgkmcnt(2)
    s_waitcnt vmcnt(8)
    s_bitcmp1_b32 s39, 0
    s_cbranch_scc0 Lk_126
    v_mfma_f32_32x32x16_bf16 v[128:143], v[64:67], v[48:51], v[128:143]
    v_mfma_f32_32x32x16_bf16 v[144:159], v[64:67], v[52:55], v[144:159]
Lk_126:
    buffer_load_dwordx4 v[88:91], v7, s[44:47], s30 offen offset:3072 sc1
    s_waitcnt vmcnt(8)
    s_bitcmp1_b32 s39, 1
    s_cbranch_scc0 Lk_127
    v_mfma_f32_32x32x16_bf16 v[160:175], v[68:71], v[48:51], v[160:175]
    v_mfma_f32_32x32x16_bf16 v[176:191], v[68:71], v[52:55], v[176:191]
Lk_127:
    buffer_load_dwordx4 v[92:95], v7, s[44:47], s31 offen offset:3072 sc1
    s_add_u32 m0, s32, 32768
    s_add_u32 s61, s59, 4
    s_and_b32 s61, s61, 7
    s_lshl_b32 s61, s61, 7
    s_add_u32 s90, s33, s61
    s_add_u32 s60, s90, 0
    buffer_load_dwordx4 v16, s[24:27], s60 offen lds
    s_waitcnt vmcnt(8)
    s_bitcmp1_b32 s39, 2
    s_cbranch_scc0 Lk_128
    v_mfma_f32_32x32x16_bf16 v[192:207], v[72:75], v[48:51], v[192:207]
    v_mfma_f32_32x32x16_bf16 v[208:223], v[72:75], v[52:55], v[208:223]
Lk_128:
    s_add_u32 s61, s59, 3
    s_and_b32 s61, s61, 7
    s_lshl_b32 s61, s61, 12
    s_add_u32 s28, s48, s61
    buffer_load_dwordx4 v[64:67], v7, s[44:47], s28 offen offset:0 sc1
    s_waitcnt vmcnt(8)
    s_bitcmp1_b32 s39, 3
    s_cbranch_scc0 Lk_129
    v_mfma_f32_32x32x16_bf16 v[224:239], v[76:79], v[48:51], v[224:239]
    v_mfma_f32_32x32x16_bf16 v[240:255], v[76:79], v[52:55], v[240:255]
Lk_129:
    s_add_u32 s61, s59, 3
    s_and_b32 s61, s61, 7
    s_lshl_b32 s61, s61, 12
    s_add_u32 s29, s49, s61
    buffer_load_dwordx4 v[68:71], v7, s[44:47], s29 offen offset:0 sc1
    s_add_u32 m0, s32, 33792
    s_add_u32 s60, s90, 32768
    buffer_load_dwordx4 v17, s[24:27], s60 offen lds
    s_waitcnt vmcnt(6)
    ds_read_b128 v[48:51], v18 offset:0
    ds_read_b128 v[52:55], v18 offset:4096
    s_waitcnt lgkmcnt(2)
    s_waitcnt vmcnt(8)
    s_bitcmp1_b32 s39, 0
    s_cbranch_scc0 Lk_130
    v_mfma_f32_32x32x16_bf16 v[128:143], v[80:83], v[56:59], v[128:143]
    v_mfma_f32_32x32x16_bf16 v[144:159], v[80:83], v[60:63], v[144:159]
Lk_130:
    s_add_u32 s61, s59, 3
    s_and_b32 s61, s61, 7
    s_lshl_b32 s61, s61, 12
    s_add_u32 s30, s50, s61
    buffer_load_dwordx4 v[72:75], v7, s[44:47], s30 offen offset:0 sc1
    s_waitcnt vmcnt(8)
    s_bitcmp1_b32 s39, 1
    s_cbranch_scc0 Lk_131
    v_mfma_f32_32x32x16_bf16 v[160:175], v[84:87], v[56:59], v[160:175]
    v_mfma_f32_32x32x16_bf16 v[176:191], v[84:87], v[60:63], v[176:191]
Lk_131:
    s_add_u32 s61, s59, 3
    s_and_b32 s61, s61, 7
    s_lshl_b32 s61, s61, 12
    s_add_u32 s31, s51, s61
    buffer_load_dwordx4 v[76:79], v7, s[44:47], s31 offen offset:0 sc1
    s_add_u32 m0, s32, 34816
    s_add_u32 s60, s90, 65536
    buffer_load_dwordx4 v16, s[24:27], s60 offen lds
    s_waitcnt vmcnt(8)
    s_bitcmp1_b32 s39, 2
    s_cbranch_scc0 Lk_132
    v_mfma_f32_32x32x16_bf16 v[192:207], v[88:91], v[56:59], v[192:207]
    v_mfma_f32_32x32x16_bf16 v[208:223], v[88:91], v[60:63], v[208:223]
Lk_132:
    buffer_load_dwordx4 v[80:83], v7, s[44:47], s28 offen offset:1024 sc1
    s_waitcnt vmcnt(8)
    s_bitcmp1_b32 s39, 3
    s_cbranch_scc0 Lk_133
    v_mfma_f32_32x32x16_bf16 v[224:239], v[92:95], v[56:59], v[224:239]
    v_mfma_f32_32x32x16_bf16 v[240:255], v[92:95], v[60:63], v[240:255]
Lk_133:
    buffer_load_dwordx4 v[84:87], v7, s[44:47], s29 offen offset:1024 sc1
    s_add_u32 m0, s32, 35840
    s_add_u32 s60, s90, 98304
    buffer_load_dwordx4 v17, s[24:27], s60 offen lds
    s_setprio 0
    ds_read_b128 v[56:59], v19 offset:0
    ds_read_b128 v[60:63], v19 offset:4096
    s_waitcnt lgkmcnt(2)
    s_waitcnt vmcnt(8)
    s_bitcmp1_b32 s39, 0
    s_cbranch_scc0 Lk_134
    v_mfma_f32_32x32x16_bf16 v[128:143], v[64:67], v[48:51], v[128:143]
    v_mfma_f32_32x32x16_bf16 v[144:159], v[64:67], v[52:55], v[144:159]
Lk_134:
    buffer_load_dwordx4 v[88:91], v7, s[44:47], s30 offen offset:1024 sc1
    s_waitcnt vmcnt(8)
    s_bitcmp1_b32 s39, 1
    s_cbranch_scc0 Lk_135
    v_mfma_f32_32x32x16_bf16 v[160:175], v[68:71], v[48:51], v[160:175]
    v_mfma_f32_32x32x16_bf16 v[176:191], v[68:71], v[52:55], v[176:191]
Lk_135:
    buffer_load_dwordx4 v[92:95], v7, s[44:47], s31 offen offset:1024 sc1
    s_add_u32 m0, s32, 36864
    s_add_u32 s60, s90, 131072
    buffer_load_dwordx4 v16, s[24:27], s60 offen lds
    s_waitcnt vmcnt(8)
    s_bitcmp1_b32 s39, 2
    s_cbranch_scc0 Lk_136
    v_mfma_f32_32x32x16_bf16 v[192:207], v[72:75], v[48:51], v[192:207]
    v_mfma_f32_32x32x16_bf16 v[208:223], v[72:75], v[52:55], v[208:223]
Lk_136:
    buffer_load_dwordx4 v[64:67], v7, s[44:47], s28 offen offset:2048 sc1
    s_waitcnt vmcnt(8)
    s_bitcmp1_b32 s39, 3
    s_cbranch_scc0 Lk_137
    v_mfma_f32_32x32x16_bf16 v[224:239], v[76:79], v[48:51], v[224:239]
    v_mfma_f32_32x32x16_bf16 v[240:255], v[76:79], v[52:55], v[240:255]
Lk_137:
    buffer_load_dwordx4 v[68:71], v7, s[44:47], s29 offen offset:2048 sc1
    s_add_u32 m0, s32, 37888
    s_add_u32 s60, s90, 163840
    buffer_load_dwordx4 v17, s[24:27], s60 offen lds
    ds_read_b128 v[48:51], v20 offset:0
    ds_read_b128 v[52:55], v20 offset:4096
    s_waitcnt lgkmcnt(2)
    s_waitcnt vmcnt(8)
    s_bitcmp1_b32 s39, 0
    s_cbranch_scc0 Lk_138
    v_mfma_f32_32x32x16_bf16 v[128:143], v[80:83], v[56:59], v[128:143]
    v_mfma_f32_32x32x16_bf16 v[144:159], v[80:83], v[60:63], v[144:159]
Lk_138:
    buffer_load_dwordx4 v[72:75], v7, s[44:47], s30 offen offset:2048 sc1
    s_waitcnt vmcnt(8)
    s_bitcmp1_b32 s39, 1
    s_cbranch_scc0 Lk_139
    v_mfma_f32_32x32x16_bf16 v[160:175], v[84:87], v[56:59], v[160:175]
    v_mfma_f32_32x32x16_bf16 v[176:191], v[84:87], v[60:63], v[176:191]
Lk_139:
    buffer_load_dwordx4 v[76:79], v7, s[44:47], s31 offen offset:2048 sc1
    s_add_u32 m0, s32, 38912
    s_add_u32 s60, s90, 196608
    buffer_load_dwordx4 v16, s[24:27], s60 offen lds
    s_waitcnt vmcnt(8)
    s_bitcmp1_b32 s39, 2
    s_cbranch_scc0 Lk_140
    v_mfma_f32_32x32x16_bf16 v[192:207], v[88:91], v[56:59], v[192:207]
    v_mfma_f32_32x32x16_bf16 v[208:223], v[88:91], v[60:63], v[208:223]
Lk_140:
    buffer_load_dwordx4 v[80:83], v7, s[44:47], s28 offen offset:3072 sc1
    s_waitcnt vmcnt(8)
    s_bitcmp1_b32 s39, 3
    s_cbranch_scc0 Lk_141
    v_mfma_f32_32x32x16_bf16 v[224:239], v[92:95], v[56:59], v[224:239]
    v_mfma_f32_32x32x16_bf16 v[240:255], v[92:95], v[60:63], v[240:255]
Lk_141:
    buffer_load_dwordx4 v[84:87], v7, s[44:47], s29 offen offset:3072 sc1
    s_add_u32 m0, s32, 39936
    s_add_u32 s60, s90, 229376
    buffer_load_dwordx4 v17, s[24:27], s60 offen lds
    ds_read_b128 v[56:59], v21 offset:0
    ds_read_b128 v[60:63], v21 offset:4096
    s_waitcnt lgkmcnt(2)
    s_waitcnt vmcnt(8)
    s_bitcmp1_b32 s39, 0
    s_cbranch_scc0 Lk_142
    v_mfma_f32_32x32x16_bf16 v[128:143], v[64:67], v[48:51], v[128:143]
    v_mfma_f32_32x32x16_bf16 v[144:159], v[64:67], v[52:55], v[144:159]
Lk_142:
    buffer_load_dwordx4 v[88:91], v7, s[44:47], s30 offen offset:3072 sc1
    s_waitcnt vmcnt(8)
    s_bitcmp1_b32 s39, 1
    s_cbranch_scc0 Lk_143
    v_mfma_f32_32x32x16_bf16 v[160:175], v[68:71], v[48:51], v[160:175]
    v_mfma_f32_32x32x16_bf16 v[176:191], v[68:71], v[52:55], v[176:191]
Lk_143:
    buffer_load_dwordx4 v[92:95], v7, s[44:47], s31 offen offset:3072 sc1
    s_add_u32 m0, s32, 65536
    s_add_u32 s61, s59, 5
    s_and_b32 s61, s61, 7
    s_lshl_b32 s61, s61, 7
    s_add_u32 s90, s33, s61
    s_add_u32 s60, s90, 0
    buffer_load_dwordx4 v16, s[24:27], s60 offen lds
    s_waitcnt vmcnt(8)
    s_bitcmp1_b32 s39, 2
    s_cbranch_scc0 Lk_144
    v_mfma_f32_32x32x16_bf16 v[192:207], v[72:75], v[48:51], v[192:207]
    v_mfma_f32_32x32x16_bf16 v[208:223], v[72:75], v[52:55], v[208:223]
Lk_144:
    s_add_u32 s61, s59, 4
    s_and_b32 s61, s61, 7
    s_lshl_b32 s61, s61, 12
    s_add_u32 s28, s48, s61
    buffer_load_dwordx4 v[64:67], v7, s[44:47], s28 offen offset:0 sc1
    s_waitcnt vmcnt(8)
    s_bitcmp1_b32 s39, 3
    s_cbranch_scc0 Lk_145
    v_mfma_f32_32x32x16_bf16 v[224:239], v[76:79], v[48:51], v[224:239]
    v_mfma_f32_32x32x16_bf16 v[240:255], v[76:79], v[52:55], v[240:255]
Lk_145:
    s_add_u32 s61, s59, 4
    s_and_b32 s61, s61, 7
    s_lshl_b32 s61, s61, 12
    s_add_u32 s29, s49, s61
    buffer_load_dwordx4 v[68:71], v7, s[44:47], s29 offen offset:0 sc1
    s_add_u32 m0, s32, 66560
    s_add_u32 s60, s90, 32768
    buffer_load_dwordx4 v17, s[24:27], s60 offen lds
    s_waitcnt vmcnt(6)
    ds_read_b128 v[48:51], v18 offset:32768
    ds_read_b128 v[52:55], v18 offset:36864
    s_waitcnt lgkmcnt(2)
    s_waitcnt vmcnt(8)
    s_bitcmp1_b32 s39, 0
    s_cbranch_scc0 Lk_146
    v_mfma_f32_32x32x16_bf16 v[128:143], v[80:83], v[56:59], v[128:143]
    v_mfma_f32_32x32x16_bf16 v[144:159], v[80:83], v[60:63], v[144:159]
Lk_146:
    s_add_u32 s61, s59, 4
    s_and_b32 s61, s61, 7
    s_lshl_b32 s61, s61, 12
    s_add_u32 s30, s50, s61
    buffer_load_dwordx4 v[72:75], v7, s[44:47], s30 offen offset:0 sc1
    s_waitcnt vmcnt(8)
    s_bitcmp1_b32 s39, 1
    s_cbranch_scc0 Lk_147
    v_mfma_f32_32x32x16_bf16 v[160:175], v[84:87], v[56:59], v[160:175]
    v_mfma_f32_32x32x16_bf16 v[176:191], v[84:87], v[60:63], v[176:191]
Lk_147:
    s_add_u32 s61, s59, 4
    s_and_b32 s61, s61, 7
    s_lshl_b32 s61, s61, 12
    s_add_u32 s31, s51, s61
    buffer_load_dwordx4 v[76:79], v7, s[44:47], s31 offen offset:0 sc1
    s_add_u32 m0, s32, 67584
    s_add_u32 s60, s90, 65536
    buffer_load_dwordx4 v16, s[24:27], s60 offen lds
    s_waitcnt vmcnt(8)
    s_bitcmp1_b32 s39, 2
    s_cbranch_scc0 Lk_148
    v_mfma_f32_32x32x16_bf16 v[192:207], v[88:91], v[56:59], v[192:207]
    v_mfma_f32_32x32x16_bf16 v[208:223], v[88:91], v[60:63], v[208:223]
Lk_148:
    buffer_load_dwordx4 v[80:83], v7, s[44:47], s28 offen offset:1024 sc1
    s_waitcnt vmcnt(8)
    s_bitcmp1_b32 s39, 3
    s_cbranch_scc0 Lk_149
    v_mfma_f32_32x32x16_bf16 v[224:239], v[92:95], v[56:59], v[224:239]
    v_mfma_f32_32x32x16_bf16 v[240:255], v[92:95], v[60:63], v[240:255]
Lk_149:
    buffer_load_dwordx4 v[84:87], v7, s[44:47], s29 offen offset:1024 sc1
    s_add_u32 m0, s32, 68608
    s_add_u32 s60, s90, 98304
    buffer_load_dwordx4 v17, s[24:27], s60 offen lds
    s_setprio 0
    ds_read_b128 v[56:59], v19 offset:32768
    ds_read_b128 v[60:63], v19 offset:36864
    s_waitcnt lgkmcnt(2)
    s_waitcnt vmcnt(8)
    s_bitcmp1_b32 s39, 0
    s_cbranch_scc0 Lk_150
    v_mfma_f32_32x32x16_bf16 v[128:143], v[64:67], v[48:51], v[128:143]
    v_mfma_f32_32x32x16_bf16 v[144:159], v[64:67], v[52:55], v[144:159]
Lk_150:
    buffer_load_dwordx4 v[88:91], v7, s[44:47], s30 offen offset:1024 sc1
    s_waitcnt vmcnt(8)
    s_bitcmp1_b32 s39, 1
    s_cbranch_scc0 Lk_151
    v_mfma_f32_32x32x16_bf16 v[160:175], v[68:71], v[48:51], v[160:175]
    v_mfma_f32_32x32x16_bf16 v[176:191], v[68:71], v[52:55], v[176:191]
Lk_151:
    buffer_load_dwordx4 v[92:95], v7, s[44:47], s31 offen offset:1024 sc1
    s_add_u32 m0, s32, 69632
    s_add_u32 s60, s90, 131072
    buffer_load_dwordx4 v16, s[24:27], s60 offen lds
    s_waitcnt vmcnt(8)
    s_bitcmp1_b32 s39, 2
    s_cbranch_scc0 Lk_152
    v_mfma_f32_32x32x16_bf16 v[192:207], v[72:75], v[48:51], v[192:207]
    v_mfma_f32_32x32x16_bf16 v[208:223], v[72:75], v[52:55], v[208:223]
Lk_152:
    buffer_load_dwordx4 v[64:67], v7, s[44:47], s28 offen offset:2048 sc1
    s_waitcnt vmcnt(8)
    s_bitcmp1_b32 s39, 3
    s_cbranch_scc0 Lk_153
    v_mfma_f32_32x32x16_bf16 v[224:239], v[76:79], v[48:51], v[224:239]
    v_mfma_f32_32x32x16_bf16 v[240:255], v[76:79], v[52:55], v[240:255]
Lk_153:
    buffer_load_dwordx4 v[68:71], v7, s[44:47], s29 offen offset:2048 sc1
    s_add_u32 m0, s32, 70656
    s_add_u32 s60, s90, 163840
    buffer_load_dwordx4 v17, s[24:27], s60 offen lds
    ds_read_b128 v[48:51], v20 offset:32768
    ds_read_b128 v[52:55], v20 offset:36864
    s_waitcnt lgkmcnt(2)
    s_waitcnt vmcnt(8)
    s_bitcmp1_b32 s39, 0
    s_cbranch_scc0 Lk_154
    v_mfma_f32_32x32x16_bf16 v[128:143], v[80:83], v[56:59], v[128:143]
    v_mfma_f32_32x32x16_bf16 v[144:159], v[80:83], v[60:63], v[144:159]
Lk_154:
    buffer_load_dwordx4 v[72:75], v7, s[44:47], s30 offen offset:2048 sc1
    s_waitcnt vmcnt(8)
    s_bitcmp1_b32 s39, 1
    s_cbranch_scc0 Lk_155
    v_mfma_f32_32x32x16_bf16 v[160:175], v[84:87], v[56:59], v[160:175]
    v_mfma_f32_32x32x16_bf16 v[176:191], v[84:87], v[60:63], v[176:191]
Lk_155:
    buffer_load_dwordx4 v[76:79], v7, s[44:47], s31 offen offset:2048 sc1
    s_add_u32 m0, s32, 71680
    s_add_u32 s60, s90, 196608
    buffer_load_dwordx4 v16, s[24:27], s60 offen lds
    s_waitcnt vmcnt(8)
    s_bitcmp1_b32 s39, 2
    s_cbranch_scc0 Lk_156
    v_mfma_f32_32x32x16_bf16 v[192:207], v[88:91], v[56:59], v[192:207]
    v_mfma_f32_32x32x16_bf16 v[208:223], v[88:91], v[60:63], v[208:223]
Lk_156:
    buffer_load_dwordx4 v[80:83], v7, s[44:47], s28 offen offset:3072 sc1
    s_waitcnt vmcnt(8)
    s_bitcmp1_b32 s39, 3
    s_cbranch_scc0 Lk_157
    v_mfma_f32_32x32x16_bf16 v[224:239], v[92:95], v[56:59], v[224:239]
    v_mfma_f32_32x32x16_bf16 v[240:255], v[92:95], v[60:63], v[240:255]
Lk_157:
    buffer_load_dwordx4 v[84:87], v7, s[44:47], s29 offen offset:3072 sc1
    s_add_u32 m0, s32, 72704
    s_add_u32 s60, s90, 229376
    buffer_load_dwordx4 v17, s[24:27], s60 offen lds
    ds_read_b128 v[56:59], v21 offset:32768
    ds_read_b128 v[60:63], v21 offset:36864
    s_waitcnt lgkmcnt(2)
    s_waitcnt vmcnt(8)
    s_bitcmp1_b32 s39, 0
    s_cbranch_scc0 Lk_158
    v_mfma_f32_32x32x16_bf16 v[128:143], v[64:67], v[48:51], v[128:143]
    v_mfma_f32_32x32x16_bf16 v[144:159], v[64:67], v[52:55], v[144:159]
Lk_158:
    buffer_load_dwordx4 v[88:91], v7, s[44:47], s30 offen offset:3072 sc1
    s_waitcnt vmcnt(8)
    s_bitcmp1_b32 s39, 1
    s_cbranch_scc0 Lk_159
    v_mfma_f32_32x32x16_bf16 v[160:175], v[68:71], v[48:51], v[160:175]
    v_mfma_f32_32x32x16_bf16 v[176:191], v[68:71], v[52:55], v[176:191]
Lk_159:
    buffer_load_dwordx4 v[92:95], v7, s[44:47], s31 offen offset:3072 sc1
    s_add_u32 m0, s32, 0
    s_add_u32 s61, s59, 6
    s_and_b32 s61, s61, 7
    s_lshl_b32 s61, s61, 7
    s_add_u32 s90, s33, s61
    s_add_u32 s60, s90, 0
    buffer_load_dwordx4 v16, s[24:27], s60 offen lds
    s_waitcnt vmcnt(8)
    s_bitcmp1_b32 s39, 2
    s_cbranch_scc0 Lk_160
    v_mfma_f32_32x32x16_bf16 v[192:207], v[72:75], v[48:51], v[192:207]
    v_mfma_f32_32x32x16_bf16 v[208:223], v[72:75], v[52:55], v[208:223]
Lk_160:
    s_add_u32 s61, s59, 5
    s_and_b32 s61, s61, 7
    s_lshl_b32 s61, s61, 12
    s_add_u32 s28, s48, s61
    buffer_load_dwordx4 v[64:67], v7, s[44:47], s28 offen offset:0 sc1
    s_waitcnt vmcnt(8)
    s_bitcmp1_b32 s39, 3
    s_cbranch_scc0 Lk_161
    v_mfma_f32_32x32x16_bf16 v[224:239], v[76:79], v[48:51], v[224:239]
    v_mfma_f32_32x32x16_bf16 v[240:255], v[76:79], v[52:55], v[240:255]
Lk_161:
    s_add_u32 s61, s59, 5
    s_and_b32 s61, s61, 7
    s_lshl_b32 s61, s61, 12
    s_add_u32 s29, s49, s61
    buffer_load_dwordx4 v[68:71], v7, s[44:47], s29 offen offset:0 sc1
    s_add_u32 m0, s32, 1024
    s_add_u32 s60, s90, 32768
    buffer_load_dwordx4 v17, s[24:27], s60 offen lds
    s_waitcnt vmcnt(6)
    ds_read_b128 v[48:51], v22 offset:0
    ds_read_b128 v[52:55], v22 offset:4096
    s_waitcnt lgkmcnt(2)
    s_waitcnt vmcnt(8)
    s_bitcmp1_b32 s39, 0
    s_cbranch_scc0 Lk_162
    v_mfma_f32_32x32x16_bf16 v[128:143], v[80:83], v[56:59], v[128:143]
    v_mfma_f32_32x32x16_bf16 v[144:159], v[80:83], v[60:63], v[144:159]
Lk_162:
    s_add_u32 s61, s59, 5
    s_and_b32 s61, s61, 7
    s_lshl_b32 s61, s61, 12
    s_add_u32 s30, s50, s61
    buffer_load_dwordx4 v[72:75], v7, s[44:47], s30 offen offset:0 sc1
    s_waitcnt vmcnt(8)
    s_bitcmp1_b32 s39, 1
    s_cbranch_scc0 Lk_163
    v_mfma_f32_32x32x16_bf16 v[160:175], v[84:87], v[56:59], v[160:175]
    v_mfma_f32_32x32x16_bf16 v[176:191], v[84:87], v[60:63], v[176:191]
Lk_163:
    s_add_u32 s61, s59, 5
    s_and_b32 s61, s61, 7
    s_lshl_b32 s61, s61, 12
    s_add_u32 s31, s51, s61
    buffer_load_dwordx4 v[76:79], v7, s[44:47], s31 offen offset:0 sc1
    s_add_u32 m0, s32, 2048
    s_add_u32 s60, s90, 65536
    buffer_load_dwordx4 v16, s[24:27], s60 offen lds
    s_waitcnt vmcnt(8)
    s_bitcmp1_b32 s39, 2
    s_cbranch_scc0 Lk_164
    v_mfma_f32_32x32x16_bf16 v[192:207], v[88:91], v[56:59], v[192:207]
    v_mfma_f32_32x32x16_bf16 v[208:223], v[88:91], v[60:63], v[208:223]
Lk_164:
    buffer_load_dwordx4 v[80:83], v7, s[44:47], s28 offen offset:1024 sc1
    s_waitcnt vmcnt(8)
    s_bitcmp1_b32 s39, 3
    s_cbranch_scc0 Lk_165
    v_mfma_f32_32x32x16_bf16 v[224:239], v[92:95], v[56:59], v[224:239]
    v_mfma_f32_32x32x16_bf16 v[240:255], v[92:95], v[60:63], v[240:255]
Lk_165:
    buffer_load_dwordx4 v[84:87], v7, s[44:47], s29 offen offset:1024 sc1
    s_add_u32 m0, s32, 3072
    s_add_u32 s60, s90, 98304
    buffer_load_dwordx4 v17, s[24:27], s60 offen lds
    s_setprio 2
    ds_read_b128 v[56:59], v23 offset:0
    ds_read_b128 v[60:63], v23 offset:4096
    s_waitcnt lgkmcnt(2)
    s_waitcnt vmcnt(8)
    s_bitcmp1_b32 s39, 0
    s_cbranch_scc0 Lk_166
    v_mfma_f32_32x32x16_bf16 v[128:143], v[64:67], v[48:51], v[128:143]
    v_mfma_f32_32x32x16_bf16 v[144:159], v[64:67], v[52:55], v[144:159]
Lk_166:
    buffer_load_dwordx4 v[88:91], v7, s[44:47], s30 offen offset:1024 sc1
    s_waitcnt vmcnt(8)
    s_bitcmp1_b32 s39, 1
    s_cbranch_scc0 Lk_167
    v_mfma_f32_32x32x16_bf16 v[160:175], v[68:71], v[48:51], v[160:175]
    v_mfma_f32_32x32x16_bf16 v[176:191], v[68:71], v[52:55], v[176:191]
Lk_167:
    buffer_load_dwordx4 v[92:95], v7, s[44:47], s31 offen offset:1024 sc1
    s_add_u32 m0, s32, 4096
    s_add_u32 s60, s90, 131072
    buffer_load_dwordx4 v16, s[24:27], s60 offen lds
    s_waitcnt vmcnt(8)
    s_bitcmp1_b32 s39, 2
    s_cbranch_scc0 Lk_168
    v_mfma_f32_32x32x16_bf16 v[192:207], v[72:75], v[48:51], v[192:207]
    v_mfma_f32_32x32x16_bf16 v[208:223], v[72:75], v[52:55], v[208:223]
Lk_168:
    buffer_load_dwordx4 v[64:67], v7, s[44:47], s28 offen offset:2048 sc1
    s_waitcnt vmcnt(8)
    s_bitcmp1_b32 s39, 3
    s_cbranch_scc0 Lk_169
    v_mfma_f32_32x32x16_bf16 v[224:239], v[76:79], v[48:51], v[224:239]
    v_mfma_f32_32x32x16_bf16 v[240:255], v[76:79], v[52:55], v[240:255]
Lk_169:
    buffer_load_dwordx4 v[68:71], v7, s[44:47], s29 offen offset:2048 sc1
    s_add_u32 m0, s32, 5120
    s_add_u32 s60, s90, 163840
    buffer_load_dwordx4 v17, s[24:27], s60 offen lds
    s_lshl_b32 s63, s54, 8
    s_add_u32 s63, s63, 9216
    buffer_load_dword v15, v4, s[44:47], s63 offen sc1
    ds_read_b128 v[48:51], v24 offset:0
    ds_read_b128 v[52:55], v24 offset:4096
    s_waitcnt lgkmcnt(2)
    s_waitcnt vmcnt(9)
    s_bitcmp1_b32 s39, 0
    s_cbranch_scc0 Lk_170
    v_mfma_f32_32x32x16_bf16 v[128:143], v[80:83], v[56:59], v[128:143]
    v_mfma_f32_32x32x16_bf16 v[144:159], v[80:83], v[60:63], v[144:159]
Lk_170:
    buffer_load_dwordx4 v[72:75], v7, s[44:47], s30 offen offset:2048 sc1
    s_waitcnt vmcnt(9)
    s_bitcmp1_b32 s39, 1
    s_cbranch_scc0 Lk_171
    v_mfma_f32_32x32x16_bf16 v[160:175], v[84:87], v[56:59], v[160:175]
    v_mfma_f32_32x32x16_bf16 v[176:191], v[84:87], v[60:63], v[176:191]
Lk_171:
    buffer_load_dwordx4 v[76:79], v7, s[44:47], s31 offen offset:2048 sc1
    s_add_u32 m0, s32, 6144
    s_add_u32 s60, s90, 196608
    buffer_load_dwordx4 v16, s[24:27], s60 offen lds
    s_waitcnt vmcnt(9)
    s_bitcmp1_b32 s39, 2
    s_cbranch_scc0 Lk_172
    v_mfma_f32_32x32x16_bf16 v[192:207], v[88:91], v[56:59], v[192:207]
    v_mfma_f32_32x32x16_bf16 v[208:223], v[88:91], v[60:63], v[208:223]
Lk_172:
    buffer_load_dwordx4 v[80:83], v7, s[44:47], s28 offen offset:3072 sc1
    s_waitcnt vmcnt(9)
    s_bitcmp1_b32 s39, 3
    s_cbranch_scc0 Lk_173
    v_mfma_f32_32x32x16_bf16 v[224:239], v[92:95], v[56:59], v[224:239]
    v_mfma_f32_32x32x16_bf16 v[240:255], v[92:95], v[60:63], v[240:255]
Lk_173:
    buffer_load_dwordx4 v[84:87], v7, s[44:47], s29 offen offset:3072 sc1
    s_add_u32 m0, s32, 7168
    s_add_u32 s60, s90, 229376
    buffer_load_dwordx4 v17, s[24:27], s60 offen lds
    ds_read_b128 v[56:59], v25 offset:0
    ds_read_b128 v[60:63], v25 offset:4096
    s_waitcnt lgkmcnt(2)
    s_waitcnt vmcnt(9)
    s_bitcmp1_b32 s39, 0
    s_cbranch_scc0 Lk_174
    v_mfma_f32_32x32x16_bf16 v[128:143], v[64:67], v[48:51], v[128:143]
    v_mfma_f32_32x32x16_bf16 v[144:159], v[64:67], v[52:55], v[144:159]
Lk_174:
    buffer_load_dwordx4 v[88:91], v7, s[44:47], s30 offen offset:3072 sc1
    s_waitcnt vmcnt(9)
    s_bitcmp1_b32 s39, 1
    s_cbranch_scc0 Lk_175
    v_mfma_f32_32x32x16_bf16 v[160:175], v[68:71], v[48:51], v[160:175]
    v_mfma_f32_32x32x16_bf16 v[176:191], v[68:71], v[52:55], v[176:191]
Lk_175:
    buffer_load_dwordx4 v[92:95], v7, s[44:47], s31 offen offset:3072 sc1
    s_add_u32 m0, s32, 32768
    s_add_u32 s61, s59, 7
    s_and_b32 s61, s61, 7
    s_lshl_b32 s61, s61, 7
    s_add_u32 s90, s33, s61
    s_add_u32 s60, s90, 0
    buffer_load_dwordx4 v16, s[24:27], s60 offen lds
    s_waitcnt vmcnt(8)
    s_bitcmp1_b32 s39, 2
    s_cbranch_scc0 Lk_176
    v_mfma_f32_32x32x16_bf16 v[192:207], v[72:75], v[48:51], v[192:207]
    v_mfma_f32_32x32x16_bf16 v[208:223], v[72:75], v[52:55], v[208:223]
Lk_176:
    s_add_u32 s61, s59, 6
    s_and_b32 s61, s61, 7
    s_lshl_b32 s61, s61, 12
    s_add_u32 s28, s48, s61
    buffer_load_dwordx4 v[64:67], v7, s[44:47], s28 offen offset:0 sc1
    s_waitcnt vmcnt(8)
    s_bitcmp1_b32 s39, 3
    s_cbranch_scc0 Lk_177
    v_mfma_f32_32x32x16_bf16 v[224:239], v[76:79], v[48:51], v[224:239]
    v_mfma_f32_32x32x16_bf16 v[240:255], v[76:79], v[52:55], v[240:255]
Lk_177:
    s_add_u32 s61, s59, 6
    s_and_b32 s61, s61, 7
    s_lshl_b32 s61, s61, 12
    s_add_u32 s29, s49, s61
    buffer_load_dwordx4 v[68:71], v7, s[44:47], s29 offen offset:0 sc1
    s_add_u32 m0, s32, 33792
    s_add_u32 s60, s90, 32768
    buffer_load_dwordx4 v17, s[24:27], s60 offen lds
    s_waitcnt vmcnt(6)
    ds_read_b128 v[48:51], v18 offset:0
    ds_read_b128 v[52:55], v18 offset:4096
    s_waitcnt lgkmcnt(2)
    s_waitcnt vmcnt(8)
    s_bitcmp1_b32 s39, 0
    s_cbranch_scc0 Lk_178
    v_mfma_f32_32x32x16_bf16 v[128:143], v[80:83], v[56:59], v[128:143]
    v_mfma_f32_32x32x16_bf16 v[144:159], v[80:83], v[60:63], v[144:159]
Lk_178:
    s_add_u32 s61, s59, 6
    s_and_b32 s61, s61, 7
    s_lshl_b32 s61, s61, 12
    s_add_u32 s30, s50, s61
    buffer_load_dwordx4 v[72:75], v7, s[44:47], s30 offen offset:0 sc1
    s_waitcnt vmcnt(8)
    s_bitcmp1_b32 s39, 1
    s_cbranch_scc0 Lk_179
    v_mfma_f32_32x32x16_bf16 v[160:175], v[84:87], v[56:59], v[160:175]
    v_mfma_f32_32x32x16_bf16 v[176:191], v[84:87], v[60:63], v[176:191]
Lk_179:
    s_add_u32 s61, s59, 6
    s_and_b32 s61, s61, 7
    s_lshl_b32 s61, s61, 12
    s_add_u32 s31, s51, s61
    buffer_load_dwordx4 v[76:79], v7, s[44:47], s31 offen offset:0 sc1
    s_add_u32 m0, s32, 34816
    s_add_u32 s60, s90, 65536
    buffer_load_dwordx4 v16, s[24:27], s60 offen lds
    s_waitcnt vmcnt(8)
    s_bitcmp1_b32 s39, 2
    s_cbranch_scc0 Lk_180
    v_mfma_f32_32x32x16_bf16 v[192:207], v[88:91], v[56:59], v[192:207]
    v_mfma_f32_32x32x16_bf16 v[208:223], v[88:91], v[60:63], v[208:223]
Lk_180:
    buffer_load_dwordx4 v[80:83], v7, s[44:47], s28 offen offset:1024 sc1
    s_waitcnt vmcnt(8)
    s_bitcmp1_b32 s39, 3
    s_cbranch_scc0 Lk_181
    v_mfma_f32_32x32x16_bf16 v[224:239], v[92:95], v[56:59], v[224:239]
    v_mfma_f32_32x32x16_bf16 v[240:255], v[92:95], v[60:63], v[240:255]
Lk_181:
    buffer_load_dwordx4 v[84:87], v7, s[44:47], s29 offen offset:1024 sc1
    s_add_u32 m0, s32, 35840
    s_add_u32 s60, s90, 98304
    buffer_load_dwordx4 v17, s[24:27], s60 offen lds
    s_setprio 2
    ds_read_b128 v[56:59], v19 offset:0
    ds_read_b128 v[60:63], v19 offset:4096
    s_waitcnt lgkmcnt(2)
    s_waitcnt vmcnt(8)
    s_bitcmp1_b32 s39, 0
    s_cbranch_scc0 Lk_182
    v_mfma_f32_32x32x16_bf16 v[128:143], v[64:67], v[48:51], v[128:143]
    v_mfma_f32_32x32x16_bf16 v[144:159], v[64:67], v[52:55], v[144:159]
Lk_182:
    buffer_load_dwordx4 v[88:91], v7, s[44:47], s30 offen offset:1024 sc1
    s_waitcnt vmcnt(8)
    s_bitcmp1_b32 s39, 1
    s_cbranch_scc0 Lk_183
    v_mfma_f32_32x32x16_bf16 v[160:175], v[68:71], v[48:51], v[160:175]
    v_mfma_f32_32x32x16_bf16 v[176:191], v[68:71], v[52:55], v[176:191]
Lk_183:
    buffer_load_dwordx4 v[92:95], v7, s[44:47], s31 offen offset:1024 sc1
    s_add_u32 m0, s32, 36864
    s_add_u32 s60, s90, 131072
    buffer_load_dwordx4 v16, s[24:27], s60 offen lds
    s_waitcnt vmcnt(8)
    s_bitcmp1_b32 s39, 2
    s_cbranch_scc0 Lk_184
    v_mfma_f32_32x32x16_bf16 v[192:207], v[72:75], v[48:51], v[192:207]
    v_mfma_f32_32x32x16_bf16 v[208:223], v[72:75], v[52:55], v[208:223]
Lk_184:
    buffer_load_dwordx4 v[64:67], v7, s[44:47], s28 offen offset:2048 sc1
    s_waitcnt vmcnt(8)
    s_bitcmp1_b32 s39, 3
    s_cbranch_scc0 Lk_185
    v_mfma_f32_32x32x16_bf16 v[224:239], v[76:79], v[48:51], v[224:239]
    v_mfma_f32_32x32x16_bf16 v[240:255], v[76:79], v[52:55], v[240:255]
Lk_185:
    buffer_load_dwordx4 v[68:71], v7, s[44:47], s29 offen offset:2048 sc1
    s_add_u32 m0, s32, 37888
    s_add_u32 s60, s90, 163840
    buffer_load_dwordx4 v17, s[24:27], s60 offen lds
    s_mov_b32 s4, -1
    s_mov_b32 s5, 0x7fff
    s_mov_b32 s3, 0x20000
    s_waitcnt vmcnt(24)
    s_branch Lpollc_187
Lpoll_186:
    buffer_load_dword v15, v4, s[44:47], s63 offen sc1
    s_waitcnt vmcnt(0)
Lpollc_187:
    v_cmp_ne_u32 vcc, 0, v15
    s_nop 0
    s_and_b64 s[6:7], vcc, s[4:5]
    s_cmp_eq_u64 s[6:7], s[4:5]
    s_cbranch_scc1 Lpolld_188
    s_sub_u32 s3, s3, 1
    s_cbranch_scc1 Lpolld_188
    s_sleep 2
    s_branch Lpoll_186
Lpolld_188:
    v_lshlrev_b32 v4, 2, v2
    v_mov_b32 v8, 0x27e04
    s_mov_b32 s3, 0x100000
Lbs_189:
    ds_read_b32 v9, v8
    s_waitcnt lgkmcnt(0)
    v_readfirstlane_b32 s6, v9
    s_nop 0
    s_cmp_ge_u32 s6, 8
    s_cbranch_scc1 Lbsd_190
    s_sub_u32 s3, s3, 1
    s_cbranch_scc1 Lbsd_190
    s_sleep 1
    s_branch Lbs_189
Lbsd_190:
    ds_read_b128 v[48:51], v20 offset:0
    ds_read_b128 v[52:55], v20 offset:4096
    s_waitcnt lgkmcnt(2)
    s_waitcnt vmcnt(8)
    s_bitcmp1_b32 s39, 0
    s_cbranch_scc0 Lk_191
    v_mfma_f32_32x32x16_bf16 v[128:143], v[80:83], v[56:59], v[128:143]
    v_mfma_f32_32x32x16_bf16 v[144:159], v[80:83], v[60:63], v[144:159]
Lk_191:
    buffer_load_dwordx4 v[72:75], v7, s[44:47], s30 offen offset:2048 sc1
    s_waitcnt vmcnt(8)
    s_bitcmp1_b32 s39, 1
    s_cbranch_scc0 Lk_192
    v_mfma_f32_32x32x16_bf16 v[160:175], v[84:87], v[56:59], v[160:175]
    v_mfma_f32_32x32x16_bf16 v[176:191], v[84:87], v[60:63], v[176:191]
Lk_192:
    buffer_load_dwordx4 v[76:79], v7, s[44:47], s31 offen offset:2048 sc1
    s_add_u32 m0, s32, 38912
    s_add_u32 s60, s90, 196608
    buffer_load_dwordx4 v16, s[24:27], s60 offen lds
    s_waitcnt vmcnt(8)
    s_bitcmp1_b32 s39, 2
    s_cbranch_scc0 Lk_193
    v_mfma_f32_32x32x16_bf16 v[192:207], v[88:91], v[56:59], v[192:207]
    v_mfma_f32_32x32x16_bf16 v[208:223], v[88:91], v[60:63], v[208:223]
Lk_193:
    buffer_load_dwordx4 v[80:83], v7, s[44:47], s28 offen offset:3072 sc1
    s_waitcnt vmcnt(8)
    s_bitcmp1_b32 s39, 3
    s_cbranch_scc0 Lk_194
    v_mfma_f32_32x32x16_bf16 v[224:239], v[92:95], v[56:59], v[224:239]
    v_mfma_f32_32x32x16_bf16 v[240:255], v[92:95], v[60:63], v[240:255]
Lk_194:
    buffer_load_dwordx4 v[84:87], v7, s[44:47], s29 offen offset:3072 sc1
    s_add_u32 m0, s32, 39936
    s_add_u32 s60, s90, 229376
    buffer_load_dwordx4 v17, s[24:27], s60 offen lds
    ds_read_b128 v[56:59], v21 offset:0
    ds_read_b128 v[60:63], v21 offset:4096
    s_waitcnt lgkmcnt(2)
    s_waitcnt vmcnt(8)
    s_bitcmp1_b32 s39, 0
    s_cbranch_scc0 Lk_195
    v_mfma_f32_32x32x16_bf16 v[128:143], v[64:67], v[48:51], v[128:143]
    v_mfma_f32_32x32x16_bf16 v[144:159], v[64:67], v[52:55], v[144:159]
Lk_195:
    buffer_load_dwordx4 v[88:91], v7, s[44:47], s30 offen offset:3072 sc1
    s_waitcnt vmcnt(8)
    s_bitcmp1_b32 s39, 1
    s_cbranch_scc0 Lk_196
    v_mfma_f32_32x32x16_bf16 v[160:175], v[68:71], v[48:51], v[160:175]
    v_mfma_f32_32x32x16_bf16 v[176:191], v[68:71], v[52:55], v[176:191]
Lk_196:
    buffer_load_dwordx4 v[92:95], v7, s[44:47], s31 offen offset:3072 sc1
    s_add_u32 m0, s93, 102400
    s_add_u32 s60, s92, 102400
    buffer_load_dwordx4 v7, s[44:47], s60 offen sc1 lds
    s_waitcnt vmcnt(8)
    s_bitcmp1_b32 s39, 2
    s_cbranch_scc0 Lk_197
    v_mfma_f32_32x32x16_bf16 v[192:207], v[72:75], v[48:51], v[192:207]
    v_mfma_f32_32x32x16_bf16 v[208:223], v[72:75], v[52:55], v[208:223]
Lk_197:
    s_add_u32 s61, s59, 7
    s_and_b32 s61, s61, 7
    s_lshl_b32 s61, s61, 12
    s_add_u32 s29, s49, s61
    buffer_load_dwordx4 v[64:67], v7, s[44:47], s29 offen offset:0 sc1
    s_waitcnt vmcnt(8)
    s_bitcmp1_b32 s39, 3
    s_cbranch_scc0 Lk_198
    v_mfma_f32_32x32x16_bf16 v[224:239], v[76:79], v[48:51], v[224:239]
    v_mfma_f32_32x32x16_bf16 v[240:255], v[76:79], v[52:55], v[240:255]
Lk_198:
    buffer_load_dwordx4 v[68:71], v7, s[44:47], s29 offen offset:1024 sc1
    s_add_u32 m0, s93, 103424
    s_add_u32 s60, s92, 103424
    buffer_load_dwordx4 v7, s[44:47], s60 offen sc1 lds
    s_waitcnt vmcnt(6)
    ds_read_b128 v[48:51], v18 offset:32768
    ds_read_b128 v[52:55], v18 offset:36864
    s_waitcnt lgkmcnt(2)
    s_waitcnt vmcnt(8)
    s_bitcmp1_b32 s39, 0
    s_cbranch_scc0 Lk_199
    v_mfma_f32_32x32x16_bf16 v[128:143], v[80:83], v[56:59], v[128:143]
    v_mfma_f32_32x32x16_bf16 v[144:159], v[80:83], v[60:63], v[144:159]
Lk_199:
    buffer_load_dwordx4 v[72:75], v7, s[44:47], s29 offen offset:2048 sc1
    s_waitcnt vmcnt(8)
    s_bitcmp1_b32 s39, 1
    s_cbranch_scc0 Lk_200
    v_mfma_f32_32x32x16_bf16 v[160:175], v[84:87], v[56:59], v[160:175]
    v_mfma_f32_32x32x16_bf16 v[176:191], v[84:87], v[60:63], v[176:191]
Lk_200:
    buffer_load_dwordx4 v[76:79], v7, s[44:47], s29 offen offset:3072 sc1
    s_add_u32 m0, s93, 104448
    s_add_u32 s60, s92, 104448
    buffer_load_dwordx4 v7, s[44:47], s60 offen sc1 lds
    s_waitcnt vmcnt(8)
    s_bitcmp1_b32 s39, 2
    s_cbranch_scc0 Lk_201
    v_mfma_f32_32x32x16_bf16 v[192:207], v[88:91], v[56:59], v[192:207]
    v_mfma_f32_32x32x16_bf16 v[208:223], v[88:91], v[60:63], v[208:223]
Lk_201:
    s_add_u32 s61, s59, 7
    s_and_b32 s61, s61, 7
    s_lshl_b32 s61, s61, 12
    s_add_u32 s30, s50, s61
    buffer_load_dwordx4 v[80:83], v7, s[44:47], s30 offen offset:0 sc1
    s_waitcnt vmcnt(8)
    s_bitcmp1_b32 s39, 3
    s_cbranch_scc0 Lk_202
    v_mfma_f32_32x32x16_bf16 v[224:239], v[92:95], v[56:59], v[224:239]
    v_mfma_f32_32x32x16_bf16 v[240:255], v[92:95], v[60:63], v[240:255]
Lk_202:
    buffer_load_dwordx4 v[84:87], v7, s[44:47], s30 offen offset:1024 sc1
    s_add_u32 m0, s93, 105472
    s_add_u32 s60, s92, 105472
    buffer_load_dwordx4 v7, s[44:47], s60 offen sc1 lds
    s_setprio 2
    ds_read_b128 v[56:59], v19 offset:32768
    ds_read_b128 v[60:63], v19 offset:36864
    ds_read_b128 v[32:35], v20 offset:32768
    ds_read_b128 v[36:39], v20 offset:36864
    ds_read_b128 v[8:11], v21 offset:32768
    ds_read_b128 v[12:15], v21 offset:36864
    v_add_u32 v28, s32, v7
    v_add_u32 v29, 0x10000, v28
    s_waitcnt lgkmcnt(6)
    s_waitcnt vmcnt(8)
    s_bitcmp1_b32 s39, 1
    s_cbranch_scc0 Lk_203
    v_mfma_f32_32x32x16_bf16 v[160:175], v[64:67], v[48:51], v[160:175]
    v_mfma_f32_32x32x16_bf16 v[176:191], v[64:67], v[52:55], v[176:191]
Lk_203:
    buffer_load_dwordx4 v[88:91], v7, s[44:47], s30 offen offset:2048 sc1
    s_waitcnt lgkmcnt(4)
    s_waitcnt vmcnt(8)
    s_bitcmp1_b32 s39, 1
    s_cbranch_scc0 Lk_204
    v_mfma_f32_32x32x16_bf16 v[160:175], v[68:71], v[56:59], v[160:175]
    v_mfma_f32_32x32x16_bf16 v[176:191], v[68:71], v[60:63], v[176:191]
Lk_204:
    buffer_load_dwordx4 v[92:95], v7, s[44:47], s30 offen offset:3072 sc1
    s_add_u32 m0, s93, 106496
    s_add_u32 s60, s92, 106496
    buffer_load_dwordx4 v7, s[44:47], s60 offen sc1 lds
    s_waitcnt lgkmcnt(2)
    s_waitcnt vmcnt(8)
    s_bitcmp1_b32 s39, 1
    s_cbranch_scc0 Lk_205
    v_mfma_f32_32x32x16_bf16 v[160:175], v[72:75], v[32:35], v[160:175]
    v_mfma_f32_32x32x16_bf16 v[176:191], v[72:75], v[36:39], v[176:191]
Lk_205:
    s_add_u32 s61, s59, 7
    s_and_b32 s61, s61, 7
    s_lshl_b32 s61, s61, 12
    s_add_u32 s31, s51, s61
    buffer_load_dwordx4 v[64:67], v7, s[44:47], s31 offen offset:0 sc1
    s_waitcnt lgkmcnt(0)
    s_waitcnt vmcnt(8)
    s_bitcmp1_b32 s39, 1
    s_cbranch_scc0 Lk_206
    v_mfma_f32_32x32x16_bf16 v[160:175], v[76:79], v[8:11], v[160:175]
    v_mfma_f32_32x32x16_bf16 v[176:191], v[76:79], v[12:15], v[176:191]
Lk_206:
    buffer_load_dwordx4 v[68:71], v7, s[44:47], s31 offen offset:1024 sc1
    s_add_u32 m0, s93, 122880
    s_add_u32 s60, s92, 122880
    buffer_load_dwordx4 v7, s[44:47], s60 offen sc1 lds
    s_waitcnt vmcnt(8)
    s_bitcmp1_b32 s39, 2
    s_cbranch_scc0 Lk_207
    v_mfma_f32_32x32x16_bf16 v[192:207], v[80:83], v[48:51], v[192:207]
    v_mfma_f32_32x32x16_bf16 v[208:223], v[80:83], v[52:55], v[208:223]
Lk_207:
    buffer_load_dwordx4 v[72:75], v7, s[44:47], s31 offen offset:2048 sc1
    s_waitcnt vmcnt(8)
    s_bitcmp1_b32 s39, 2
    s_cbranch_scc0 Lk_208
    v_mfma_f32_32x32x16_bf16 v[192:207], v[84:87], v[56:59], v[192:207]
    v_mfma_f32_32x32x16_bf16 v[208:223], v[84:87], v[60:63], v[208:223]
Lk_208:
    buffer_load_dwordx4 v[76:79], v7, s[44:47], s31 offen offset:3072 sc1
    s_add_u32 m0, s93, 123904
    s_add_u32 s60, s92, 123904
    buffer_load_dwordx4 v7, s[44:47], s60 offen sc1 lds
    ds_write_b128 v28, v[160:163] offset:0
    ds_write_b128 v28, v[164:167] offset:1024
    ds_write_b128 v28, v[168:171] offset:2048
    s_waitcnt vmcnt(8)
    s_bitcmp1_b32 s39, 2
    s_cbranch_scc0 Lk_209
    v_mfma_f32_32x32x16_bf16 v[192:207], v[88:91], v[32:35], v[192:207]
    v_mfma_f32_32x32x16_bf16 v[208:223], v[88:91], v[36:39], v[208:223]
Lk_209:
    s_add_u32 s61, s59, 7
    s_and_b32 s61, s61, 7
    s_lshl_b32 s61, s61, 12
    s_add_u32 s28, s48, s61
    buffer_load_dwordx4 v[80:83], v7, s[44:47], s28 offen offset:0 sc1
    ds_write_b128 v28, v[172:175] offset:3072
    ds_write_b128 v28, v[176:179] offset:4096
    ds_write_b128 v28, v[180:183] offset:5120
    s_waitcnt vmcnt(8)
    s_bitcmp1_b32 s39, 2
    s_cbranch_scc0 Lk_210
    v_mfma_f32_32x32x16_bf16 v[192:207], v[92:95], v[8:11], v[192:207]
    v_mfma_f32_32x32x16_bf16 v[208:223], v[92:95], v[12:15], v[208:223]
Lk_210:
    buffer_load_dwordx4 v[84:87], v7, s[44:47], s28 offen offset:1024 sc1
    s_add_u32 m0, s93, 124928
    s_add_u32 s60, s92, 124928
    buffer_load_dwordx4 v7, s[44:47], s60 offen sc1 lds
    ds_write_b128 v28, v[184:187] offset:6144
    ds_write_b128 v28, v[188:191] offset:7168
    s_waitcnt vmcnt(8)
    s_bitcmp1_b32 s39, 3
    s_cbranch_scc0 Lk_211
    v_mfma_f32_32x32x16_bf16 v[224:239], v[64:67], v[48:51], v[224:239]
    v_mfma_f32_32x32x16_bf16 v[240:255], v[64:67], v[52:55], v[240:255]
Lk_211:
    buffer_load_dwordx4 v[88:91], v7, s[44:47], s28 offen offset:2048 sc1
    s_waitcnt vmcnt(8)
    s_bitcmp1_b32 s39, 3
    s_cbranch_scc0 Lk_212
    v_mfma_f32_32x32x16_bf16 v[224:239], v[68:71], v[56:59], v[224:239]
    v_mfma_f32_32x32x16_bf16 v[240:255], v[68:71], v[60:63], v[240:255]
Lk_212:
    buffer_load_dwordx4 v[92:95], v7, s[44:47], s28 offen offset:3072 sc1
    s_add_u32 m0, s93, 125952
    s_add_u32 s60, s92, 125952
    buffer_load_dwordx4 v7, s[44:47], s60 offen sc1 lds
    ds_write_b128 v28, v[192:195] offset:32768
    ds_write_b128 v28, v[196:199] offset:33792
    ds_write_b128 v28, v[200:203] offset:34816
    s_waitcnt vmcnt(8)
    s_bitcmp1_b32 s39, 3
    s_cbranch_scc0 Lk_213
    v_mfma_f32_32x32x16_bf16 v[224:239], v[72:75], v[32:35], v[224:239]
    v_mfma_f32_32x32x16_bf16 v[240:255], v[72:75], v[36:39], v[240:255]
Lk_213:
    ds_write_b128 v28, v[204:207] offset:35840
    ds_write_b128 v28, v[208:211] offset:36864
    ds_write_b128 v28, v[212:215] offset:37888
    s_waitcnt vmcnt(7)
    s_bitcmp1_b32 s39, 3
    s_cbranch_scc0 Lk_214
    v_mfma_f32_32x32x16_bf16 v[224:239], v[76:79], v[8:11], v[224:239]
    v_mfma_f32_32x32x16_bf16 v[240:255], v[76:79], v[12:15], v[240:255]
Lk_214:
    s_add_u32 m0, s93, 126976
    s_add_u32 s60, s92, 126976
    buffer_load_dwordx4 v7, s[44:47], s60 offen sc1 lds
    ds_write_b128 v28, v[216:219] offset:38912
    ds_write_b128 v28, v[220:223] offset:39936
    s_waitcnt vmcnt(6)
    s_bitcmp1_b32 s39, 0
    s_cbranch_scc0 Lk_215
    v_mfma_f32_32x32x16_bf16 v[128:143], v[80:83], v[48:51], v[128:143]
    v_mfma_f32_32x32x16_bf16 v[144:159], v[80:83], v[52:55], v[144:159]
Lk_215:
    s_waitcnt vmcnt(5)
    s_bitcmp1_b32 s39, 0
    s_cbranch_scc0 Lk_216
    v_mfma_f32_32x32x16_bf16 v[128:143], v[84:87], v[56:59], v[128:143]
    v_mfma_f32_32x32x16_bf16 v[144:159], v[84:87], v[60:63], v[144:159]
Lk_216:
    ds_write_b128 v29, v[224:227] offset:0
    ds_write_b128 v29, v[228:231] offset:1024
    ds_write_b128 v29, v[232:235] offset:2048
    s_waitcnt vmcnt(3)
    s_bitcmp1_b32 s39, 0
    s_cbranch_scc0 Lk_217
    v_mfma_f32_32x32x16_bf16 v[128:143], v[88:91], v[32:35], v[128:143]
    v_mfma_f32_32x32x16_bf16 v[144:159], v[88:91], v[36:39], v[144:159]
Lk_217:
    ds_write_b128 v29, v[236:239] offset:3072
    ds_write_b128 v29, v[240:243] offset:4096
    ds_write_b128 v29, v[244:247] offset:5120
    s_waitcnt vmcnt(2)
    s_bitcmp1_b32 s39, 0
    s_cbranch_scc0 Lk_218
    v_mfma_f32_32x32x16_bf16 v[128:143], v[92:95], v[8:11], v[128:143]
    v_mfma_f32_32x32x16_bf16 v[144:159], v[92:95], v[12:15], v[144:159]
Lk_218:
    ds_write_b128 v29, v[248:251] offset:6144
    ds_write_b128 v29, v[252:255] offset:7168
    s_branch L_spdone
L_sp4:
    ds_read_b128 v[48:51], v18 offset:0
    ds_read_b128 v[52:55], v18 offset:4096
    s_setprio 0
    ds_read_b128 v[56:59], v19 offset:0
    ds_read_b128 v[60:63], v19 offset:4096
    s_waitcnt lgkmcnt(2)
    s_waitcnt vmcnt(13)
    v_mfma_f32_32x32x16_bf16 v[128:143], v[64:67], v[48:51], v[128:143]
    v_mfma_f32_32x32x16_bf16 v[144:159], v[64:67], v[52:55], v[144:159]
    buffer_load_dwordx4 v[88:91], v7, s[44:47], s30 offen offset:1024 sc1
    s_waitcnt vmcnt(13)
    v_mfma_f32_32x32x16_bf16 v[160:175], v[68:71], v[48:51], 0
    v_mfma_f32_32x32x16_bf16 v[176:191], v[68:71], v[52:55], 0
    buffer_load_dwordx4 v[92:95], v7, s[44:47], s31 offen offset:1024 sc1
    s_waitcnt vmcnt(13)
    v_mfma_f32_32x32x16_bf16 v[192:207], v[72:75], v[48:51], 0
    v_mfma_f32_32x32x16_bf16 v[208:223], v[72:75], v[52:55], 0
    buffer_load_dwordx4 v[64:67], v7, s[44:47], s28 offen offset:2048 sc1
    s_waitcnt vmcnt(13)
    v_mfma_f32_32x32x16_bf16 v[224:239], v[76:79], v[48:51], 0
    v_mfma_f32_32x32x16_bf16 v[240:255], v[76:79], v[52:55], 0
    buffer_load_dwordx4 v[68:71], v7, s[44:47], s29 offen offset:2048 sc1
    ds_read_b128 v[48:51], v20 offset:0
    ds_read_b128 v[52:55], v20 offset:4096
    s_waitcnt lgkmcnt(2)
    s_waitcnt vmcnt(13)
    v_mfma_f32_32x32x16_bf16 v[128:143], v[80:83], v[56:59], v[128:143]
    v_mfma_f32_32x32x16_bf16 v[144:159], v[80:83], v[60:63], v[144:159]
    buffer_load_dwordx4 v[72:75], v7, s[44:47], s30 offen offset:2048 sc1
    s_waitcnt vmcnt(13)
    v_mfma_f32_32x32x16_bf16 v[160:175], v[84:87], v[56:59], v[160:175]
    v_mfma_f32_32x32x16_bf16 v[176:191], v[84:87], v[60:63], v[176:191]
    buffer_load_dwordx4 v[76:79], v7, s[44:47], s31 offen offset:2048 sc1
    s_waitcnt vmcnt(5)
    v_mfma_f32_32x32x16_bf16 v[192:207], v[88:91], v[56:59], v[192:207]
    v_mfma_f32_32x32x16_bf16 v[208:223], v[88:91], v[60:63], v[208:223]
    buffer_load_dwordx4 v[80:83], v7, s[44:47], s28 offen offset:3072 sc1
    s_waitcnt vmcnt(5)
    v_mfma_f32_32x32x16_bf16 v[224:239], v[92:95], v[56:59], v[224:239]
    v_mfma_f32_32x32x16_bf16 v[240:255], v[92:95], v[60:63], v[240:255]
    buffer_load_dwordx4 v[84:87], v7, s[44:47], s29 offen offset:3072 sc1
    ds_read_b128 v[56:59], v21 offset:0
    ds_read_b128 v[60:63], v21 offset:4096
    s_waitcnt lgkmcnt(2)
    s_waitcnt vmcnt(5)
    v_mfma_f32_32x32x16_bf16 v[128:143], v[64:67], v[48:51], v[128:143]
    v_mfma_f32_32x32x16_bf16 v[144:159], v[64:67], v[52:55], v[144:159]
    buffer_load_dwordx4 v[88:91], v7, s[44:47], s30 offen offset:3072 sc1
    s_waitcnt vmcnt(5)
    v_mfma_f32_32x32x16_bf16 v[160:175], v[68:71], v[48:51], v[160:175]
    v_mfma_f32_32x32x16_bf16 v[176:191], v[68:71], v[52:55], v[176:191]
    buffer_load_dwordx4 v[92:95], v7, s[44:47], s31 offen offset:3072 sc1
    s_add_u32 m0, s32, 65536
    s_add_u32 s61, s59, 2
    s_and_b32 s61, s61, 7
    s_lshl_b32 s61, s61, 7
    s_add_u32 s90, s33, s61
    s_add_u32 s60, s90, 0
    buffer_load_dwordx4 v16, s[24:27], s60 offen lds
    s_waitcnt vmcnt(6)
    v_mfma_f32_32x32x16_bf16 v[192:207], v[72:75], v[48:51], v[192:207]
    v_mfma_f32_32x32x16_bf16 v[208:223], v[72:75], v[52:55], v[208:223]
    s_add_u32 s61, s59, 1
    s_and_b32 s61, s61, 7
    s_lshl_b32 s61, s61, 12
    s_add_u32 s28, s48, s61
    buffer_load_dwordx4 v[64:67], v7, s[44:47], s28 offen offset:0 sc1
    s_waitcnt vmcnt(6)
    v_mfma_f32_32x32x16_bf16 v[224:239], v[76:79], v[48:51], v[224:239]
    v_mfma_f32_32x32x16_bf16 v[240:255], v[76:79], v[52:55], v[240:255]
    s_add_u32 s61, s59, 1
    s_and_b32 s61, s61, 7
    s_lshl_b32 s61, s61, 12
    s_add_u32 s29, s49, s61
    buffer_load_dwordx4 v[68:71], v7, s[44:47], s29 offen offset:0 sc1
    s_add_u32 m0, s32, 66560
    s_add_u32 s60, s90, 32768
    buffer_load_dwordx4 v17, s[24:27], s60 offen lds
    s_waitcnt vmcnt(14)
    ds_read_b128 v[48:51], v18 offset:32768
    ds_read_b128 v[52:55], v18 offset:36864
    s_waitcnt lgkmcnt(2)
    s_waitcnt vmcnt(7)
    v_mfma_f32_32x32x16_bf16 v[128:143], v[80:83], v[56:59], v[128:143]
    v_mfma_f32_32x32x16_bf16 v[144:159], v[80:83], v[60:63], v[144:159]
    s_add_u32 s61, s59, 1
    s_and_b32 s61, s61, 7
    s_lshl_b32 s61, s61, 12
    s_add_u32 s30, s50, s61
    buffer_load_dwordx4 v[72:75], v7, s[44:47], s30 offen offset:0 sc1
    s_waitcnt vmcnt(7)
    v_mfma_f32_32x32x16_bf16 v[160:175], v[84:87], v[56:59], v[160:175]
    v_mfma_f32_32x32x16_bf16 v[176:191], v[84:87], v[60:63], v[176:191]
    s_add_u32 s61, s59, 1
    s_and_b32 s61, s61, 7
    s_lshl_b32 s61, s61, 12
    s_add_u32 s31, s51, s61
    buffer_load_dwordx4 v[76:79], v7, s[44:47], s31 offen offset:0 sc1
    s_add_u32 m0, s32, 67584
    s_add_u32 s60, s90, 65536
    buffer_load_dwordx4 v16, s[24:27], s60 offen lds
    s_waitcnt vmcnt(8)
    v_mfma_f32_32x32x16_bf16 v[192:207], v[88:91], v[56:59], v[192:207]
    v_mfma_f32_32x32x16_bf16 v[208:223], v[88:91], v[60:63], v[208:223]
    buffer_load_dwordx4 v[80:83], v7, s[44:47], s28 offen offset:1024 sc1
    s_waitcnt vmcnt(8)
    v_mfma_f32_32x32x16_bf16 v[224:239], v[92:95], v[56:59], v[224:239]
    v_mfma_f32_32x32x16_bf16 v[240:255], v[92:95], v[60:63], v[240:255]
    buffer_load_dwordx4 v[84:87], v7, s[44:47], s29 offen offset:1024 sc1
    s_add_u32 m0, s32, 68608
    s_add_u32 s60, s90, 98304
    buffer_load_dwordx4 v17, s[24:27], s60 offen lds
    s_setprio 0
    ds_read_b128 v[56:59], v19 offset:32768
    ds_read_b128 v[60:63], v19 offset:36864
    s_waitcnt lgkmcnt(2)
    s_waitcnt vmcnt(8)
    v_mfma_f32_32x32x16_bf16 v[128:143], v[64:67], v[48:51], v[128:143]
    v_mfma_f32_32x32x16_bf16 v[144:159], v[64:67], v[52:55], v[144:159]
    buffer_load_dwordx4 v[88:91], v7, s[44:47], s30 offen offset:1024 sc1
    s_waitcnt vmcnt(8)
    v_mfma_f32_32x32x16_bf16 v[160:175], v[68:71], v[48:51], v[160:175]
    v_mfma_f32_32x32x16_bf16 v[176:191], v[68:71], v[52:55], v[176:191]
    buffer_load_dwordx4 v[92:95], v7, s[44:47], s31 offen offset:1024 sc1
    s_add_u32 m0, s32, 69632
    s_add_u32 s60, s90, 131072
    buffer_load_dwordx4 v16, s[24:27], s60 offen lds
    s_waitcnt vmcnt(8)
    v_mfma_f32_32x32x16_bf16 v[192:207], v[72:75], v[48:51], v[192:207]
    v_mfma_f32_32x32x16_bf16 v[208:223], v[72:75], v[52:55], v[208:223]
    buffer_load_dwordx4 v[64:67], v7, s[44:47], s28 offen offset:2048 sc1
    s_waitcnt vmcnt(8)
    v_mfma_f32_32x32x16_bf16 v[224:239], v[76:79], v[48:51], v[224:239]
    v_mfma_f32_32x32x16_bf16 v[240:255], v[76:79], v[52:55], v[240:255]
    buffer_load_dwordx4 v[68:71], v7, s[44:47], s29 offen offset:2048 sc1
    s_add_u32 m0, s32, 70656
    s_add_u32 s60, s90, 163840
    buffer_load_dwordx4 v17, s[24:27], s60 offen lds
    ds_read_b128 v[48:51], v20 offset:32768
    ds_read_b128 v[52:55], v20 offset:36864
    s_waitcnt lgkmcnt(2)
    s_waitcnt vmcnt(8)
    v_mfma_f32_32x32x16_bf16 v[128:143], v[80:83], v[56:59], v[128:143]
    v_mfma_f32_32x32x16_bf16 v[144:159], v[80:83], v[60:63], v[144:159]
    buffer_load_dwordx4 v[72:75], v7, s[44:47], s30 offen offset:2048 sc1
    s_waitcnt vmcnt(8)
    v_mfma_f32_32x32x16_bf16 v[160:175], v[84:87], v[56:59], v[160:175]
    v_mfma_f32_32x32x16_bf16 v[176:191], v[84:87], v[60:63], v[176:191]
    buffer_load_dwordx4 v[76:79], v7, s[44:47], s31 offen offset:2048 sc1
    s_add_u32 m0, s32, 71680
    s_add_u32 s60, s90, 196608
    buffer_load_dwordx4 v16, s[24:27], s60 offen lds
    s_waitcnt vmcnt(8)
    v_mfma_f32_32x32x16_bf16 v[192:207], v[88:91], v[56:59], v[192:207]
    v_mfma_f32_32x32x16_bf16 v[208:223], v[88:91], v[60:63], v[208:223]
    buffer_load_dwordx4 v[80:83], v7, s[44:47], s28 offen offset:3072 sc1
    s_waitcnt vmcnt(8)
    v_mfma_f32_32x32x16_bf16 v[224:239], v[92:95], v[56:59], v[224:239]
    v_mfma_f32_32x32x16_bf16 v[240:255], v[92:95], v[60:63], v[240:255]
    buffer_load_dwordx4 v[84:87], v7, s[44:47], s29 offen offset:3072 sc1
    s_add_u32 m0, s32, 72704
    s_add_u32 s60, s90, 229376
    buffer_load_dwordx4 v17, s[24:27], s60 offen lds
    ds_read_b128 v[56:59], v21 offset:32768
    ds_read_b128 v[60:63], v21 offset:36864
    s_waitcnt lgkmcnt(2)
    s_waitcnt vmcnt(8)
    v_mfma_f32_32x32x16_bf16 v[128:143], v[64:67], v[48:51], v[128:143]
    v_mfma_f32_32x32x16_bf16 v[144:159], v[64:67], v[52:55], v[144:159]
    buffer_load_dwordx4 v[88:91], v7, s[44:47], s30 offen offset:3072 sc1
    s_waitcnt vmcnt(8)
    v_mfma_f32_32x32x16_bf16 v[160:175], v[68:71], v[48:51], v[160:175]
    v_mfma_f32_32x32x16_bf16 v[176:191], v[68:71], v[52:55], v[176:191]
    buffer_load_dwordx4 v[92:95], v7, s[44:47], s31 offen offset:3072 sc1
    s_add_u32 m0, s32, 0
    s_add_u32 s61, s59, 3
    s_and_b32 s61, s61, 7
    s_lshl_b32 s61, s61, 7
    s_add_u32 s90, s33, s61
    s_add_u32 s60, s90, 0
    buffer_load_dwordx4 v16, s[24:27], s60 offen lds
    s_waitcnt vmcnt(8)
    v_mfma_f32_32x32x16_bf16 v[192:207], v[72:75], v[48:51], v[192:207]
    v_mfma_f32_32x32x16_bf16 v[208:223], v[72:75], v[52:55], v[208:223]
    s_add_u32 s61, s59, 2
    s_and_b32 s61, s61, 7
    s_lshl_b32 s61, s61, 12
    s_add_u32 s28, s48, s61
    buffer_load_dwordx4 v[64:67], v7, s[44:47], s28 offen offset:0 sc1
    s_waitcnt vmcnt(8)
    v_mfma_f32_32x32x16_bf16 v[224:239], v[76:79], v[48:51], v[224:239]
    v_mfma_f32_32x32x16_bf16 v[240:255], v[76:79], v[52:55], v[240:255]
    s_add_u32 s61, s59, 2
    s_and_b32 s61, s61, 7
    s_lshl_b32 s61, s61, 12
    s_add_u32 s29, s49, s61
    buffer_load_dwordx4 v[68:71], v7, s[44:47], s29 offen offset:0 sc1
    s_add_u32 m0, s32, 1024
    s_add_u32 s60, s90, 32768
    buffer_load_dwordx4 v17, s[24:27], s60 offen lds
    s_waitcnt vmcnt(6)
    ds_read_b128 v[48:51], v22 offset:0
    ds_read_b128 v[52:55], v22 offset:4096
    s_waitcnt lgkmcnt(2)
    s_waitcnt vmcnt(8)
    v_mfma_f32_32x32x16_bf16 v[128:143], v[80:83], v[56:59], v[128:143]
    v_mfma_f32_32x32x16_bf16 v[144:159], v[80:83], v[60:63], v[144:159]
    s_add_u32 s61, s59, 2
    s_and_b32 s61, s61, 7
    s_lshl_b32 s61, s61, 12
    s_add_u32 s30, s50, s61
    buffer_load_dwordx4 v[72:75], v7, s[44:47], s30 offen offset:0 sc1
    s_waitcnt vmcnt(8)
    v_mfma_f32_32x32x16_bf16 v[160:175], v[84:87], v[56:59], v[160:175]
    v_mfma_f32_32x32x16_bf16 v[176:191], v[84:87], v[60:63], v[176:191]
    s_add_u32 s61, s59, 2
    s_and_b32 s61, s61, 7
    s_lshl_b32 s61, s61, 12
    s_add_u32 s31, s51, s61
    buffer_load_dwordx4 v[76:79], v7, s[44:47], s31 offen offset:0 sc1
    s_add_u32 m0, s32, 2048
    s_add_u32 s60, s90, 65536
    buffer_load_dwordx4 v16, s[24:27], s60 offen lds
    s_waitcnt vmcnt(8)
    v_mfma_f32_32x32x16_bf16 v[192:207], v[88:91], v[56:59], v[192:207]
    v_mfma_f32_32x32x16_bf16 v[208:223], v[88:91], v[60:63], v[208:223]
    buffer_load_dwordx4 v[80:83], v7, s[44:47], s28 offen offset:1024 sc1
    s_waitcnt vmcnt(8)
    v_mfma_f32_32x32x16_bf16 v[224:239], v[92:95], v[56:59], v[224:239]
    v_mfma_f32_32x32x16_bf16 v[240:255], v[92:95], v[60:63], v[240:255]
    buffer_load_dwordx4 v[84:87], v7, s[44:47], s29 offen offset:1024 sc1
    s_add_u32 m0, s32, 3072
    s_add_u32 s60, s90, 98304
    buffer_load_dwordx4 v17, s[24:27], s60 offen lds
    s_setprio 0
    ds_read_b128 v[56:59], v23 offset:0
    ds_read_b128 v[60:63], v23 offset:4096
    s_waitcnt lgkmcnt(2)
    s_waitcnt vmcnt(8)
    v_mfma_f32_32x32x16_bf16 v[128:143], v[64:67], v[48:51], v[128:143]
    v_mfma_f32_32x32x16_bf16 v[144:159], v[64:67], v[52:55], v[144:159]
    buffer_load_dwordx4 v[88:91], v7, s[44:47], s30 offen offset:1024 sc1
    s_waitcnt vmcnt(8)
    v_mfma_f32_32x32x16_bf16 v[160:175], v[68:71], v[48:51], v[160:175]
    v_mfma_f32_32x32x16_bf16 v[176:191], v[68:71], v[52:55], v[176:191]
    buffer_load_dwordx4 v[92:95], v7, s[44:47], s31 offen offset:1024 sc1
    s_add_u32 m0, s32, 4096
    s_add_u32 s60, s90, 131072
    buffer_load_dwordx4 v16, s[24:27], s60 offen lds
    s_waitcnt vmcnt(8)
    v_mfma_f32_32x32x16_bf16 v[192:207], v[72:75], v[48:51], v[192:207]
    v_mfma_f32_32x32x16_bf16 v[208:223], v[72:75], v[52:55], v[208:223]
    buffer_load_dwordx4 v[64:67], v7, s[44:47], s28 offen offset:2048 sc1
    s_waitcnt vmcnt(8)
    v_mfma_f32_32x32x16_bf16 v[224:239], v[76:79], v[48:51], v[224:239]
    v_mfma_f32_32x32x16_bf16 v[240:255], v[76:79], v[52:55], v[240:255]
    buffer_load_dwordx4 v[68:71], v7, s[44:47], s29 offen offset:2048 sc1
    s_add_u32 m0, s32, 5120
    s_add_u32 s60, s90, 163840
    buffer_load_dwordx4 v17, s[24:27], s60 offen lds
    ds_read_b128 v[48:51], v24 offset:0
    ds_read_b128 v[52:55], v24 offset:4096
    s_waitcnt lgkmcnt(2)
    s_waitcnt vmcnt(8)
    v_mfma_f32_32x32x16_bf16 v[128:143], v[80:83], v[56:59], v[128:143]
    v_mfma_f32_32x32x16_bf16 v[144:159], v[80:83], v[60:63], v[144:159]
    buffer_load_dwordx4 v[72:75], v7, s[44:47], s30 offen offset:2048 sc1
    s_waitcnt vmcnt(8)
    v_mfma_f32_32x32x16_bf16 v[160:175], v[84:87], v[56:59], v[160:175]
    v_mfma_f32_32x32x16_bf16 v[176:191], v[84:87], v[60:63], v[176:191]
    buffer_load_dwordx4 v[76:79], v7, s[44:47], s31 offen offset:2048 sc1
    s_add_u32 m0, s32, 6144
    s_add_u32 s60, s90, 196608
    buffer_load_dwordx4 v16, s[24:27], s60 offen lds
    s_waitcnt vmcnt(8)
    v_mfma_f32_32x32x16_bf16 v[192:207], v[88:91], v[56:59], v[192:207]
    v_mfma_f32_32x32x16_bf16 v[208:223], v[88:91], v[60:63], v[208:223]
    buffer_load_dwordx4 v[80:83], v7, s[44:47], s28 offen offset:3072 sc1
    s_waitcnt vmcnt(8)
    v_mfma_f32_32x32x16_bf16 v[224:239], v[92:95], v[56:59], v[224:239]
    v_mfma_f32_32x32x16_bf16 v[240:255], v[92:95], v[60:63], v[240:255]
    buffer_load_dwordx4 v[84:87], v7, s[44:47], s29 offen offset:3072 sc1
    s_add_u32 m0, s32, 7168
    s_add_u32 s60, s90, 229376
    buffer_load_dwordx4 v17, s[24:27], s60 offen lds
    ds_read_b128 v[56:59], v25 offset:0
    ds_read_b128 v[60:63], v25 offset:4096
    s_waitcnt lgkmcnt(2)
    s_waitcnt vmcnt(8)
    v_mfma_f32_32x32x16_bf16 v[128:143], v[64:67], v[48:51], v[128:143]
    v_mfma_f32_32x32x16_bf16 v[144:159], v[64:67], v[52:55], v[144:159]
    buffer_load_dwordx4 v[88:91], v7, s[44:47], s30 offen offset:3072 sc1
    s_waitcnt vmcnt(8)
    v_mfma_f32_32x32x16_bf16 v[160:175], v[68:71], v[48:51], v[160:175]
    v_mfma_f32_32x32x16_bf16 v[176:191], v[68:71], v[52:55], v[176:191]
    buffer_load_dwordx4 v[92:95], v7, s[44:47], s31 offen offset:3072 sc1
    s_add_u32 m0, s32, 32768
    s_add_u32 s61, s59, 4
    s_and_b32 s61, s61, 7
    s_lshl_b32 s61, s61, 7
    s_add_u32 s90, s33, s61
    s_add_u32 s60, s90, 0
    buffer_load_dwordx4 v16, s[24:27], s60 offen lds
    s_waitcnt vmcnt(8)
    v_mfma_f32_32x32x16_bf16 v[192:207], v[72:75], v[48:51], v[192:207]
    v_mfma_f32_32x32x16_bf16 v[208:223], v[72:75], v[52:55], v[208:223]
    s_add_u32 s61, s59, 3
    s_and_b32 s61, s61, 7
    s_lshl_b32 s61, s61, 12
    s_add_u32 s28, s48, s61
    buffer_load_dwordx4 v[64:67], v7, s[44:47], s28 offen offset:0 sc1
    s_waitcnt vmcnt(8)
    v_mfma_f32_32x32x16_bf16 v[224:239], v[76:79], v[48:51], v[224:239]
    v_mfma_f32_32x32x16_bf16 v[240:255], v[76:79], v[52:55], v[240:255]
    s_add_u32 s61, s59, 3
    s_and_b32 s61, s61, 7
    s_lshl_b32 s61, s61, 12
    s_add_u32 s29, s49, s61
    buffer_load_dwordx4 v[68:71], v7, s[44:47], s29 offen offset:0 sc1
    s_add_u32 m0, s32, 33792
    s_add_u32 s60, s90, 32768
    buffer_load_dwordx4 v17, s[24:27], s60 offen lds
    s_waitcnt vmcnt(6)
    ds_read_b128 v[48:51], v18 offset:0
    ds_read_b128 v[52:55], v18 offset:4096
    s_waitcnt lgkmcnt(2)
    s_waitcnt vmcnt(8)
    v_mfma_f32_32x32x16_bf16 v[128:143], v[80:83], v[56:59], v[128:143]
    v_mfma_f32_32x32x16_bf16 v[144:159], v[80:83], v[60:63], v[144:159]
    s_add_u32 s61, s59, 3
    s_and_b32 s61, s61, 7
    s_lshl_b32 s61, s61, 12
    s_add_u32 s30, s50, s61
    buffer_load_dwordx4 v[72:75], v7, s[44:47], s30 offen offset:0 sc1
    s_waitcnt vmcnt(8)
    v_mfma_f32_32x32x16_bf16 v[160:175], v[84:87], v[56:59], v[160:175]
    v_mfma_f32_32x32x16_bf16 v[176:191], v[84:87], v[60:63], v[176:191]
    s_add_u32 s61, s59, 3
    s_and_b32 s61, s61, 7
    s_lshl_b32 s61, s61, 12
    s_add_u32 s31, s51, s61
    buffer_load_dwordx4 v[76:79], v7, s[44:47], s31 offen offset:0 sc1
    s_add_u32 m0, s32, 34816
    s_add_u32 s60, s90, 65536
    buffer_load_dwordx4 v16, s[24:27], s60 offen lds
    s_waitcnt vmcnt(8)
    v_mfma_f32_32x32x16_bf16 v[192:207], v[88:91], v[56:59], v[192:207]
    v_mfma_f32_32x32x16_bf16 v[208:223], v[88:91], v[60:63], v[208:223]
    buffer_load_dwordx4 v[80:83], v7, s[44:47], s28 offen offset:1024 sc1
    s_waitcnt vmcnt(8)
    v_mfma_f32_32x32x16_bf16 v[224:239], v[92:95], v[56:59], v[224:239]
    v_mfma_f32_32x32x16_bf16 v[240:255], v[92:95], v[60:63], v[240:255]
    buffer_load_dwordx4 v[84:87], v7, s[44:47], s29 offen offset:1024 sc1
    s_add_u32 m0, s32, 35840
    s_add_u32 s60, s90, 98304
    buffer_load_dwordx4 v17, s[24:27], s60 offen lds
    s_setprio 0
    ds_read_b128 v[56:59], v19 offset:0
    ds_read_b128 v[60:63], v19 offset:4096
    s_waitcnt lgkmcnt(2)
    s_waitcnt vmcnt(8)
    v_mfma_f32_32x32x16_bf16 v[128:143], v[64:67], v[48:51], v[128:143]
    v_mfma_f32_32x32x16_bf16 v[144:159], v[64:67], v[52:55], v[144:159]
    buffer_load_dwordx4 v[88:91], v7, s[44:47], s30 offen offset:1024 sc1
    s_waitcnt vmcnt(8)
    v_mfma_f32_32x32x16_bf16 v[160:175], v[68:71], v[48:51], v[160:175]
    v_mfma_f32_32x32x16_bf16 v[176:191], v[68:71], v[52:55], v[176:191]
    buffer_load_dwordx4 v[92:95], v7, s[44:47], s31 offen offset:1024 sc1
    s_add_u32 m0, s32, 36864
    s_add_u32 s60, s90, 131072
    buffer_load_dwordx4 v16, s[24:27], s60 offen lds
    s_waitcnt vmcnt(8)
    v_mfma_f32_32x32x16_bf16 v[192:207], v[72:75], v[48:51], v[192:207]
    v_mfma_f32_32x32x16_bf16 v[208:223], v[72:75], v[52:55], v[208:223]
    buffer_load_dwordx4 v[64:67], v7, s[44:47], s28 offen offset:2048 sc1
    s_waitcnt vmcnt(8)
    v_mfma_f32_32x32x16_bf16 v[224:239], v[76:79], v[48:51], v[224:239]
    v_mfma_f32_32x32x16_bf16 v[240:255], v[76:79], v[52:55], v[240:255]
    buffer_load_dwordx4 v[68:71], v7, s[44:47], s29 offen offset:2048 sc1
    s_add_u32 m0, s32, 37888
    s_add_u32 s60, s90, 163840
    buffer_load_dwordx4 v17, s[24:27], s60 offen lds
    ds_read_b128 v[48:51], v20 offset:0
    ds_read_b128 v[52:55], v20 offset:4096
    s_waitcnt lgkmcnt(2)
    s_waitcnt vmcnt(8)
    v_mfma_f32_32x32x16_bf16 v[128:143], v[80:83], v[56:59], v[128:143]
    v_mfma_f32_32x32x16_bf16 v[144:159], v[80:83], v[60:63], v[144:159]
    buffer_load_dwordx4 v[72:75], v7, s[44:47], s30 offen offset:2048 sc1
    s_waitcnt vmcnt(8)
    v_mfma_f32_32x32x16_bf16 v[160:175], v[84:87], v[56:59], v[160:175]
    v_mfma_f32_32x32x16_bf16 v[176:191], v[84:87], v[60:63], v[176:191]
    buffer_load_dwordx4 v[76:79], v7, s[44:47], s31 offen offset:2048 sc1
    s_add_u32 m0, s32, 38912
    s_add_u32 s60, s90, 196608
    buffer_load_dwordx4 v16, s[24:27], s60 offen lds
    s_waitcnt vmcnt(8)
    v_mfma_f32_32x32x16_bf16 v[192:207], v[88:91], v[56:59], v[192:207]
    v_mfma_f32_32x32x16_bf16 v[208:223], v[88:91], v[60:63], v[208:223]
    buffer_load_dwordx4 v[80:83], v7, s[44:47], s28 offen offset:3072 sc1
    s_waitcnt vmcnt(8)
    v_mfma_f32_32x32x16_bf16 v[224:239], v[92:95], v[56:59], v[224:239]
    v_mfma_f32_32x32x16_bf16 v[240:255], v[92:95], v[60:63], v[240:255]
    buffer_load_dwordx4 v[84:87], v7, s[44:47], s29 offen offset:3072 sc1
    s_add_u32 m0, s32, 39936
    s_add_u32 s60, s90, 229376
    buffer_load_dwordx4 v17, s[24:27], s60 offen lds
    ds_read_b128 v[56:59], v21 offset:0
    ds_read_b128 v[60:63], v21 offset:4096
    s_waitcnt lgkmcnt(2)
    s_waitcnt vmcnt(8)
    v_mfma_f32_32x32x16_bf16 v[128:143], v[64:67], v[48:51], v[128:143]
    v_mfma_f32_32x32x16_bf16 v[144:159], v[64:67], v[52:55], v[144:159]
    buffer_load_dwordx4 v[88:91], v7, s[44:47], s30 offen offset:3072 sc1
    s_waitcnt vmcnt(8)
    v_mfma_f32_32x32x16_bf16 v[160:175], v[68:71], v[48:51], v[160:175]
    v_mfma_f32_32x32x16_bf16 v[176:191], v[68:71], v[52:55], v[176:191]
    buffer_load_dwordx4 v[92:95], v7, s[44:47], s31 offen offset:3072 sc1
    s_add_u32 m0, s32, 65536
    s_add_u32 s61, s59, 5
    s_and_b32 s61, s61, 7
    s_lshl_b32 s61, s61, 7
    s_add_u32 s90, s33, s61
    s_add_u32 s60, s90, 0
    buffer_load_dwordx4 v16, s[24:27], s60 offen lds
    s_waitcnt vmcnt(8)
    v_mfma_f32_32x32x16_bf16 v[192:207], v[72:75], v[48:51], v[192:207]
    v_mfma_f32_32x32x16_bf16 v[208:223], v[72:75], v[52:55], v[208:223]
    s_add_u32 s61, s59, 4
    s_and_b32 s61, s61, 7
    s_lshl_b32 s61, s61, 12
    s_add_u32 s28, s48, s61
    buffer_load_dwordx4 v[64:67], v7, s[44:47], s28 offen offset:0 sc1
    s_waitcnt vmcnt(8)
    v_mfma_f32_32x32x16_bf16 v[224:239], v[76:79], v[48:51], v[224:239]
    v_mfma_f32_32x32x16_bf16 v[240:255], v[76:79], v[52:55], v[240:255]
    s_add_u32 s61, s59, 4
    s_and_b32 s61, s61, 7
    s_lshl_b32 s61, s61, 12
    s_add_u32 s29, s49, s61
    buffer_load_dwordx4 v[68:71], v7, s[44:47], s29 offen offset:0 sc1
    s_add_u32 m0, s32, 66560
    s_add_u32 s60, s90, 32768
    buffer_load_dwordx4 v17, s[24:27], s60 offen lds
    s_waitcnt vmcnt(6)
    ds_read_b128 v[48:51], v18 offset:32768
    ds_read_b128 v[52:55], v18 offset:36864
    s_waitcnt lgkmcnt(2)
    s_waitcnt vmcnt(8)
    v_mfma_f32_32x32x16_bf16 v[128:143], v[80:83], v[56:59], v[128:143]
    v_mfma_f32_32x32x16_bf16 v[144:159], v[80:83], v[60:63], v[144:159]
    s_add_u32 s61, s59, 4
    s_and_b32 s61, s61, 7
    s_lshl_b32 s61, s61, 12
    s_add_u32 s30, s50, s61
    buffer_load_dwordx4 v[72:75], v7, s[44:47], s30 offen offset:0 sc1
    s_waitcnt vmcnt(8)
    v_mfma_f32_32x32x16_bf16 v[160:175], v[84:87], v[56:59], v[160:175]
    v_mfma_f32_32x32x16_bf16 v[176:191], v[84:87], v[60:63], v[176:191]
    s_add_u32 s61, s59, 4
    s_and_b32 s61, s61, 7
    s_lshl_b32 s61, s61, 12
    s_add_u32 s31, s51, s61
    buffer_load_dwordx4 v[76:79], v7, s[44:47], s31 offen offset:0 sc1
    s_add_u32 m0, s32, 67584
    s_add_u32 s60, s90, 65536
    buffer_load_dwordx4 v16, s[24:27], s60 offen lds
    s_waitcnt vmcnt(8)
    v_mfma_f32_32x32x16_bf16 v[192:207], v[88:91], v[56:59], v[192:207]
    v_mfma_f32_32x32x16_bf16 v[208:223], v[88:91], v[60:63], v[208:223]
    buffer_load_dwordx4 v[80:83], v7, s[44:47], s28 offen offset:1024 sc1
    s_waitcnt vmcnt(8)
    v_mfma_f32_32x32x16_bf16 v[224:239], v[92:95], v[56:59], v[224:239]
    v_mfma_f32_32x32x16_bf16 v[240:255], v[92:95], v[60:63], v[240:255]
    buffer_load_dwordx4 v[84:87], v7, s[44:47], s29 offen offset:1024 sc1
    s_add_u32 m0, s32, 68608
    s_add_u32 s60, s90, 98304
    buffer_load_dwordx4 v17, s[24:27], s60 offen lds
    s_setprio 0
    ds_read_b128 v[56:59], v19 offset:32768
    ds_read_b128 v[60:63], v19 offset:36864
    s_waitcnt lgkmcnt(2)
    s_waitcnt vmcnt(8)
    v_mfma_f32_32x32x16_bf16 v[128:143], v[64:67], v[48:51], v[128:143]
    v_mfma_f32_32x32x16_bf16 v[144:159], v[64:67], v[52:55], v[144:159]
    buffer_load_dwordx4 v[88:91], v7, s[44:47], s30 offen offset:1024 sc1
    s_waitcnt vmcnt(8)
    v_mfma_f32_32x32x16_bf16 v[160:175], v[68:71], v[48:51], v[160:175]
    v_mfma_f32_32x32x16_bf16 v[176:191], v[68:71], v[52:55], v[176:191]
    buffer_load_dwordx4 v[92:95], v7, s[44:47], s31 offen offset:1024 sc1
    s_add_u32 m0, s32, 69632
    s_add_u32 s60, s90, 131072
    buffer_load_dwordx4 v16, s[24:27], s60 offen lds
    s_waitcnt vmcnt(8)
    v_mfma_f32_32x32x16_bf16 v[192:207], v[72:75], v[48:51], v[192:207]
    v_mfma_f32_32x32x16_bf16 v[208:223], v[72:75], v[52:55], v[208:223]
    buffer_load_dwordx4 v[64:67], v7, s[44:47], s28 offen offset:2048 sc1
    s_waitcnt vmcnt(8)
    v_mfma_f32_32x32x16_bf16 v[224:239], v[76:79], v[48:51], v[224:239]
    v_mfma_f32_32x32x16_bf16 v[240:255], v[76:79], v[52:55], v[240:255]
    buffer_load_dwordx4 v[68:71], v7, s[44:47], s29 offen offset:2048 sc1
    s_add_u32 m0, s32, 70656
    s_add_u32 s60, s90, 163840
    buffer_load_dwordx4 v17, s[24:27], s60 offen lds
    ds_read_b128 v[48:51], v20 offset:32768
    ds_read_b128 v[52:55], v20 offset:36864
    s_waitcnt lgkmcnt(2)
    s_waitcnt vmcnt(8)
    v_mfma_f32_32x32x16_bf16 v[128:143], v[80:83], v[56:59], v[128:143]
    v_mfma_f32_32x32x16_bf16 v[144:159], v[80:83], v[60:63], v[144:159]
    buffer_load_dwordx4 v[72:75], v7, s[44:47], s30 offen offset:2048 sc1
    s_waitcnt vmcnt(8)
    v_mfma_f32_32x32x16_bf16 v[160:175], v[84:87], v[56:59], v[160:175]
    v_mfma_f32_32x32x16_bf16 v[176:191], v[84:87], v[60:63], v[176:191]
    buffer_load_dwordx4 v[76:79], v7, s[44:47], s31 offen offset:2048 sc1
    s_add_u32 m0, s32, 71680
    s_add_u32 s60, s90, 196608
    buffer_load_dwordx4 v16, s[24:27], s60 offen lds
    s_waitcnt vmcnt(8)
    v_mfma_f32_32x32x16_bf16 v[192:207], v[88:91], v[56:59], v[192:207]
    v_mfma_f32_32x32x16_bf16 v[208:223], v[88:91], v[60:63], v[208:223]
    buffer_load_dwordx4 v[80:83], v7, s[44:47], s28 offen offset:3072 sc1
    s_waitcnt vmcnt(8)
    v_mfma_f32_32x32x16_bf16 v[224:239], v[92:95], v[56:59], v[224:239]
    v_mfma_f32_32x32x16_bf16 v[240:255], v[92:95], v[60:63], v[240:255]
    buffer_load_dwordx4 v[84:87], v7, s[44:47], s29 offen offset:3072 sc1
    s_add_u32 m0, s32, 72704
    s_add_u32 s60, s90, 229376
    buffer_load_dwordx4 v17, s[24:27], s60 offen lds
    ds_read_b128 v[56:59], v21 offset:32768
    ds_read_b128 v[60:63], v21 offset:36864
    s_waitcnt lgkmcnt(2)
    s_waitcnt vmcnt(8)
    v_mfma_f32_32x32x16_bf16 v[128:143], v[64:67], v[48:51], v[128:143]
    v_mfma_f32_32x32x16_bf16 v[144:159], v[64:67], v[52:55], v[144:159]
    buffer_load_dwordx4 v[88:91], v7, s[44:47], s30 offen offset:3072 sc1
    s_waitcnt vmcnt(8)
    v_mfma_f32_32x32x16_bf16 v[160:175], v[68:71], v[48:51], v[160:175]
    v_mfma_f32_32x32x16_bf16 v[176:191], v[68:71], v[52:55], v[176:191]
    buffer_load_dwordx4 v[92:95], v7, s[44:47], s31 offen offset:3072 sc1
    s_add_u32 m0, s32, 0
    s_add_u32 s61, s59, 6
    s_and_b32 s61, s61, 7
    s_lshl_b32 s61, s61, 7
    s_add_u32 s90, s33, s61
    s_add_u32 s60, s90, 0
    buffer_load_dwordx4 v16, s[24:27], s60 offen lds
    s_waitcnt vmcnt(8)
    v_mfma_f32_32x32x16_bf16 v[192:207], v[72:75], v[48:51], v[192:207]
    v_mfma_f32_32x32x16_bf16 v[208:223], v[72:75], v[52:55], v[208:223]
    s_add_u32 s61, s59, 5
    s_and_b32 s61, s61, 7
    s_lshl_b32 s61, s61, 12
    s_add_u32 s28, s48, s61
    buffer_load_dwordx4 v[64:67], v7, s[44:47], s28 offen offset:0 sc1
    s_waitcnt vmcnt(8)
    v_mfma_f32_32x32x16_bf16 v[224:239], v[76:79], v[48:51], v[224:239]
    v_mfma_f32_32x32x16_bf16 v[240:255], v[76:79], v[52:55], v[240:255]
    s_add_u32 s61, s59, 5
    s_and_b32 s61, s61, 7
    s_lshl_b32 s61, s61, 12
    s_add_u32 s29, s49, s61
    buffer_load_dwordx4 v[68:71], v7, s[44:47], s29 offen offset:0 sc1
    s_add_u32 m0, s32, 1024
    s_add_u32 s60, s90, 32768
    buffer_load_dwordx4 v17, s[24:27], s60 offen lds
    s_waitcnt vmcnt(6)
    ds_read_b128 v[48:51], v22 offset:0
    ds_read_b128 v[52:55], v22 offset:4096
    s_waitcnt lgkmcnt(2)
    s_waitcnt vmcnt(8)
    v_mfma_f32_32x32x16_bf16 v[128:143], v[80:83], v[56:59], v[128:143]
    v_mfma_f32_32x32x16_bf16 v[144:159], v[80:83], v[60:63], v[144:159]
    s_add_u32 s61, s59, 5
    s_and_b32 s61, s61, 7
    s_lshl_b32 s61, s61, 12
    s_add_u32 s30, s50, s61
    buffer_load_dwordx4 v[72:75], v7, s[44:47], s30 offen offset:0 sc1
    s_waitcnt vmcnt(8)
    v_mfma_f32_32x32x16_bf16 v[160:175], v[84:87], v[56:59], v[160:175]
    v_mfma_f32_32x32x16_bf16 v[176:191], v[84:87], v[60:63], v[176:191]
    s_add_u32 s61, s59, 5
    s_and_b32 s61, s61, 7
    s_lshl_b32 s61, s61, 12
    s_add_u32 s31, s51, s61
    buffer_load_dwordx4 v[76:79], v7, s[44:47], s31 offen offset:0 sc1
    s_add_u32 m0, s32, 2048
    s_add_u32 s60, s90, 65536
    buffer_load_dwordx4 v16, s[24:27], s60 offen lds
    s_waitcnt vmcnt(8)
    v_mfma_f32_32x32x16_bf16 v[192:207], v[88:91], v[56:59], v[192:207]
    v_mfma_f32_32x32x16_bf16 v[208:223], v[88:91], v[60:63], v[208:223]
    buffer_load_dwordx4 v[80:83], v7, s[44:47], s28 offen offset:1024 sc1
    s_waitcnt vmcnt(8)
    v_mfma_f32_32x32x16_bf16 v[224:239], v[92:95], v[56:59], v[224:239]
    v_mfma_f32_32x32x16_bf16 v[240:255], v[92:95], v[60:63], v[240:255]
    buffer_load_dwordx4 v[84:87], v7, s[44:47], s29 offen offset:1024 sc1
    s_add_u32 m0, s32, 3072
    s_add_u32 s60, s90, 98304
    buffer_load_dwordx4 v17, s[24:27], s60 offen lds
    s_setprio 2
    ds_read_b128 v[56:59], v23 offset:0
    ds_read_b128 v[60:63], v23 offset:4096
    s_waitcnt lgkmcnt(2)
    s_waitcnt vmcnt(8)
    v_mfma_f32_32x32x16_bf16 v[128:143], v[64:67], v[48:51], v[128:143]
    v_mfma_f32_32x32x16_bf16 v[144:159], v[64:67], v[52:55], v[144:159]
    buffer_load_dwordx4 v[88:91], v7, s[44:47], s30 offen offset:1024 sc1
    s_waitcnt vmcnt(8)
    v_mfma_f32_32x32x16_bf16 v[160:175], v[68:71], v[48:51], v[160:175]
    v_mfma_f32_32x32x16_bf16 v[176:191], v[68:71], v[52:55], v[176:191]
    buffer_load_dwordx4 v[92:95], v7, s[44:47], s31 offen offset:1024 sc1
    s_add_u32 m0, s32, 4096
    s_add_u32 s60, s90, 131072
    buffer_load_dwordx4 v16, s[24:27], s60 offen lds
    s_waitcnt vmcnt(8)
    v_mfma_f32_32x32x16_bf16 v[192:207], v[72:75], v[48:51], v[192:207]
    v_mfma_f32_32x32x16_bf16 v[208:223], v[72:75], v[52:55], v[208:223]
    buffer_load_dwordx4 v[64:67], v7, s[44:47], s28 offen offset:2048 sc1
    s_waitcnt vmcnt(8)
    v_mfma_f32_32x32x16_bf16 v[224:239], v[76:79], v[48:51], v[224:239]
    v_mfma_f32_32x32x16_bf16 v[240:255], v[76:79], v[52:55], v[240:255]
    buffer_load_dwordx4 v[68:71], v7, s[44:47], s29 offen offset:2048 sc1
    s_add_u32 m0, s32, 5120
    s_add_u32 s60, s90, 163840
    buffer_load_dwordx4 v17, s[24:27], s60 offen lds
    s_lshl_b32 s63, s54, 8
    s_add_u32 s63, s63, 9216
    buffer_load_dword v15, v4, s[44:47], s63 offen sc1
    ds_read_b128 v[48:51], v24 offset:0
    ds_read_b128 v[52:55], v24 offset:4096
    s_waitcnt lgkmcnt(2)
    s_waitcnt vmcnt(9)
    v_mfma_f32_32x32x16_bf16 v[128:143], v[80:83], v[56:59], v[128:143]
    v_mfma_f32_32x32x16_bf16 v[144:159], v[80:83], v[60:63], v[144:159]
    buffer_load_dwordx4 v[72:75], v7, s[44:47], s30 offen offset:2048 sc1
    s_waitcnt vmcnt(9)
    v_mfma_f32_32x32x16_bf16 v[160:175], v[84:87], v[56:59], v[160:175]
    v_mfma_f32_32x32x16_bf16 v[176:191], v[84:87], v[60:63], v[176:191]
    buffer_load_dwordx4 v[76:79], v7, s[44:47], s31 offen offset:2048 sc1
    s_add_u32 m0, s32, 6144
    s_add_u32 s60, s90, 196608
    buffer_load_dwordx4 v16, s[24:27], s60 offen lds
    s_waitcnt vmcnt(9)
    v_mfma_f32_32x32x16_bf16 v[192:207], v[88:91], v[56:59], v[192:207]
    v_mfma_f32_32x32x16_bf16 v[208:223], v[88:91], v[60:63], v[208:223]
    buffer_load_dwordx4 v[80:83], v7, s[44:47], s28 offen offset:3072 sc1
    s_waitcnt vmcnt(9)
    v_mfma_f32_32x32x16_bf16 v[224:239], v[92:95], v[56:59], v[224:239]
    v_mfma_f32_32x32x16_bf16 v[240:255], v[92:95], v[60:63], v[240:255]
    buffer_load_dwordx4 v[84:87], v7, s[44:47], s29 offen offset:3072 sc1
    s_add_u32 m0, s32, 7168
    s_add_u32 s60, s90, 229376
    buffer_load_dwordx4 v17, s[24:27], s60 offen lds
    ds_read_b128 v[56:59], v25 offset:0
    ds_read_b128 v[60:63], v25 offset:4096
    s_waitcnt lgkmcnt(2)
    s_waitcnt vmcnt(9)
    v_mfma_f32_32x32x16_bf16 v[128:143], v[64:67], v[48:51], v[128:143]
    v_mfma_f32_32x32x16_bf16 v[144:159], v[64:67], v[52:55], v[144:159]
    buffer_load_dwordx4 v[88:91], v7, s[44:47], s30 offen offset:3072 sc1
    s_waitcnt vmcnt(9)
    v_mfma_f32_32x32x16_bf16 v[160:175], v[68:71], v[48:51], v[160:175]
    v_mfma_f32_32x32x16_bf16 v[176:191], v[68:71], v[52:55], v[176:191]
    buffer_load_dwordx4 v[92:95], v7, s[44:47], s31 offen offset:3072 sc1
    s_add_u32 m0, s32, 32768
    s_add_u32 s61, s59, 7
    s_and_b32 s61, s61, 7
    s_lshl_b32 s61, s61, 7
    s_add_u32 s90, s33, s61
    s_add_u32 s60, s90, 0
    buffer_load_dwordx4 v16, s[24:27], s60 offen lds
    s_waitcnt vmcnt(8)
    v_mfma_f32_32x32x16_bf16 v[192:207], v[72:75], v[48:51], v[192:207]
    v_mfma_f32_32x32x16_bf16 v[208:223], v[72:75], v[52:55], v[208:223]
    s_add_u32 s61, s59, 6
    s_and_b32 s61, s61, 7
    s_lshl_b32 s61, s61, 12
    s_add_u32 s28, s48, s61
    buffer_load_dwordx4 v[64:67], v7, s[44:47], s28 offen offset:0 sc1
    s_waitcnt vmcnt(8)
    v_mfma_f32_32x32x16_bf16 v[224:239], v[76:79], v[48:51], v[224:239]
    v_mfma_f32_32x32x16_bf16 v[240:255], v[76:79], v[52:55], v[240:255]
    s_add_u32 s61, s59, 6
    s_and_b32 s61, s61, 7
    s_lshl_b32 s61, s61, 12
    s_add_u32 s29, s49, s61
    buffer_load_dwordx4 v[68:71], v7, s[44:47], s29 offen offset:0 sc1
    s_add_u32 m0, s32, 33792
    s_add_u32 s60, s90, 32768
    buffer_load_dwordx4 v17, s[24:27], s60 offen lds
    s_waitcnt vmcnt(6)
    ds_read_b128 v[48:51], v18 offset:0
    ds_read_b128 v[52:55], v18 offset:4096
    s_waitcnt lgkmcnt(2)
    s_waitcnt vmcnt(8)
    v_mfma_f32_32x32x16_bf16 v[128:143], v[80:83], v[56:59], v[128:143]
    v_mfma_f32_32x32x16_bf16 v[144:159], v[80:83], v[60:63], v[144:159]
    s_add_u32 s61, s59, 6
    s_and_b32 s61, s61, 7
    s_lshl_b32 s61, s61, 12
    s_add_u32 s30, s50, s61
    buffer_load_dwordx4 v[72:75], v7, s[44:47], s30 offen offset:0 sc1
    s_waitcnt vmcnt(8)
    v_mfma_f32_32x32x16_bf16 v[160:175], v[84:87], v[56:59], v[160:175]
    v_mfma_f32_32x32x16_bf16 v[176:191], v[84:87], v[60:63], v[176:191]
    s_add_u32 s61, s59, 6
    s_and_b32 s61, s61, 7
    s_lshl_b32 s61, s61, 12
    s_add_u32 s31, s51, s61
    buffer_load_dwordx4 v[76:79], v7, s[44:47], s31 offen offset:0 sc1
    s_add_u32 m0, s32, 34816
    s_add_u32 s60, s90, 65536
    buffer_load_dwordx4 v16, s[24:27], s60 offen lds
    s_waitcnt vmcnt(8)
    v_mfma_f32_32x32x16_bf16 v[192:207], v[88:91], v[56:59], v[192:207]
    v_mfma_f32_32x32x16_bf16 v[208:223], v[88:91], v[60:63], v[208:223]
    buffer_load_dwordx4 v[80:83], v7, s[44:47], s28 offen offset:1024 sc1
    s_waitcnt vmcnt(8)
    v_mfma_f32_32x32x16_bf16 v[224:239], v[92:95], v[56:59], v[224:239]
    v_mfma_f32_32x32x16_bf16 v[240:255], v[92:95], v[60:63], v[240:255]
    buffer_load_dwordx4 v[84:87], v7, s[44:47], s29 offen offset:1024 sc1
    s_add_u32 m0, s32, 35840
    s_add_u32 s60, s90, 98304
    buffer_load_dwordx4 v17, s[24:27], s60 offen lds
    s_setprio 2
    ds_read_b128 v[56:59], v19 offset:0
    ds_read_b128 v[60:63], v19 offset:4096
    s_waitcnt lgkmcnt(2)
    s_waitcnt vmcnt(8)
    v_mfma_f32_32x32x16_bf16 v[128:143], v[64:67], v[48:51], v[128:143]
    v_mfma_f32_32x32x16_bf16 v[144:159], v[64:67], v[52:55], v[144:159]
    buffer_load_dwordx4 v[88:91], v7, s[44:47], s30 offen offset:1024 sc1
    s_waitcnt vmcnt(8)
    v_mfma_f32_32x32x16_bf16 v[160:175], v[68:71], v[48:51], v[160:175]
    v_mfma_f32_32x32x16_bf16 v[176:191], v[68:71], v[52:55], v[176:191]
    buffer_load_dwordx4 v[92:95], v7, s[44:47], s31 offen offset:1024 sc1
    s_add_u32 m0, s32, 36864
    s_add_u32 s60, s90, 131072
    buffer_load_dwordx4 v16, s[24:27], s60 offen lds
    s_waitcnt vmcnt(8)
    v_mfma_f32_32x32x16_bf16 v[192:207], v[72:75], v[48:51], v[192:207]
    v_mfma_f32_32x32x16_bf16 v[208:223], v[72:75], v[52:55], v[208:223]
    buffer_load_dwordx4 v[64:67], v7, s[44:47], s28 offen offset:2048 sc1
    s_waitcnt vmcnt(8)
    v_mfma_f32_32x32x16_bf16 v[224:239], v[76:79], v[48:51], v[224:239]
    v_mfma_f32_32x32x16_bf16 v[240:255], v[76:79], v[52:55], v[240:255]
    buffer_load_dwordx4 v[68:71], v7, s[44:47], s29 offen offset:2048 sc1
    s_add_u32 m0, s32, 37888
    s_add_u32 s60, s90, 163840
    buffer_load_dwordx4 v17, s[24:27], s60 offen lds
    s_mov_b32 s4, -1
    s_mov_b32 s5, 0x7fff
    s_mov_b32 s3, 0x20000
    s_waitcnt vmcnt(24)
    s_branch Lpollc_220
Lpoll_219:
    buffer_load_dword v15, v4, s[44:47], s63 offen sc1
    s_waitcnt vmcnt(0)
Lpollc_220:
    v_cmp_ne_u32 vcc, 0, v15
    s_nop 0
    s_and_b64 s[6:7], vcc, s[4:5]
    s_cmp_eq_u64 s[6:7], s[4:5]
    s_cbranch_scc1 Lpolld_221
    s_sub_u32 s3, s3, 1
    s_cbranch_scc1 Lpolld_221
    s_sleep 2
    s_branch Lpoll_219
Lpolld_221:
    v_lshlrev_b32 v4, 2, v2
    v_mov_b32 v8, 0x27e04
    s_mov_b32 s3, 0x100000
Lbs_222:
    ds_read_b32 v9, v8
    s_waitcnt lgkmcnt(0)
    v_readfirstlane_b32 s6, v9
    s_nop 0
    s_cmp_ge_u32 s6, 8
    s_cbranch_scc1 Lbsd_223
    s_sub_u32 s3, s3, 1
    s_cbranch_scc1 Lbsd_223
    s_sleep 1
    s_branch Lbs_222
Lbsd_223:
    ds_read_b128 v[48:51], v20 offset:0
    ds_read_b128 v[52:55], v20 offset:4096
    s_waitcnt lgkmcnt(2)
    s_waitcnt vmcnt(8)
    v_mfma_f32_32x32x16_bf16 v[128:143], v[80:83], v[56:59], v[128:143]
    v_mfma_f32_32x32x16_bf16 v[144:159], v[80:83], v[60:63], v[144:159]
    buffer_load_dwordx4 v[72:75], v7, s[44:47], s30 offen offset:2048 sc1
    s_waitcnt vmcnt(8)
    v_mfma_f32_32x32x16_bf16 v[160:175], v[84:87], v[56:59], v[160:175]
    v_mfma_f32_32x32x16_bf16 v[176:191], v[84:87], v[60:63], v[176:191]
    buffer_load_dwordx4 v[76:79], v7, s[44:47], s31 offen offset:2048 sc1
    s_add_u32 m0, s32, 38912
    s_add_u32 s60, s90, 196608
    buffer_load_dwordx4 v16, s[24:27], s60 offen lds
    s_waitcnt vmcnt(8)
    v_mfma_f32_32x32x16_bf16 v[192:207], v[88:91], v[56:59], v[192:207]
    v_mfma_f32_32x32x16_bf16 v[208:223], v[88:91], v[60:63], v[208:223]
    buffer_load_dwordx4 v[80:83], v7, s[44:47], s28 offen offset:3072 sc1
    s_waitcnt vmcnt(8)
    v_mfma_f32_32x32x16_bf16 v[224:239], v[92:95], v[56:59], v[224:239]
    v_mfma_f32_32x32x16_bf16 v[240:255], v[92:95], v[60:63], v[240:255]
    buffer_load_dwordx4 v[84:87], v7, s[44:47], s29 offen offset:3072 sc1
    s_add_u32 m0, s32, 39936
    s_add_u32 s60, s90, 229376
    buffer_load_dwordx4 v17, s[24:27], s60 offen lds
    ds_read_b128 v[56:59], v21 offset:0
    ds_read_b128 v[60:63], v21 offset:4096
    s_waitcnt lgkmcnt(2)
    s_waitcnt vmcnt(8)
    v_mfma_f32_32x32x16_bf16 v[128:143], v[64:67], v[48:51], v[128:143]
    v_mfma_f32_32x32x16_bf16 v[144:159], v[64:67], v[52:55], v[144:159]
    buffer_load_dwordx4 v[88:91], v7, s[44:47], s30 offen offset:3072 sc1
    s_waitcnt vmcnt(8)
    v_mfma_f32_32x32x16_bf16 v[160:175], v[68:71], v[48:51], v[160:175]
    v_mfma_f32_32x32x16_bf16 v[176:191], v[68:71], v[52:55], v[176:191]
    buffer_load_dwordx4 v[92:95], v7, s[44:47], s31 offen offset:3072 sc1
    s_add_u32 m0, s93, 102400
    s_add_u32 s60, s92, 102400
    buffer_load_dwordx4 v7, s[44:47], s60 offen sc1 lds
    s_waitcnt vmcnt(8)
    v_mfma_f32_32x32x16_bf16 v[192:207], v[72:75], v[48:51], v[192:207]
    v_mfma_f32_32x32x16_bf16 v[208:223], v[72:75], v[52:55], v[208:223]
    s_add_u32 s61, s59, 7
    s_and_b32 s61, s61, 7
    s_lshl_b32 s61, s61, 12
    s_add_u32 s29, s49, s61
    buffer_load_dwordx4 v[64:67], v7, s[44:47], s29 offen offset:0 sc1
    s_waitcnt vmcnt(8)
    v_mfma_f32_32x32x16_bf16 v[224:239], v[76:79], v[48:51], v[224:239]
    v_mfma_f32_32x32x16_bf16 v[240:255], v[76:79], v[52:55], v[240:255]
    buffer_load_dwordx4 v[68:71], v7, s[44:47], s29 offen offset:1024 sc1
    s_add_u32 m0, s93, 103424
    s_add_u32 s60, s92, 103424
    buffer_load_dwordx4 v7, s[44:47], s60 offen sc1 lds
    s_waitcnt vmcnt(6)
    ds_read_b128 v[48:51], v18 offset:32768
    ds_read_b128 v[52:55], v18 offset:36864
    s_waitcnt lgkmcnt(2)
    s_waitcnt vmcnt(8)
    v_mfma_f32_32x32x16_bf16 v[128:143], v[80:83], v[56:59], v[128:143]
    v_mfma_f32_32x32x16_bf16 v[144:159], v[80:83], v[60:63], v[144:159]
    buffer_load_dwordx4 v[72:75], v7, s[44:47], s29 offen offset:2048 sc1
    s_waitcnt vmcnt(8)
    v_mfma_f32_32x32x16_bf16 v[160:175], v[84:87], v[56:59], v[160:175]
    v_mfma_f32_32x32x16_bf16 v[176:191], v[84:87], v[60:63], v[176:191]
    buffer_load_dwordx4 v[76:79], v7, s[44:47], s29 offen offset:3072 sc1
    s_add_u32 m0, s93, 104448
    s_add_u32 s60, s92, 104448
    buffer_load_dwordx4 v7, s[44:47], s60 offen sc1 lds
    s_waitcnt vmcnt(8)
    v_mfma_f32_32x32x16_bf16 v[192:207], v[88:91], v[56:59], v[192:207]
    v_mfma_f32_32x32x16_bf16 v[208:223], v[88:91], v[60:63], v[208:223]
    s_add_u32 s61, s59, 7
    s_and_b32 s61, s61, 7
    s_lshl_b32 s61, s61, 12
    s_add_u32 s30, s50, s61
    buffer_load_dwordx4 v[80:83], v7, s[44:47], s30 offen offset:0 sc1
    s_waitcnt vmcnt(8)
    v_mfma_f32_32x32x16_bf16 v[224:239], v[92:95], v[56:59], v[224:239]
    v_mfma_f32_32x32x16_bf16 v[240:255], v[92:95], v[60:63], v[240:255]
    buffer_load_dwordx4 v[84:87], v7, s[44:47], s30 offen offset:1024 sc1
    s_add_u32 m0, s93, 105472
    s_add_u32 s60, s92, 105472
    buffer_load_dwordx4 v7, s[44:47], s60 offen sc1 lds
    s_setprio 2
    ds_read_b128 v[56:59], v19 offset:32768
    ds_read_b128 v[60:63], v19 offset:36864
    ds_read_b128 v[32:35], v20 offset:32768
    ds_read_b128 v[36:39], v20 offset:36864
    ds_read_b128 v[8:11], v21 offset:32768
    ds_read_b128 v[12:15], v21 offset:36864
    v_add_u32 v28, s32, v7
    v_add_u32 v29, 0x10000, v28
    s_waitcnt lgkmcnt(6)
    s_waitcnt vmcnt(8)
    v_mfma_f32_32x32x16_bf16 v[160:175], v[64:67], v[48:51], v[160:175]
    v_mfma_f32_32x32x16_bf16 v[176:191], v[64:67], v[52:55], v[176:191]
    buffer_load_dwordx4 v[88:91], v7, s[44:47], s30 offen offset:2048 sc1
    s_waitcnt lgkmcnt(4)
    s_waitcnt vmcnt(8)
    v_mfma_f32_32x32x16_bf16 v[160:175], v[68:71], v[56:59], v[160:175]
    v_mfma_f32_32x32x16_bf16 v[176:191], v[68:71], v[60:63], v[176:191]
    buffer_load_dwordx4 v[92:95], v7, s[44:47], s30 offen offset:3072 sc1
    s_add_u32 m0, s93, 106496
    s_add_u32 s60, s92, 106496
    buffer_load_dwordx4 v7, s[44:47], s60 offen sc1 lds
    s_waitcnt lgkmcnt(2)
    s_waitcnt vmcnt(8)
    v_mfma_f32_32x32x16_bf16 v[160:175], v[72:75], v[32:35], v[160:175]
    v_mfma_f32_32x32x16_bf16 v[176:191], v[72:75], v[36:39], v[176:191]
    s_add_u32 s61, s59, 7
    s_and_b32 s61, s61, 7
    s_lshl_b32 s61, s61, 12
    s_add_u32 s31, s51, s61
    buffer_load_dwordx4 v[64:67], v7, s[44:47], s31 offen offset:0 sc1
    s_waitcnt lgkmcnt(0)
    s_waitcnt vmcnt(8)
    v_mfma_f32_32x32x16_bf16 v[160:175], v[76:79], v[8:11], v[160:175]
    v_mfma_f32_32x32x16_bf16 v[176:191], v[76:79], v[12:15], v[176:191]
    buffer_load_dwordx4 v[68:71], v7, s[44:47], s31 offen offset:1024 sc1
    s_add_u32 m0, s93, 122880
    s_add_u32 s60, s92, 122880
    buffer_load_dwordx4 v7, s[44:47], s60 offen sc1 lds
    s_waitcnt vmcnt(8)
    v_mfma_f32_32x32x16_bf16 v[192:207], v[80:83], v[48:51], v[192:207]
    v_mfma_f32_32x32x16_bf16 v[208:223], v[80:83], v[52:55], v[208:223]
    buffer_load_dwordx4 v[72:75], v7, s[44:47], s31 offen offset:2048 sc1
    s_waitcnt vmcnt(8)
    v_mfma_f32_32x32x16_bf16 v[192:207], v[84:87], v[56:59], v[192:207]
    v_mfma_f32_32x32x16_bf16 v[208:223], v[84:87], v[60:63], v[208:223]
    buffer_load_dwordx4 v[76:79], v7, s[44:47], s31 offen offset:3072 sc1
    s_add_u32 m0, s93, 123904
    s_add_u32 s60, s92, 123904
    buffer_load_dwordx4 v7, s[44:47], s60 offen sc1 lds
    ds_write_b128 v28, v[160:163] offset:0
    ds_write_b128 v28, v[164:167] offset:1024
    ds_write_b128 v28, v[168:171] offset:2048
    s_waitcnt vmcnt(8)
    v_mfma_f32_32x32x16_bf16 v[192:207], v[88:91], v[32:35], v[192:207]
    v_mfma_f32_32x32x16_bf16 v[208:223], v[88:91], v[36:39], v[208:223]
    s_add_u32 s61, s59, 7
    s_and_b32 s61, s61, 7
    s_lshl_b32 s61, s61, 12
    s_add_u32 s28, s48, s61
    buffer_load_dwordx4 v[80:83], v7, s[44:47], s28 offen offset:0 sc1
    ds_write_b128 v28, v[172:175] offset:3072
    ds_write_b128 v28, v[176:179] offset:4096
    ds_write_b128 v28, v[180:183] offset:5120
    s_waitcnt vmcnt(8)
    v_mfma_f32_32x32x16_bf16 v[192:207], v[92:95], v[8:11], v[192:207]
    v_mfma_f32_32x32x16_bf16 v[208:223], v[92:95], v[12:15], v[208:223]
    buffer_load_dwordx4 v[84:87], v7, s[44:47], s28 offen offset:1024 sc1
    s_add_u32 m0, s93, 124928
    s_add_u32 s60, s92, 124928
    buffer_load_dwordx4 v7, s[44:47], s60 offen sc1 lds
    ds_write_b128 v28, v[184:187] offset:6144
    ds_write_b128 v28, v[188:191] offset:7168
    s_waitcnt vmcnt(8)
    v_mfma_f32_32x32x16_bf16 v[224:239], v[64:67], v[48:51], v[224:239]
    v_mfma_f32_32x32x16_bf16 v[240:255], v[64:67], v[52:55], v[240:255]
    buffer_load_dwordx4 v[88:91], v7, s[44:47], s28 offen offset:2048 sc1
    s_waitcnt vmcnt(8)
    v_mfma_f32_32x32x16_bf16 v[224:239], v[68:71], v[56:59], v[224:239]
    v_mfma_f32_32x32x16_bf16 v[240:255], v[68:71], v[60:63], v[240:255]
    buffer_load_dwordx4 v[92:95], v7, s[44:47], s28 offen offset:3072 sc1
    s_add_u32 m0, s93, 125952
    s_add_u32 s60, s92, 125952
    buffer_load_dwordx4 v7, s[44:47], s60 offen sc1 lds
    ds_write_b128 v28, v[192:195] offset:32768
    ds_write_b128 v28, v[196:199] offset:33792
    ds_write_b128 v28, v[200:203] offset:34816
    s_waitcnt vmcnt(8)
    v_mfma_f32_32x32x16_bf16 v[224:239], v[72:75], v[32:35], v[224:239]
    v_mfma_f32_32x32x16_bf16 v[240:255], v[72:75], v[36:39], v[240:255]
    ds_write_b128 v28, v[204:207] offset:35840
    ds_write_b128 v28, v[208:211] offset:36864
    ds_write_b128 v28, v[212:215] offset:37888
    s_waitcnt vmcnt(7)
    v_mfma_f32_32x32x16_bf16 v[224:239], v[76:79], v[8:11], v[224:239]
    v_mfma_f32_32x32x16_bf16 v[240:255], v[76:79], v[12:15], v[240:255]
    s_add_u32 m0, s93, 126976
    s_add_u32 s60, s92, 126976
    buffer_load_dwordx4 v7, s[44:47], s60 offen sc1 lds
    ds_write_b128 v28, v[216:219] offset:38912
    ds_write_b128 v28, v[220:223] offset:39936
    s_waitcnt vmcnt(6)
    v_mfma_f32_32x32x16_bf16 v[128:143], v[80:83], v[48:51], v[128:143]
    v_mfma_f32_32x32x16_bf16 v[144:159], v[80:83], v[52:55], v[144:159]
    s_waitcnt vmcnt(5)
    v_mfma_f32_32x32x16_bf16 v[128:143], v[84:87], v[56:59], v[128:143]
    v_mfma_f32_32x32x16_bf16 v[144:159], v[84:87], v[60:63], v[144:159]
    ds_write_b128 v29, v[224:227] offset:0
    ds_write_b128 v29, v[228:231] offset:1024
    ds_write_b128 v29, v[232:235] offset:2048
    s_waitcnt vmcnt(3)
    v_mfma_f32_32x32x16_bf16 v[128:143], v[88:91], v[32:35], v[128:143]
    v_mfma_f32_32x32x16_bf16 v[144:159], v[88:91], v[36:39], v[144:159]
    ds_write_b128 v29, v[236:239] offset:3072
    ds_write_b128 v29, v[240:243] offset:4096
    ds_write_b128 v29, v[244:247] offset:5120
    s_waitcnt vmcnt(2)
    v_mfma_f32_32x32x16_bf16 v[128:143], v[92:95], v[8:11], v[128:143]
    v_mfma_f32_32x32x16_bf16 v[144:159], v[92:95], v[12:15], v[144:159]
    ds_write_b128 v29, v[248:251] offset:6144
    ds_write_b128 v29, v[252:255] offset:7168
L_spdone:
    s_setprio 2
    s_add_u32 s60, s101, 3
    s_and_b32 s60, s60, 3
    s_lshl_b32 s60, s60, 13
    s_add_u32 s60, s60, 0
    v_add_u32 v30, s60, v7
    s_add_u32 s60, s101, 2
    s_and_b32 s60, s60, 3
    s_lshl_b32 s60, s60, 13
    s_add_u32 s60, s60, 32768
    v_add_u32 v31, s60, v7
    s_add_u32 s60, s101, 1
    s_and_b32 s60, s60, 3
    s_lshl_b32 s60, s60, 13
    s_add_u32 s60, s60, 65536
    v_add_u32 v32, s60, v7
    s_mul_i32 s62, s53, 27
    s_add_u32 s60, s62, s100
    s_lshl_b32 s60, s60, 12
    s_add_u32 s90, s60, 0x500000
    s_waitcnt lgkmcnt(0)
    v_mov_b32 v8, 0x27e00
    v_mov_b32 v9, 1
    s_mov_b64 exec, 1
    ds_add_u32 v8, v9
    s_mov_b64 exec, -1
    v_mov_b32 v8, 0x27e00
    s_mov_b32 s3, 0x100000
Lbs_224:
    ds_read_b32 v9, v8
    s_waitcnt lgkmcnt(0)
    v_readfirstlane_b32 s6, v9
    s_nop 0
    s_cmp_ge_u32 s6, 4
    s_cbranch_scc1 Lbsd_225
    s_sub_u32 s3, s3, 1
    s_cbranch_scc1 Lbsd_225
    s_sleep 1
    s_branch Lbs_224
Lbsd_225:
    ds_read_b128 v[160:163], v30 offset:0
    ds_read_b128 v[164:167], v30 offset:1024
    ds_read_b128 v[168:171], v30 offset:2048
    ds_read_b128 v[172:175], v30 offset:3072
    ds_read_b128 v[192:195], v31 offset:0
    ds_read_b128 v[196:199], v31 offset:1024
    ds_read_b128 v[200:203], v31 offset:2048
    ds_read_b128 v[204:207], v31 offset:3072
    ds_read_b128 v[224:227], v32 offset:0
    ds_read_b128 v[228:231], v32 offset:1024
    ds_read_b128 v[232:235], v32 offset:2048
    ds_read_b128 v[236:239], v32 offset:3072
    ds_read_b128 v[176:179], v30 offset:4096
    ds_read_b128 v[180:183], v30 offset:5120
    ds_read_b128 v[184:187], v30 offset:6144
    ds_read_b128 v[188:191], v30 offset:7168
    ds_read_b128 v[208:211], v31 offset:4096
    ds_read_b128 v[212:215], v31 offset:5120
    ds_read_b128 v[216:219], v31 offset:6144
    ds_read_b128 v[220:223], v31 offset:7168
    ds_read_b128 v[240:243], v32 offset:4096
    ds_read_b128 v[244:247], v32 offset:5120
    ds_read_b128 v[248:251], v32 offset:6144
    ds_read_b128 v[252:255], v32 offset:7168
    s_waitcnt lgkmcnt(12)
    v_pk_add_f32 v[128:129], v[128:129], v[160:161]
    v_pk_add_f32 v[192:193], v[192:193], v[224:225]
    v_pk_add_f32 v[130:131], v[130:131], v[162:163]
    v_pk_add_f32 v[194:195], v[194:195], v[226:227]
    v_pk_add_f32 v[132:133], v[132:133], v[164:165]
    v_pk_add_f32 v[196:197], v[196:197], v[228:229]
    v_pk_add_f32 v[134:135], v[134:135], v[166:167]
    v_pk_add_f32 v[198:199], v[198:199], v[230:231]
    v_pk_add_f32 v[136:137], v[136:137], v[168:169]
    v_pk_add_f32 v[200:201], v[200:201], v[232:233]
    v_pk_add_f32 v[138:139], v[138:139], v[170:171]
    v_pk_add_f32 v[202:203], v[202:203], v[234:235]
    v_pk_add_f32 v[140:141], v[140:141], v[172:173]
    v_pk_add_f32 v[204:205], v[204:205], v[236:237]
    v_pk_add_f32 v[142:143], v[142:143], v[174:175]
    v_pk_add_f32 v[206:207], v[206:207], v[238:239]
    v_pk_add_f32 v[128:129], v[128:129], v[192:193]
    v_pk_add_f32 v[130:131], v[130:131], v[194:195]
    v_pk_add_f32 v[132:133], v[132:133], v[196:197]
    v_pk_add_f32 v[134:135], v[134:135], v[198:199]
    v_pk_add_f32 v[136:137], v[136:137], v[200:201]
    v_pk_add_f32 v[138:139], v[138:139], v[202:203]
    v_pk_add_f32 v[140:141], v[140:141], v[204:205]
    v_pk_add_f32 v[142:143], v[142:143], v[206:207]
    v_pk_mul_f32 v[128:129], v[128:129], v[96:97]
    v_pk_mul_f32 v[130:131], v[130:131], v[98:99]
    v_pk_mul_f32 v[132:133], v[132:133], v[100:101]
    v_pk_mul_f32 v[134:135], v[134:135], v[102:103]
    v_pk_mul_f32 v[136:137], v[136:137], v[104:105]
    v_pk_mul_f32 v[138:139], v[138:139], v[106:107]
    v_pk_mul_f32 v[140:141], v[140:141], v[108:109]
    v_pk_mul_f32 v[142:143], v[142:143], v[110:111]
    v_cvt_pk_bf16_f32 v64, v128, v129
    v_cvt_pk_bf16_f32 v65, v130, v131
    v_cvt_pk_bf16_f32 v66, v132, v133
    v_cvt_pk_bf16_f32 v67, v134, v135
    v_cvt_pk_bf16_f32 v68, v136, v137
    v_cvt_pk_bf16_f32 v69, v138, v139
    v_cvt_pk_bf16_f32 v70, v140, v141
    v_cvt_pk_bf16_f32 v71, v142, v143
    s_cmp_ge_u32 s101, s56
    s_cbranch_scc1 Lb_226
    buffer_store_dwordx4 v[64:67], v45, s[44:47], s90 offen offset:0 sc1
    buffer_store_dwordx4 v[68:71], v45, s[44:47], s90 offen offset:512 sc1
Lb_226:
    s_waitcnt lgkmcnt(0)
    v_mov_b32 v8, 0x27e08
    v_mov_b32 v9, 1
    s_mov_b64 exec, 1
    ds_add_u32 v8, v9
    s_mov_b64 exec, -1
    v_pk_add_f32 v[144:145], v[144:145], v[176:177]
    v_pk_add_f32 v[208:209], v[208:209], v[240:241]
    v_pk_add_f32 v[146:147], v[146:147], v[178:179]
    v_pk_add_f32 v[210:211], v[210:211], v[242:243]
    v_pk_add_f32 v[148:149], v[148:149], v[180:181]
    v_pk_add_f32 v[212:213], v[212:213], v[244:245]
    v_pk_add_f32 v[150:151], v[150:151], v[182:183]
    v_pk_add_f32 v[214:215], v[214:215], v[246:247]
    v_pk_add_f32 v[152:153], v[152:153], v[184:185]
    v_pk_add_f32 v[216:217], v[216:217], v[248:249]
    v_pk_add_f32 v[154:155], v[154:155], v[186:187]
    v_pk_add_f32 v[218:219], v[218:219], v[250:251]
    v_pk_add_f32 v[156:157], v[156:157], v[188:189]
    v_pk_add_f32 v[220:221], v[220:221], v[252:253]
    v_pk_add_f32 v[158:159], v[158:159], v[190:191]
    v_pk_add_f32 v[222:223], v[222:223], v[254:255]
    v_pk_add_f32 v[144:145], v[144:145], v[208:209]
    v_pk_add_f32 v[146:147], v[146:147], v[210:211]
    v_pk_add_f32 v[148:149], v[148:149], v[212:213]
    v_pk_add_f32 v[150:151], v[150:151], v[214:215]
    v_pk_add_f32 v[152:153], v[152:153], v[216:217]
    v_pk_add_f32 v[154:155], v[154:155], v[218:219]
    v_pk_add_f32 v[156:157], v[156:157], v[220:221]
    v_pk_add_f32 v[158:159], v[158:159], v[222:223]
    v_pk_mul_f32 v[144:145], v[144:145], v[112:113]
    v_pk_mul_f32 v[146:147], v[146:147], v[114:115]
    v_pk_mul_f32 v[148:149], v[148:149], v[116:117]
    v_pk_mul_f32 v[150:151], v[150:151], v[118:119]
    v_pk_mul_f32 v[152:153], v[152:153], v[120:121]
    v_pk_mul_f32 v[154:155], v[154:155], v[122:123]
    v_pk_mul_f32 v[156:157], v[156:157], v[124:125]
    v_pk_mul_f32 v[158:159], v[158:159], v[126:127]
    v_cvt_pk_bf16_f32 v72, v144, v145
    v_cvt_pk_bf16_f32 v73, v146, v147
    v_cvt_pk_bf16_f32 v74, v148, v149
    v_cvt_pk_bf16_f32 v75, v150, v151
    v_cvt_pk_bf16_f32 v76, v152, v153
    v_cvt_pk_bf16_f32 v77, v154, v155
    v_cvt_pk_bf16_f32 v78, v156, v157
    v_cvt_pk_bf16_f32 v79, v158, v159
    s_cmp_ge_u32 s101, s56
    s_cbranch_scc1 Lb_227
    buffer_store_dwordx4 v[72:75], v45, s[44:47], s90 offen offset:2048 sc1
    buffer_store_dwordx4 v[76:79], v45, s[44:47], s90 offen offset:2560 sc1
Lb_227:
    v_mov_b32 v8, 0x27e08
    s_mov_b32 s3, 0x100000
Lbs_228:
    ds_read_b32 v9, v8
    s_waitcnt lgkmcnt(0)
    v_readfirstlane_b32 s6, v9
    s_nop 0
    s_cmp_ge_u32 s6, 4
    s_cbranch_scc1 Lbsd_229
    s_sub_u32 s3, s3, 1
    s_cbranch_scc1 Lbsd_229
    s_sleep 1
    s_branch Lbs_228
Lbsd_229:
    s_mov_b32 s49, 5
    s_and_b32 s48, s53, 7
    s_cmp_ge_u32 s48, 5
    s_cselect_b32 s60, 5, 0
    s_sub_u32 s48, s48, s60
    s_mul_i32 s61, s48, 20480
    s_add_u32 s60, s61, s92
    s_add_u32 m0, s61, s93
    s_nop 0
    buffer_load_dwordx4 v7, s[44:47], s60 offen offset:0 sc1 lds
    buffer_load_dwordx4 v7, s[44:47], s60 offen offset:1024 sc1 lds
    buffer_load_dwordx4 v7, s[44:47], s60 offen offset:2048 sc1 lds
    buffer_load_dwordx4 v7, s[44:47], s60 offen offset:3072 sc1 lds
    s_add_u32 m0, m0, 4096
    s_add_u32 s60, s60, 4096
    buffer_load_dwordx4 v7, s[44:47], s60 offen offset:0 sc1 lds
Lb_230:
    s_add_u32 s48, s48, 1
    s_cmp_eq_u32 s48, s49
    s_cselect_b32 s48, 0, s48
    v_mov_b32 v8, 0x27e34
    v_mov_b32 v9, 1
    s_waitcnt vmcnt(5)
    s_mov_b64 exec, 1
    ds_add_rtn_u32 v9, v8, v9
    s_mov_b64 exec, -1
    s_lshl_b32 s60, s54, 2
    s_waitcnt lgkmcnt(0)
    v_readfirstlane_b32 s63, v9
    s_nop 0
    s_cmp_eq_u32 s63, 3
    s_cbranch_scc0 Lb_231
    s_lshl_b32 s61, s53, 11
    s_add_u32 s61, s61, s60
    s_add_u32 s61, s61, 0x30000
    v_lshlrev_b32 v8, 8, v1
    v_mov_b32 v9, 1
    s_mov_b64 exec, 0xff
    buffer_store_dword v9, v8, s[44:47], s61 offen sc1
    s_mov_b64 exec, -1
Lb_231:
    s_mul_i32 s61, s48, 20480
    s_add_u32 s60, s61, s92
    s_add_u32 m0, s61, s93
    s_waitcnt vmcnt(8)
    buffer_load_dwordx4 v7, s[44:47], s60 offen offset:0 sc1 lds
    s_waitcnt vmcnt(8)
    buffer_load_dwordx4 v7, s[44:47], s60 offen offset:1024 sc1 lds
    s_waitcnt vmcnt(8)
    buffer_load_dwordx4 v7, s[44:47], s60 offen offset:2048 sc1 lds
    s_waitcnt vmcnt(8)
    buffer_load_dwordx4 v7, s[44:47], s60 offen offset:3072 sc1 lds
    s_add_u32 m0, m0, 4096
    s_add_u32 s60, s60, 4096
    s_waitcnt vmcnt(8)
    buffer_load_dwordx4 v7, s[44:47], s60 offen offset:0 sc1 lds
Lb_232:
    s_add_u32 s48, s48, 1
    s_cmp_eq_u32 s48, s49
    s_cselect_b32 s48, 0, s48
    s_mul_i32 s61, s48, 20480
    s_add_u32 s60, s61, s92
    s_add_u32 m0, s61, s93
    s_waitcnt vmcnt(8)
    buffer_load_dwordx4 v7, s[44:47], s60 offen offset:0 sc1 lds
    s_waitcnt vmcnt(8)
    buffer_load_dwordx4 v7, s[44:47], s60 offen offset:1024 sc1 lds
    s_waitcnt vmcnt(8)
    buffer_load_dwordx4 v7, s[44:47], s60 offen offset:2048 sc1 lds
    s_waitcnt vmcnt(8)
    buffer_load_dwordx4 v7, s[44:47], s60 offen offset:3072 sc1 lds
    s_add_u32 m0, m0, 4096
    s_add_u32 s60, s60, 4096
    s_waitcnt vmcnt(8)
    buffer_load_dwordx4 v7, s[44:47], s60 offen offset:0 sc1 lds
Lb_233:
    s_add_u32 s48, s48, 1
    s_cmp_eq_u32 s48, s49
    s_cselect_b32 s48, 0, s48
    s_mul_i32 s61, s48, 20480
    s_add_u32 s60, s61, s92
    s_add_u32 m0, s61, s93
    s_waitcnt vmcnt(8)
    buffer_load_dwordx4 v7, s[44:47], s60 offen offset:0 sc1 lds
    s_waitcnt vmcnt(8)
    buffer_load_dwordx4 v7, s[44:47], s60 offen offset:1024 sc1 lds
    s_waitcnt vmcnt(8)
    buffer_load_dwordx4 v7, s[44:47], s60 offen offset:2048 sc1 lds
    s_waitcnt vmcnt(8)
    buffer_load_dwordx4 v7, s[44:47], s60 offen offset:3072 sc1 lds
    s_add_u32 m0, m0, 4096
    s_add_u32 s60, s60, 4096
    s_waitcnt vmcnt(8)
    buffer_load_dwordx4 v7, s[44:47], s60 offen offset:0 sc1 lds
Lb_234:
    s_add_u32 s48, s48, 1
    s_cmp_eq_u32 s48, s49
    s_cselect_b32 s48, 0, s48
    s_mul_i32 s61, s48, 20480
    s_add_u32 s60, s61, s92
    s_add_u32 m0, s61, s93
    s_waitcnt vmcnt(8)
    buffer_load_dwordx4 v7, s[44:47], s60 offen offset:0 sc1 lds
    s_waitcnt vmcnt(8)
    buffer_load_dwordx4 v7, s[44:47], s60 offen offset:1024 sc1 lds
    s_waitcnt vmcnt(8)
    buffer_load_dwordx4 v7, s[44:47], s60 offen offset:2048 sc1 lds
    s_waitcnt vmcnt(8)
    buffer_load_dwordx4 v7, s[44:47], s60 offen offset:3072 sc1 lds
    s_add_u32 m0, m0, 4096
    s_add_u32 s60, s60, 4096
    s_waitcnt vmcnt(8)
    buffer_load_dwordx4 v7, s[44:47], s60 offen offset:0 sc1 lds
Lb_235:
    s_add_u32 s48, s48, 1
    s_cmp_eq_u32 s48, s49
    s_cselect_b32 s48, 0, s48
    s_mul_i32 s62, s54, 10
    s_and_b32 s61, s101, 2
    s_lshl_b32 s61, s61, 1
    s_add_u32 s61, s61, s62
    s_and_b32 s63, s101, 1
    s_lshl_b32 s63, s63, 11
    v_lshrrev_b32 v11, 4, v2
    v_lshlrev_b32 v11, 10, v11
    v_and_b32 v10, 15, v2
    v_lshl_add_u32 v11, v10, 4, v11
    v_add_u32 v11, s63, v11
    v_add_u32 v10, s61, v3
    v_lshrrev_b32 v40, 2, v10
    v_lshl_add_u32 v40, v40, 12, v11
    v_and_b32 v10, 3, v10
    v_lshl_add_u32 v40, v10, 8, v40
    s_add_u32 s61, s61, 2
    v_add_u32 v10, s61, v3
    v_lshrrev_b32 v41, 2, v10
    v_lshl_add_u32 v41, v41, 12, v11
    v_and_b32 v10, 3, v10
    v_lshl_add_u32 v41, v10, 8, v41
    s_add_u32 s61, s61, 2
    s_lshr_b32 s61, s101, 1
    s_add_u32 s61, s61, s62
    s_add_u32 s61, s61, 8
    s_lshr_b32 s62, s61, 2
    s_lshl_b32 s62, s62, 12
    s_and_b32 s61, s61, 3
    s_lshl_b32 s61, s61, 8
    s_add_u32 s62, s62, s61
    v_add_u32 v42, s62, v11
    v_mov_b32 v32, -1
    v_mov_b32 v33, -1
    v_mov_b32 v34, -1
    v_mov_b32 v35, -1
    s_mul_i32 s60, s53, 81920
    s_add_u32 s60, s60, 0x900000
    s_mul_i32 s62, s53, 27
    buffer_store_dwordx4 v[32:35], v40, s[44:47], s60 offen sc1
    buffer_store_dwordx4 v[32:35], v41, s[44:47], s60 offen sc1
    s_mov_b32 exec_hi, 0
    buffer_store_dwordx4 v[32:35], v42, s[44:47], s60 offen sc1
    s_mov_b64 exec, -1
    s_lshl_b32 s60, s101, 5
    v_add_u32 v10, s60, v2
    v_min_u32 v10, 99, v10
    v_lshlrev_b32 v10, 7, v10
    s_and_b32 s60, s53, 7
    s_mul_i32 s60, s60, 12800
    s_add_u32 s60, s60, s92
    s_sub_u32 s60, s60, s93
    s_add_u32 s60, s60, 138240
    buffer_load_dword v11, v10, s[44:47], s60 offen sc1
    s_lshl_b32 s50, s62, 12
    s_add_u32 s50, s50, 0x500000
    s_lshl_b32 s61, s101, 10
    v_add_u32 v28, s61, v7
    v_xor_b32 v29, 0x400, v28
    s_and_b32 s61, s54, 3
    s_mul_i32 s61, s61, 7
    s_lshr_b32 s61, s61, 1
    s_and_b32 s63, s101, 1
    s_mul_i32 s60, s63, 14
    s_add_u32 s61, s61, s60
    s_lshl_b32 s36, s60, 12
    s_mul_i32 s38, s60, 5120
    s_mul_i32 s60, s63, 13
    s_add_u32 s60, s60, 14
    s_lshl_b32 s37, s60, 12
    s_mul_i32 s39, s60, 5120
    s_lshl_b32 s48, s61, 12
    s_mul_i32 s49, s61, 5120
    s_lshl_b32 s60, s53, 2
    s_add_u32 s60, s60, s101
    s_mul_i32 s60, s60, 20480
    s_add_u32 s100, s60, s91
    s_lshl_b32 s60, s53, 3
    s_add_u32 s60, s60, s54
    s_lshl_b32 s60, s60, 8
    s_add_u32 s60, s60, 0x30000
    s_mov_b64 s[4:5], 0xff
    s_bitcmp1_b32 s101, 0
    s_cselect_b32 s4, 0xf0, 15
    s_waitcnt vmcnt(0)
    s_waitcnt lgkmcnt(0)
    v_mov_b32 v8, 0x27e0c
    v_mov_b32 v9, 1
    s_mov_b64 exec, 1
    ds_add_u32 v8, v9
    s_mov_b64 exec, -1
    v_mov_b32 v8, 0x27e0c
    s_mov_b32 s3, 0x100000
Lbs_236:
    ds_read_b32 v9, v8
    s_waitcnt lgkmcnt(0)
    v_readfirstlane_b32 s6, v9
    s_nop 0
    s_cmp_ge_u32 s6, 4
    s_cbranch_scc1 Lbsd_237
    s_sub_u32 s3, s3, 1
    s_cbranch_scc1 Lbsd_237
    s_sleep 1
    s_branch Lbs_236
Lbsd_237:
    s_mov_b32 s3, 0x20000
Lpoll_238:
    buffer_load_dword v8, v4, s[44:47], s60 offen sc1
    s_waitcnt vmcnt(0)
Lpollc_239:
    v_cmp_ne_u32 vcc, 0, v8
    s_nop 0
    s_and_b64 s[6:7], vcc, s[4:5]
    s_cmp_eq_u64 s[6:7], s[4:5]
    s_cbranch_scc1 Lpolld_240
    s_sub_u32 s3, s3, 1
    s_cbranch_scc1 Lpolld_240
    s_sleep 2
    s_branch Lpoll_238
Lpolld_240:
    s_add_u32 s60, s50, s48
    buffer_load_dwordx4 v[140:143], v28, s[44:47], s60 offen sc1
    buffer_load_dwordx4 v[144:147], v29, s[44:47], s60 offen sc1
    s_add_u32 s48, s48, 4096
    s_cmp_eq_u32 s48, s37
    s_cselect_b32 s48, s36, s48
    s_add_u32 s60, s50, s48
    buffer_load_dwordx4 v[148:151], v28, s[44:47], s60 offen sc1
    buffer_load_dwordx4 v[152:155], v29, s[44:47], s60 offen sc1
    s_add_u32 s48, s48, 4096
    s_cmp_eq_u32 s48, s37
    s_cselect_b32 s48, s36, s48
    s_add_u32 s60, s50, s48
    buffer_load_dwordx4 v[156:159], v28, s[44:47], s60 offen sc1
    buffer_load_dwordx4 v[160:163], v29, s[44:47], s60 offen sc1
    s_add_u32 s48, s48, 4096
    s_cmp_eq_u32 s48, s37
    s_cselect_b32 s48, s36, s48
    s_add_u32 s60, s50, s48
    buffer_load_dwordx4 v[164:167], v28, s[44:47], s60 offen sc1
    buffer_load_dwordx4 v[168:171], v29, s[44:47], s60 offen sc1
    s_add_u32 s48, s48, 4096
    s_cmp_eq_u32 s48, s37
    s_cselect_b32 s48, s36, s48
    s_setprio 2
    v_add_u32 v14, s49, v7
    s_add_u32 s49, s49, 5120
    s_cmp_eq_u32 s49, s39
    s_cselect_b32 s49, s38, s49
    ds_read_b128 v[56:59], v14 offset:0
    ds_read_b128 v[60:63], v14 offset:1024
    ds_read_b128 v[64:67], v14 offset:2048
    ds_read_b128 v[68:71], v14 offset:3072
    ds_read_b128 v[72:75], v14 offset:4096
    v_add_u32 v14, s49, v7
    s_add_u32 s49, s49, 5120
    s_cmp_eq_u32 s49, s39
    s_cselect_b32 s49, s38, s49
    ds_read_b128 v[76:79], v14 offset:0
    ds_read_b128 v[80:83], v14 offset:1024
    ds_read_b128 v[84:87], v14 offset:2048
    ds_read_b128 v[88:91], v14 offset:3072
    ds_read_b128 v[92:95], v14 offset:4096
    s_waitcnt lgkmcnt(5)
    s_waitcnt vmcnt(6)
    v_mfma_f32_16x16x32_bf16 v[96:99], v[56:59], v[140:143], 0
    v_mfma_f32_16x16x32_bf16 v[116:119], v[56:59], v[144:147], 0
    v_mfma_f32_16x16x32_bf16 v[100:103], v[60:63], v[140:143], 0
    v_mfma_f32_16x16x32_bf16 v[120:123], v[60:63], v[144:147], 0
    v_mfma_f32_16x16x32_bf16 v[104:107], v[64:67], v[140:143], 0
    v_mfma_f32_16x16x32_bf16 v[124:127], v[64:67], v[144:147], 0
    v_mfma_f32_16x16x32_bf16 v[108:111], v[68:71], v[140:143], 0
    v_mfma_f32_16x16x32_bf16 v[128:131], v[68:71], v[144:147], 0
    v_mfma_f32_16x16x32_bf16 v[112:115], v[72:75], v[140:143], 0
    v_mfma_f32_16x16x32_bf16 v[132:135], v[72:75], v[144:147], 0
    s_add_u32 s60, s50, s48
    buffer_load_dwordx4 v[172:175], v28, s[44:47], s60 offen sc1
    buffer_load_dwordx4 v[176:179], v29, s[44:47], s60 offen sc1
    s_add_u32 s48, s48, 4096
    s_cmp_eq_u32 s48, s37
    s_cselect_b32 s48, s36, s48
    v_add_u32 v14, s49, v7
    s_add_u32 s49, s49, 5120
    s_cmp_eq_u32 s49, s39
    s_cselect_b32 s49, s38, s49
    ds_read_b128 v[56:59], v14 offset:0
    ds_read_b128 v[60:63], v14 offset:1024
    ds_read_b128 v[64:67], v14 offset:2048
    ds_read_b128 v[68:71], v14 offset:3072
    ds_read_b128 v[72:75], v14 offset:4096
    s_waitcnt lgkmcnt(5)
    s_waitcnt vmcnt(6)
    v_mfma_f32_16x16x32_bf16 v[96:99], v[76:79], v[148:151], v[96:99]
    v_mfma_f32_16x16x32_bf16 v[116:119], v[76:79], v[152:155], v[116:119]
    v_mfma_f32_16x16x32_bf16 v[100:103], v[80:83], v[148:151], v[100:103]
    v_mfma_f32_16x16x32_bf16 v[120:123], v[80:83], v[152:155], v[120:123]
    v_mfma_f32_16x16x32_bf16 v[104:107], v[84:87], v[148:151], v[104:107]
    v_mfma_f32_16x16x32_bf16 v[124:127], v[84:87], v[152:155], v[124:127]
    v_mfma_f32_16x16x32_bf16 v[108:111], v[88:91], v[148:151], v[108:111]
    v_mfma_f32_16x16x32_bf16 v[128:131], v[88:91], v[152:155], v[128:131]
    v_mfma_f32_16x16x32_bf16 v[112:115], v[92:95], v[148:151], v[112:115]
    v_mfma_f32_16x16x32_bf16 v[132:135], v[92:95], v[152:155], v[132:135]
    s_add_u32 s60, s50, s48
    buffer_load_dwordx4 v[180:183], v28, s[44:47], s60 offen sc1
    buffer_load_dwordx4 v[184:187], v29, s[44:47], s60 offen sc1
    s_add_u32 s48, s48, 4096
    s_cmp_eq_u32 s48, s37
    s_cselect_b32 s48, s36, s48
    v_add_u32 v14, s49, v7
    s_add_u32 s49, s49, 5120
    s_cmp_eq_u32 s49, s39
    s_cselect_b32 s49, s38, s49
    ds_read_b128 v[76:79], v14 offset:0
    ds_read_b128 v[80:83], v14 offset:1024
    ds_read_b128 v[84:87], v14 offset:2048
    ds_read_b128 v[88:91], v14 offset:3072
    ds_read_b128 v[92:95], v14 offset:4096
    s_waitcnt lgkmcnt(5)
    s_waitcnt vmcnt(6)
    v_mfma_f32_16x16x32_bf16 v[96:99], v[56:59], v[156:159], v[96:99]
    v_mfma_f32_16x16x32_bf16 v[116:119], v[56:59], v[160:163], v[116:119]
    v_mfma_f32_16x16x32_bf16 v[100:103], v[60:63], v[156:159], v[100:103]
    v_mfma_f32_16x16x32_bf16 v[120:123], v[60:63], v[160:163], v[120:123]
    v_mfma_f32_16x16x32_bf16 v[104:107], v[64:67], v[156:159], v[104:107]
    v_mfma_f32_16x16x32_bf16 v[124:127], v[64:67], v[160:163], v[124:127]
    v_mfma_f32_16x16x32_bf16 v[108:111], v[68:71], v[156:159], v[108:111]
    v_mfma_f32_16x16x32_bf16 v[128:131], v[68:71], v[160:163], v[128:131]
    v_mfma_f32_16x16x32_bf16 v[112:115], v[72:75], v[156:159], v[112:115]
    v_mfma_f32_16x16x32_bf16 v[132:135], v[72:75], v[160:163], v[132:135]
    s_add_u32 s60, s50, s48
    buffer_load_dwordx4 v[188:191], v28, s[44:47], s60 offen sc1
    buffer_load_dwordx4 v[192:195], v29, s[44:47], s60 offen sc1
    s_add_u32 s48, s48, 4096
    s_cmp_eq_u32 s48, s37
    s_cselect_b32 s48, s36, s48
    v_add_u32 v14, s49, v7
    s_add_u32 s49, s49, 5120
    s_cmp_eq_u32 s49, s39
    s_cselect_b32 s49, s38, s49
    ds_read_b128 v[56:59], v14 offset:0
    ds_read_b128 v[60:63], v14 offset:1024
    ds_read_b128 v[64:67], v14 offset:2048
    ds_read_b128 v[68:71], v14 offset:3072
    ds_read_b128 v[72:75], v14 offset:4096
    s_waitcnt lgkmcnt(5)
    s_waitcnt vmcnt(6)
    v_mfma_f32_16x16x32_bf16 v[96:99], v[76:79], v[164:167], v[96:99]
    v_mfma_f32_16x16x32_bf16 v[116:119], v[76:79], v[168:171], v[116:119]
    v_mfma_f32_16x16x32_bf16 v[100:103], v[80:83], v[164:167], v[100:103]
    v_mfma_f32_16x16x32_bf16 v[120:123], v[80:83], v[168:171], v[120:123]
    v_mfma_f32_16x16x32_bf16 v[104:107], v[84:87], v[164:167], v[104:107]
    v_mfma_f32_16x16x32_bf16 v[124:127], v[84:87], v[168:171], v[124:127]
    v_mfma_f32_16x16x32_bf16 v[108:111], v[88:91], v[164:167], v[108:111]
    v_mfma_f32_16x16x32_bf16 v[128:131], v[88:91], v[168:171], v[128:131]
    v_mfma_f32_16x16x32_bf16 v[112:115], v[92:95], v[164:167], v[112:115]
    v_mfma_f32_16x16x32_bf16 v[132:135], v[92:95], v[168:171], v[132:135]
    s_add_u32 s60, s50, s48
    buffer_load_dwordx4 v[196:199], v28, s[44:47], s60 offen sc1
    buffer_load_dwordx4 v[200:203], v29, s[44:47], s60 offen sc1
    s_add_u32 s48, s48, 4096
    s_cmp_eq_u32 s48, s37
    s_cselect_b32 s48, s36, s48
    v_add_u32 v14, s49, v7
    s_add_u32 s49, s49, 5120
    s_cmp_eq_u32 s49, s39
    s_cselect_b32 s49, s38, s49
    ds_read_b128 v[76:79], v14 offset:0
    ds_read_b128 v[80:83], v14 offset:1024
    ds_read_b128 v[84:87], v14 offset:2048
    ds_read_b128 v[88:91], v14 offset:3072
    ds_read_b128 v[92:95], v14 offset:4096
    s_waitcnt lgkmcnt(5)
    s_waitcnt vmcnt(6)
    v_mfma_f32_16x16x32_bf16 v[96:99], v[56:59], v[172:175], v[96:99]
    v_mfma_f32_16x16x32_bf16 v[116:119], v[56:59], v[176:179], v[116:119]
    v_mfma_f32_16x16x32_bf16 v[100:103], v[60:63], v[172:175], v[100:103]
    v_mfma_f32_16x16x32_bf16 v[120:123], v[60:63], v[176:179], v[120:123]
    v_mfma_f32_16x16x32_bf16 v[104:107], v[64:67], v[172:175], v[104:107]
    v_mfma_f32_16x16x32_bf16 v[124:127], v[64:67], v[176:179], v[124:127]
    v_mfma_f32_16x16x32_bf16 v[108:111], v[68:71], v[172:175], v[108:111]
    v_mfma_f32_16x16x32_bf16 v[128:131], v[68:71], v[176:179], v[128:131]
    v_mfma_f32_16x16x32_bf16 v[112:115], v[72:75], v[172:175], v[112:115]
    v_mfma_f32_16x16x32_bf16 v[132:135], v[72:75], v[176:179], v[132:135]
    s_add_u32 s60, s50, s48
    buffer_load_dwordx4 v[204:207], v28, s[44:47], s60 offen sc1
    buffer_load_dwordx4 v[208:211], v29, s[44:47], s60 offen sc1
    s_add_u32 s48, s48, 4096
    s_cmp_eq_u32 s48, s37
    s_cselect_b32 s48, s36, s48
    v_add_u32 v14, s49, v7
    s_add_u32 s49, s49, 5120
    s_cmp_eq_u32 s49, s39
    s_cselect_b32 s49, s38, s49
    ds_read_b128 v[56:59], v14 offset:0
    ds_read_b128 v[60:63], v14 offset:1024
    ds_read_b128 v[64:67], v14 offset:2048
    ds_read_b128 v[68:71], v14 offset:3072
    ds_read_b128 v[72:75], v14 offset:4096
    s_waitcnt lgkmcnt(5)
    s_waitcnt vmcnt(6)
    v_mfma_f32_16x16x32_bf16 v[96:99], v[76:79], v[180:183], v[96:99]
    v_mfma_f32_16x16x32_bf16 v[116:119], v[76:79], v[184:187], v[116:119]
    v_mfma_f32_16x16x32_bf16 v[100:103], v[80:83], v[180:183], v[100:103]
    v_mfma_f32_16x16x32_bf16 v[120:123], v[80:83], v[184:187], v[120:123]
    v_mfma_f32_16x16x32_bf16 v[104:107], v[84:87], v[180:183], v[104:107]
    v_mfma_f32_16x16x32_bf16 v[124:127], v[84:87], v[184:187], v[124:127]
    v_mfma_f32_16x16x32_bf16 v[108:111], v[88:91], v[180:183], v[108:111]
    v_mfma_f32_16x16x32_bf16 v[128:131], v[88:91], v[184:187], v[128:131]
    v_mfma_f32_16x16x32_bf16 v[112:115], v[92:95], v[180:183], v[112:115]
    v_mfma_f32_16x16x32_bf16 v[132:135], v[92:95], v[184:187], v[132:135]
    s_add_u32 s60, s50, s48
    buffer_load_dwordx4 v[212:215], v28, s[44:47], s60 offen sc1
    buffer_load_dwordx4 v[216:219], v29, s[44:47], s60 offen sc1
    s_add_u32 s48, s48, 4096
    s_cmp_eq_u32 s48, s37
    s_cselect_b32 s48, s36, s48
    v_add_u32 v14, s49, v7
    s_add_u32 s49, s49, 5120
    s_cmp_eq_u32 s49, s39
    s_cselect_b32 s49, s38, s49
    ds_read_b128 v[76:79], v14 offset:0
    ds_read_b128 v[80:83], v14 offset:1024
    ds_read_b128 v[84:87], v14 offset:2048
    ds_read_b128 v[88:91], v14 offset:3072
    ds_read_b128 v[92:95], v14 offset:4096
    s_waitcnt lgkmcnt(5)
    s_waitcnt vmcnt(6)
    v_mfma_f32_16x16x32_bf16 v[96:99], v[56:59], v[188:191], v[96:99]
    v_mfma_f32_16x16x32_bf16 v[116:119], v[56:59], v[192:195], v[116:119]
    v_mfma_f32_16x16x32_bf16 v[100:103], v[60:63], v[188:191], v[100:103]
    v_mfma_f32_16x16x32_bf16 v[120:123], v[60:63], v[192:195], v[120:123]
    v_mfma_f32_16x16x32_bf16 v[104:107], v[64:67], v[188:191], v[104:107]
    v_mfma_f32_16x16x32_bf16 v[124:127], v[64:67], v[192:195], v[124:127]
    v_mfma_f32_16x16x32_bf16 v[108:111], v[68:71], v[188:191], v[108:111]
    v_mfma_f32_16x16x32_bf16 v[128:131], v[68:71], v[192:195], v[128:131]
    v_mfma_f32_16x16x32_bf16 v[112:115], v[72:75], v[188:191], v[112:115]
    v_mfma_f32_16x16x32_bf16 v[132:135], v[72:75], v[192:195], v[132:135]
    s_add_u32 s60, s50, s48
    buffer_load_dwordx4 v[220:223], v28, s[44:47], s60 offen sc1
    buffer_load_dwordx4 v[224:227], v29, s[44:47], s60 offen sc1
    s_add_u32 s48, s48, 4096
    s_cmp_eq_u32 s48, s37
    s_cselect_b32 s48, s36, s48
    v_add_u32 v14, s49, v7
    s_add_u32 s49, s49, 5120
    s_cmp_eq_u32 s49, s39
    s_cselect_b32 s49, s38, s49
    ds_read_b128 v[56:59], v14 offset:0
    ds_read_b128 v[60:63], v14 offset:1024
    ds_read_b128 v[64:67], v14 offset:2048
    ds_read_b128 v[68:71], v14 offset:3072
    ds_read_b128 v[72:75], v14 offset:4096
    s_waitcnt lgkmcnt(5)
    s_waitcnt vmcnt(6)
    v_mfma_f32_16x16x32_bf16 v[96:99], v[76:79], v[196:199], v[96:99]
    v_mfma_f32_16x16x32_bf16 v[116:119], v[76:79], v[200:203], v[116:119]
    v_mfma_f32_16x16x32_bf16 v[100:103], v[80:83], v[196:199], v[100:103]
    v_mfma_f32_16x16x32_bf16 v[120:123], v[80:83], v[200:203], v[120:123]
    v_mfma_f32_16x16x32_bf16 v[104:107], v[84:87], v[196:199], v[104:107]
    v_mfma_f32_16x16x32_bf16 v[124:127], v[84:87], v[200:203], v[124:127]
    v_mfma_f32_16x16x32_bf16 v[108:111], v[88:91], v[196:199], v[108:111]
    v_mfma_f32_16x16x32_bf16 v[128:131], v[88:91], v[200:203], v[128:131]
    v_mfma_f32_16x16x32_bf16 v[112:115], v[92:95], v[196:199], v[112:115]
    v_mfma_f32_16x16x32_bf16 v[132:135], v[92:95], v[200:203], v[132:135]
    s_add_u32 s60, s50, s48
    buffer_load_dwordx4 v[228:231], v28, s[44:47], s60 offen sc1
    buffer_load_dwordx4 v[232:235], v29, s[44:47], s60 offen sc1
    s_add_u32 s48, s48, 4096
    s_cmp_eq_u32 s48, s37
    s_cselect_b32 s48, s36, s48
    v_add_u32 v14, s49, v7
    s_add_u32 s49, s49, 5120
    s_cmp_eq_u32 s49, s39
    s_cselect_b32 s49, s38, s49
    ds_read_b128 v[76:79], v14 offset:0
    ds_read_b128 v[80:83], v14 offset:1024
    ds_read_b128 v[84:87], v14 offset:2048
    ds_read_b128 v[88:91], v14 offset:3072
    ds_read_b128 v[92:95], v14 offset:4096
    s_waitcnt lgkmcnt(5)
    s_waitcnt vmcnt(6)
    v_mfma_f32_16x16x32_bf16 v[96:99], v[56:59], v[204:207], v[96:99]
    v_mfma_f32_16x16x32_bf16 v[116:119], v[56:59], v[208:211], v[116:119]
    v_mfma_f32_16x16x32_bf16 v[100:103], v[60:63], v[204:207], v[100:103]
    v_mfma_f32_16x16x32_bf16 v[120:123], v[60:63], v[208:211], v[120:123]
    v_mfma_f32_16x16x32_bf16 v[104:107], v[64:67], v[204:207], v[104:107]
    v_mfma_f32_16x16x32_bf16 v[124:127], v[64:67], v[208:211], v[124:127]
    v_mfma_f32_16x16x32_bf16 v[108:111], v[68:71], v[204:207], v[108:111]
    v_mfma_f32_16x16x32_bf16 v[128:131], v[68:71], v[208:211], v[128:131]
    v_mfma_f32_16x16x32_bf16 v[112:115], v[72:75], v[204:207], v[112:115]
    v_mfma_f32_16x16x32_bf16 v[132:135], v[72:75], v[208:211], v[132:135]
    s_add_u32 s60, s50, s48
    buffer_load_dwordx4 v[236:239], v28, s[44:47], s60 offen sc1
    buffer_load_dwordx4 v[240:243], v29, s[44:47], s60 offen sc1
    s_add_u32 s48, s48, 4096
    s_cmp_eq_u32 s48, s37
    s_cselect_b32 s48, s36, s48
    v_add_u32 v14, s49, v7
    s_add_u32 s49, s49, 5120
    s_cmp_eq_u32 s49, s39
    s_cselect_b32 s49, s38, s49
    ds_read_b128 v[56:59], v14 offset:0
    ds_read_b128 v[60:63], v14 offset:1024
    ds_read_b128 v[64:67], v14 offset:2048
    ds_read_b128 v[68:71], v14 offset:3072
    ds_read_b128 v[72:75], v14 offset:4096
    s_waitcnt lgkmcnt(5)
    s_waitcnt vmcnt(6)
    v_mfma_f32_16x16x32_bf16 v[96:99], v[76:79], v[212:215], v[96:99]
    v_mfma_f32_16x16x32_bf16 v[116:119], v[76:79], v[216:219], v[116:119]
    v_mfma_f32_16x16x32_bf16 v[100:103], v[80:83], v[212:215], v[100:103]
    v_mfma_f32_16x16x32_bf16 v[120:123], v[80:83], v[216:219], v[120:123]
    v_mfma_f32_16x16x32_bf16 v[104:107], v[84:87], v[212:215], v[104:107]
    v_mfma_f32_16x16x32_bf16 v[124:127], v[84:87], v[216:219], v[124:127]
    v_mfma_f32_16x16x32_bf16 v[108:111], v[88:91], v[212:215], v[108:111]
    v_mfma_f32_16x16x32_bf16 v[128:131], v[88:91], v[216:219], v[128:131]
    v_mfma_f32_16x16x32_bf16 v[112:115], v[92:95], v[212:215], v[112:115]
    v_mfma_f32_16x16x32_bf16 v[132:135], v[92:95], v[216:219], v[132:135]
    s_add_u32 s60, s50, s48
    buffer_load_dwordx4 v[244:247], v28, s[44:47], s60 offen sc1
    buffer_load_dwordx4 v[248:251], v29, s[44:47], s60 offen sc1
    s_add_u32 s48, s48, 4096
    s_cmp_eq_u32 s48, s37
    s_cselect_b32 s48, s36, s48
    v_add_u32 v14, s49, v7
    s_add_u32 s49, s49, 5120
    s_cmp_eq_u32 s49, s39
    s_cselect_b32 s49, s38, s49
    ds_read_b128 v[76:79], v14 offset:0
    ds_read_b128 v[80:83], v14 offset:1024
    ds_read_b128 v[84:87], v14 offset:2048
    ds_read_b128 v[88:91], v14 offset:3072
    ds_read_b128 v[92:95], v14 offset:4096
    s_waitcnt lgkmcnt(5)
    s_waitcnt vmcnt(6)
    v_mfma_f32_16x16x32_bf16 v[96:99], v[56:59], v[220:223], v[96:99]
    v_mfma_f32_16x16x32_bf16 v[116:119], v[56:59], v[224:227], v[116:119]
    v_mfma_f32_16x16x32_bf16 v[100:103], v[60:63], v[220:223], v[100:103]
    v_mfma_f32_16x16x32_bf16 v[120:123], v[60:63], v[224:227], v[120:123]
    v_mfma_f32_16x16x32_bf16 v[104:107], v[64:67], v[220:223], v[104:107]
    v_mfma_f32_16x16x32_bf16 v[124:127], v[64:67], v[224:227], v[124:127]
    v_mfma_f32_16x16x32_bf16 v[108:111], v[68:71], v[220:223], v[108:111]
    v_mfma_f32_16x16x32_bf16 v[128:131], v[68:71], v[224:227], v[128:131]
    v_mfma_f32_16x16x32_bf16 v[112:115], v[72:75], v[220:223], v[112:115]
    v_mfma_f32_16x16x32_bf16 v[132:135], v[72:75], v[224:227], v[132:135]
    v_add_u32 v14, s49, v7
    s_add_u32 s49, s49, 5120
    s_cmp_eq_u32 s49, s39
    s_cselect_b32 s49, s38, s49
    ds_read_b128 v[56:59], v14 offset:0
    ds_read_b128 v[60:63], v14 offset:1024
    ds_read_b128 v[64:67], v14 offset:2048
    ds_read_b128 v[68:71], v14 offset:3072
    ds_read_b128 v[72:75], v14 offset:4096
    s_waitcnt lgkmcnt(5)
    s_waitcnt vmcnt(4)
    v_mfma_f32_16x16x32_bf16 v[96:99], v[76:79], v[228:231], v[96:99]
    v_mfma_f32_16x16x32_bf16 v[116:119], v[76:79], v[232:235], v[116:119]
    v_mfma_f32_16x16x32_bf16 v[100:103], v[80:83], v[228:231], v[100:103]
    v_mfma_f32_16x16x32_bf16 v[120:123], v[80:83], v[232:235], v[120:123]
    v_mfma_f32_16x16x32_bf16 v[104:107], v[84:87], v[228:231], v[104:107]
    v_mfma_f32_16x16x32_bf16 v[124:127], v[84:87], v[232:235], v[124:127]
    v_mfma_f32_16x16x32_bf16 v[108:111], v[88:91], v[228:231], v[108:111]
    v_mfma_f32_16x16x32_bf16 v[128:131], v[88:91], v[232:235], v[128:131]
    v_mfma_f32_16x16x32_bf16 v[112:115], v[92:95], v[228:231], v[112:115]
    v_mfma_f32_16x16x32_bf16 v[132:135], v[92:95], v[232:235], v[132:135]
    v_add_u32 v14, s49, v7
    s_add_u32 s49, s49, 5120
    s_cmp_eq_u32 s49, s39
    s_cselect_b32 s49, s38, s49
    ds_read_b128 v[76:79], v14 offset:0
    ds_read_b128 v[80:83], v14 offset:1024
    ds_read_b128 v[84:87], v14 offset:2048
    ds_read_b128 v[88:91], v14 offset:3072
    ds_read_b128 v[92:95], v14 offset:4096
    s_waitcnt lgkmcnt(5)
    s_waitcnt vmcnt(2)
    v_mfma_f32_16x16x32_bf16 v[96:99], v[56:59], v[236:239], v[96:99]
    v_mfma_f32_16x16x32_bf16 v[116:119], v[56:59], v[240:243], v[116:119]
    v_mfma_f32_16x16x32_bf16 v[100:103], v[60:63], v[236:239], v[100:103]
    v_mfma_f32_16x16x32_bf16 v[120:123], v[60:63], v[240:243], v[120:123]
    v_mfma_f32_16x16x32_bf16 v[104:107], v[64:67], v[236:239], v[104:107]
    v_mfma_f32_16x16x32_bf16 v[124:127], v[64:67], v[240:243], v[124:127]
    v_mfma_f32_16x16x32_bf16 v[108:111], v[68:71], v[236:239], v[108:111]
    v_mfma_f32_16x16x32_bf16 v[128:131], v[68:71], v[240:243], v[128:131]
    v_mfma_f32_16x16x32_bf16 v[112:115], v[72:75], v[236:239], v[112:115]
    v_mfma_f32_16x16x32_bf16 v[132:135], v[72:75], v[240:243], v[132:135]
    s_bitcmp1_b32 s101, 0
    s_cbranch_scc1 Lb_241
    s_waitcnt lgkmcnt(0)
    s_waitcnt vmcnt(0)
    v_mfma_f32_16x16x32_bf16 v[96:99], v[76:79], v[244:247], v[96:99]
    v_mfma_f32_16x16x32_bf16 v[116:119], v[76:79], v[248:251], v[116:119]
    v_mfma_f32_16x16x32_bf16 v[100:103], v[80:83], v[244:247], v[100:103]
    v_mfma_f32_16x16x32_bf16 v[120:123], v[80:83], v[248:251], v[120:123]
    v_mfma_f32_16x16x32_bf16 v[104:107], v[84:87], v[244:247], v[104:107]
    v_mfma_f32_16x16x32_bf16 v[124:127], v[84:87], v[248:251], v[124:127]
    v_mfma_f32_16x16x32_bf16 v[108:111], v[88:91], v[244:247], v[108:111]
    v_mfma_f32_16x16x32_bf16 v[128:131], v[88:91], v[248:251], v[128:131]
    v_mfma_f32_16x16x32_bf16 v[112:115], v[92:95], v[244:247], v[112:115]
    v_mfma_f32_16x16x32_bf16 v[132:135], v[92:95], v[248:251], v[132:135]
Lb_241:
    s_setprio 2
    s_mul_i32 s60, s101, 5120
    s_add_u32 s60, s60, 138240
    v_add_u32 v10, s60, v7
    s_xor_b32 s60, s101, 1
    s_mul_i32 s60, s60, 5120
    s_add_u32 s60, s60, 138240
    v_add_u32 v11, s60, v7
    s_waitcnt vmcnt(0)
    ds_write_b128 v10, v[116:119] offset:0
    ds_write_b128 v10, v[120:123] offset:1024
    ds_write_b128 v10, v[124:127] offset:2048
    ds_write_b128 v10, v[128:131] offset:3072
    ds_write_b128 v10, v[132:135] offset:4096
    s_waitcnt lgkmcnt(0)
    v_mov_b32 v8, 0x27e10
    v_mov_b32 v9, 1
    s_mov_b64 exec, 1
    ds_add_u32 v8, v9
    s_mov_b64 exec, -1
    v_mov_b32 v8, 0x27e10
    s_mov_b32 s3, 0x100000
Lbs_242:
    ds_read_b32 v9, v8
    s_waitcnt lgkmcnt(0)
    v_readfirstlane_b32 s6, v9
    s_nop 0
    s_cmp_ge_u32 s6, 4
    s_cbranch_scc1 Lbsd_243
    s_sub_u32 s3, s3, 1
    s_cbranch_scc1 Lbsd_243
    s_sleep 1
    s_branch Lbs_242
Lbsd_243:
    ds_read_b128 v[116:119], v11 offset:0
    ds_read_b128 v[120:123], v11 offset:1024
    ds_read_b128 v[124:127], v11 offset:2048
    ds_read_b128 v[128:131], v11 offset:3072
    ds_read_b128 v[132:135], v11 offset:4096
    s_and_b32 s48, s53, 3
    s_mov_b32 s49, 5
    s_lshl_b32 s61, s48, 2
    s_add_u32 s61, s61, s101
    s_cmp_eq_u32 s61, 19
    s_cbranch_scc1 Lb_244
    s_mul_i32 s61, s48, 20480
    s_add_u32 s60, s61, s92
    s_add_u32 s60, s60, 138240
    s_add_u32 m0, s61, s93
    s_nop 0
    buffer_load_dwordx4 v7, s[44:47], s60 offen offset:0 sc1 lds
    buffer_load_dwordx4 v7, s[44:47], s60 offen offset:1024 sc1 lds
    buffer_load_dwordx4 v7, s[44:47], s60 offen offset:2048 sc1 lds
    buffer_load_dwordx4 v7, s[44:47], s60 offen offset:3072 sc1 lds
    s_add_u32 m0, m0, 4096
    s_add_u32 s60, s60, 4096
    buffer_load_dwordx4 v7, s[44:47], s60 offen offset:0 sc1 lds
Lb_244:
    s_add_u32 s48, s48, 1
    s_cmp_eq_u32 s48, s49
    s_cselect_b32 s48, 0, s48
    s_waitcnt lgkmcnt(0)
    s_lshl_b32 s61, s48, 2
    s_add_u32 s61, s61, s101
    s_cmp_eq_u32 s61, 19
    s_cbranch_scc1 Lb_245
    s_mul_i32 s61, s48, 20480
    s_add_u32 s60, s61, s92
    s_add_u32 s60, s60, 138240
    s_add_u32 m0, s61, s93
    s_waitcnt vmcnt(8)
    buffer_load_dwordx4 v7, s[44:47], s60 offen offset:0 sc1 lds
    s_waitcnt vmcnt(8)
    buffer_load_dwordx4 v7, s[44:47], s60 offen offset:1024 sc1 lds
    s_waitcnt vmcnt(8)
    buffer_load_dwordx4 v7, s[44:47], s60 offen offset:2048 sc1 lds
    s_waitcnt vmcnt(8)
    buffer_load_dwordx4 v7, s[44:47], s60 offen offset:3072 sc1 lds
    s_add_u32 m0, m0, 4096
    s_add_u32 s60, s60, 4096
    s_waitcnt vmcnt(8)
    buffer_load_dwordx4 v7, s[44:47], s60 offen offset:0 sc1 lds
Lb_245:
    s_add_u32 s48, s48, 1
    s_cmp_eq_u32 s48, s49
    s_cselect_b32 s48, 0, s48
    s_lshl_b32 s61, s48, 2
    s_add_u32 s61, s61, s101
    s_cmp_eq_u32 s61, 19
    s_cbranch_scc1 Lb_246
    s_mul_i32 s61, s48, 20480
    s_add_u32 s60, s61, s92
    s_add_u32 s60, s60, 138240
    s_add_u32 m0, s61, s93
    s_waitcnt vmcnt(8)
    buffer_load_dwordx4 v7, s[44:47], s60 offen offset:0 sc1 lds
    s_waitcnt vmcnt(8)
    buffer_load_dwordx4 v7, s[44:47], s60 offen offset:1024 sc1 lds
    s_waitcnt vmcnt(8)
    buffer_load_dwordx4 v7, s[44:47], s60 offen offset:2048 sc1 lds
    s_waitcnt vmcnt(8)
    buffer_load_dwordx4 v7, s[44:47], s60 offen offset:3072 sc1 lds
    s_add_u32 m0, m0, 4096
    s_add_u32 s60, s60, 4096
    s_waitcnt vmcnt(8)
    buffer_load_dwordx4 v7, s[44:47], s60 offen offset:0 sc1 lds
Lb_246:
    s_add_u32 s48, s48, 1
    s_cmp_eq_u32 s48, s49
    s_cselect_b32 s48, 0, s48
    s_lshl_b32 s61, s48, 2
    s_add_u32 s61, s61, s101
    s_cmp_eq_u32 s61, 19
    s_cbranch_scc1 Lb_247
    s_mul_i32 s61, s48, 20480
    s_add_u32 s60, s61, s92
    s_add_u32 s60, s60, 138240
    s_add_u32 m0, s61, s93
    s_waitcnt vmcnt(8)
    buffer_load_dwordx4 v7, s[44:47], s60 offen offset:0 sc1 lds
    s_waitcnt vmcnt(8)
    buffer_load_dwordx4 v7, s[44:47], s60 offen offset:1024 sc1 lds
    s_waitcnt vmcnt(8)
    buffer_load_dwordx4 v7, s[44:47], s60 offen offset:2048 sc1 lds
    s_waitcnt vmcnt(8)
    buffer_load_dwordx4 v7, s[44:47], s60 offen offset:3072 sc1 lds
    s_add_u32 m0, m0, 4096
    s_add_u32 s60, s60, 4096
    s_waitcnt vmcnt(8)
    buffer_load_dwordx4 v7, s[44:47], s60 offen offset:0 sc1 lds
Lb_247:
    s_add_u32 s48, s48, 1
    s_cmp_eq_u32 s48, s49
    s_cselect_b32 s48, 0, s48
    s_lshl_b32 s61, s48, 2
    s_add_u32 s61, s61, s101
    s_cmp_eq_u32 s61, 19
    s_cbranch_scc1 Lb_248
    s_mul_i32 s61, s48, 20480
    s_add_u32 s60, s61, s92
    s_add_u32 s60, s60, 138240
    s_add_u32 m0, s61, s93
    s_waitcnt vmcnt(8)
    buffer_load_dwordx4 v7, s[44:47], s60 offen offset:0 sc1 lds
    s_waitcnt vmcnt(8)
    buffer_load_dwordx4 v7, s[44:47], s60 offen offset:1024 sc1 lds
    s_waitcnt vmcnt(8)
    buffer_load_dwordx4 v7, s[44:47], s60 offen offset:2048 sc1 lds
    s_waitcnt vmcnt(8)
    buffer_load_dwordx4 v7, s[44:47], s60 offen offset:3072 sc1 lds
    s_add_u32 m0, m0, 4096
    s_add_u32 s60, s60, 4096
    s_waitcnt vmcnt(8)
    buffer_load_dwordx4 v7, s[44:47], s60 offen offset:0 sc1 lds
Lb_248:
    s_add_u32 s48, s48, 1
    s_cmp_eq_u32 s48, s49
    s_cselect_b32 s48, 0, s48
    s_waitcnt vmcnt(0)
    s_barrier
    v_pk_add_f32 v[96:97], v[96:97], v[116:117]
    v_pk_add_f32 v[98:99], v[98:99], v[118:119]
    v_pk_add_f32 v[100:101], v[100:101], v[120:121]
    v_pk_add_f32 v[102:103], v[102:103], v[122:123]
    v_pk_add_f32 v[104:105], v[104:105], v[124:125]
    v_pk_add_f32 v[106:107], v[106:107], v[126:127]
    v_pk_add_f32 v[108:109], v[108:109], v[128:129]
    v_pk_add_f32 v[110:111], v[110:111], v[130:131]
    v_pk_add_f32 v[112:113], v[112:113], v[132:133]
    v_pk_add_f32 v[114:115], v[114:115], v[134:135]
    buffer_load_dwordx2 v[30:31], v46, s[8:11], s100 offen offset:0
    buffer_load_dwordx2 v[32:33], v46, s[8:11], s100 offen offset:32
    buffer_load_dwordx2 v[34:35], v46, s[8:11], s100 offen offset:64
    buffer_load_dwordx2 v[36:37], v46, s[8:11], s100 offen offset:96
    buffer_load_dwordx2 v[38:39], v46, s[8:11], s100 offen offset:128
    s_lshr_b32 s62, s52, 2
    s_mul_i32 s60, s62, 6
    s_bitcmp1_b32 s54, 0
    s_cselect_b32 s95, 3, s60
    s_mul_i32 s60, s62, 10
    s_add_u32 s60, s60, s95
    s_mul_i32 s60, s60, 5120
    v_add_u32 v25, s60, v7
    s_cmp_eq_u32 s95, 6
    s_cselect_b32 s61, -6, 4
    s_mul_i32 s61, s61, 5120
    v_add_u32 v51, s61, v25
    s_cmp_ge_u32 s95, 3
    s_cselect_b32 s61, -3, 7
    s_mul_i32 s61, s61, 5120
    v_add_u32 v55, s61, v25
    s_mul_i32 s60, s54, 48
    s_mul_i32 s61, s62, 10
    s_add_u32 s60, s60, s61
    s_add_u32 s60, s60, 27
    s_mul_i32 s60, s60, 5120
    s_add_u32 s94, s60, 0xf00000
    v_lshlrev_b32 v52, 2, v2
    s_lshl_b32 s60, s53, 3
    s_add_u32 s60, s60, s54
    s_lshl_b32 s60, s60, 8
    s_add_u32 s96, s60, 0x30080
    s_mul_i32 s60, s53, 20
    s_mul_i32 s61, s62, 10
    s_add_u32 s60, s60, s61
    s_lshl_b32 s60, s60, 12
    s_and_b32 s61, s52, 3
    s_lshl_b32 s61, s61, 10
    s_add_u32 s60, s60, s61
    s_add_u32 s90, s60, 0x900000
    s_lshl_b32 s61, s62, 2
    s_lshl_b32 s4, 15, s61
    s_mov_b32 s5, 0
    s_mov_b32 s91, 4096
    s_cmp_eq_u32 s95, 3
    s_cbranch_scc1 Lb_249
    s_add_u32 s60, s95, 3
    s_cmp_ge_u32 s60, 10
    s_cselect_b32 s61, 10, 0
    s_sub_u32 s60, s60, s61
    s_mul_i32 s60, s60, 5120
    s_add_u32 s60, s60, s94
    s_add_u32 s61, s60, 4096
    buffer_load_dwordx4 v[116:119], v7, s[44:47], s60 offen offset:0 sc1
    buffer_load_dwordx4 v[120:123], v7, s[44:47], s60 offen offset:1024 sc1
    buffer_load_dwordx4 v[124:127], v7, s[44:47], s60 offen offset:2048 sc1
    buffer_load_dwordx4 v[128:131], v7, s[44:47], s60 offen offset:3072 sc1
    buffer_load_dwordx4 v[132:135], v7, s[44:47], s61 offen offset:0 sc1
    s_branch Lb_250
Lb_249:
    s_add_u32 s60, s95, 6
    s_cmp_ge_u32 s60, 10
    s_cselect_b32 s61, 10, 0
    s_sub_u32 s60, s60, s61
    s_mul_i32 s60, s60, 5120
    s_add_u32 s60, s60, s94
    s_add_u32 s61, s60, 4096
    buffer_load_dwordx4 v[176:179], v7, s[44:47], s60 offen offset:0 sc1
    buffer_load_dwordx4 v[180:183], v7, s[44:47], s60 offen offset:1024 sc1
    buffer_load_dwordx4 v[184:187], v7, s[44:47], s60 offen offset:2048 sc1
    buffer_load_dwordx4 v[188:191], v7, s[44:47], s60 offen offset:3072 sc1
    buffer_load_dwordx4 v[192:195], v7, s[44:47], s61 offen offset:0 sc1
Lb_250:
    v_mov_b32 v8, 0xbfb8aa3b
    v_pk_mul_f32 v[56:57], v[96:97], v[8:9] op_sel_hi:[1,0]
    v_pk_mul_f32 v[58:59], v[98:99], v[8:9] op_sel_hi:[1,0]
    v_pk_mul_f32 v[60:61], v[100:101], v[8:9] op_sel_hi:[1,0]
    v_pk_mul_f32 v[62:63], v[102:103], v[8:9] op_sel_hi:[1,0]
    v_pk_mul_f32 v[64:65], v[104:105], v[8:9] op_sel_hi:[1,0]
    v_pk_mul_f32 v[66:67], v[106:107], v[8:9] op_sel_hi:[1,0]
    v_pk_mul_f32 v[68:69], v[108:109], v[8:9] op_sel_hi:[1,0]
    v_pk_mul_f32 v[70:71], v[110:111], v[8:9] op_sel_hi:[1,0]
    v_pk_mul_f32 v[72:73], v[112:113], v[8:9] op_sel_hi:[1,0]
    v_pk_mul_f32 v[74:75], v[114:115], v[8:9] op_sel_hi:[1,0]
    v_exp_f32 v56, v56
    v_exp_f32 v57, v57
    v_exp_f32 v58, v58
    v_exp_f32 v59, v59
    v_exp_f32 v60, v60
    v_exp_f32 v61, v61
    v_exp_f32 v62, v62
    v_exp_f32 v63, v63
    v_exp_f32 v64, v64
    v_exp_f32 v65, v65
    v_exp_f32 v66, v66
    v_exp_f32 v67, v67
    v_exp_f32 v68, v68
    v_exp_f32 v69, v69
    v_exp_f32 v70, v70
    v_exp_f32 v71, v71
    v_exp_f32 v72, v72
    v_exp_f32 v73, v73
    v_exp_f32 v74, v74
    v_exp_f32 v75, v75
    v_pk_add_f32 v[56:57], v[56:57], 1.0 op_sel_hi:[1,0]
    v_pk_add_f32 v[58:59], v[58:59], 1.0 op_sel_hi:[1,0]
    v_pk_add_f32 v[60:61], v[60:61], 1.0 op_sel_hi:[1,0]
    v_pk_add_f32 v[62:63], v[62:63], 1.0 op_sel_hi:[1,0]
    v_pk_add_f32 v[64:65], v[64:65], 1.0 op_sel_hi:[1,0]
    v_pk_add_f32 v[66:67], v[66:67], 1.0 op_sel_hi:[1,0]
    v_pk_add_f32 v[68:69], v[68:69], 1.0 op_sel_hi:[1,0]
    v_pk_add_f32 v[70:71], v[70:71], 1.0 op_sel_hi:[1,0]
    v_pk_add_f32 v[72:73], v[72:73], 1.0 op_sel_hi:[1,0]
    v_pk_add_f32 v[74:75], v[74:75], 1.0 op_sel_hi:[1,0]
    v_rcp_f32 v56, v56
    v_rcp_f32 v57, v57
    v_rcp_f32 v58, v58
    v_rcp_f32 v59, v59
    v_rcp_f32 v60, v60
    v_rcp_f32 v61, v61
    v_rcp_f32 v62, v62
    v_rcp_f32 v63, v63
    v_rcp_f32 v64, v64
    v_rcp_f32 v65, v65
    v_rcp_f32 v66, v66
    v_rcp_f32 v67, v67
    v_rcp_f32 v68, v68
    v_rcp_f32 v69, v69
    v_rcp_f32 v70, v70
    v_rcp_f32 v71, v71
    v_rcp_f32 v72, v72
    v_rcp_f32 v73, v73
    v_rcp_f32 v74, v74
    v_rcp_f32 v75, v75
    v_mul_f32 v12, v96, v56
    v_mul_f32 v13, v97, v57
    v_mul_f32 v14, v98, v58
    v_mul_f32 v15, v99, v59
    v_mul_f32 v16, v100, v60
    v_mul_f32 v17, v101, v61
    v_mul_f32 v18, v102, v62
    v_mul_f32 v19, v103, v63
    v_mul_f32 v20, v104, v64
    v_mul_f32 v21, v105, v65
    v_mul_f32 v22, v106, v66
    v_mul_f32 v23, v107, v67
    v_mul_f32 v24, v108, v68
    v_mul_f32 v26, v109, v69
    v_mul_f32 v27, v110, v70
    v_mul_f32 v28, v111, v71
    v_mul_f32 v29, v112, v72
    v_mul_f32 v48, v113, v73
    v_mul_f32 v49, v114, v74
    v_mul_f32 v50, v115, v75
    s_barrier
    s_barrier
    s_barrier
    ds_read_b128 v[56:59], v25 offset:0
    ds_read_b128 v[60:63], v25 offset:1024
    ds_read_b128 v[64:67], v25 offset:2048
    ds_read_b128 v[68:71], v25 offset:3072
    ds_read_b128 v[72:75], v25 offset:4096
    ds_read_b128 v[76:79], v25 offset:5120
    ds_read_b128 v[80:83], v25 offset:6144
    ds_read_b128 v[84:87], v25 offset:7168
    ds_read_b128 v[88:91], v25 offset:8192
    ds_read_b128 v[92:95], v25 offset:9216
    ds_read_b128 v[96:99], v25 offset:10240
    ds_read_b128 v[100:103], v25 offset:11264
    ds_read_b128 v[104:107], v25 offset:12288
    ds_read_b128 v[108:111], v25 offset:13312
    ds_read_b128 v[112:115], v25 offset:14336
    ds_read_b128 v[136:139], v51 offset:0
    ds_read_b128 v[140:143], v51 offset:1024
    ds_read_b128 v[144:147], v51 offset:2048
    ds_read_b128 v[148:151], v51 offset:3072
    ds_read_b128 v[152:155], v51 offset:4096
    ds_read_b128 v[156:159], v51 offset:5120
    ds_read_b128 v[160:163], v51 offset:6144
    ds_read_b128 v[164:167], v51 offset:7168
    ds_read_b128 v[168:171], v51 offset:8192
    ds_read_b128 v[172:175], v51 offset:9216
    s_cmp_eq_u32 s95, 3
    s_cbranch_scc1 Lb_251
    ds_read_b128 v[176:179], v51 offset:10240
    ds_read_b128 v[180:183], v51 offset:11264
    ds_read_b128 v[184:187], v51 offset:12288
    ds_read_b128 v[188:191], v51 offset:13312
    ds_read_b128 v[192:195], v51 offset:14336
    s_branch L_tail
Lb_251:
    ds_read_b128 v[116:119], v25 offset:15360
    ds_read_b128 v[120:123], v25 offset:16384
    ds_read_b128 v[124:127], v25 offset:17408
    ds_read_b128 v[128:131], v25 offset:18432
    ds_read_b128 v[132:135], v25 offset:19456
    s_branch L_tail
L_redo:
    s_add_u32 s60, s95, 0
    s_cmp_ge_u32 s60, 10
    s_cselect_b32 s61, 10, 0
    s_sub_u32 s60, s60, s61
    s_mul_i32 s60, s60, 5120
    s_add_u32 s60, s60, s94
    s_add_u32 s61, s60, 4096
    buffer_load_dwordx4 v[56:59], v7, s[44:47], s60 offen offset:0 sc1
    buffer_load_dwordx4 v[60:63], v7, s[44:47], s60 offen offset:1024 sc1
    buffer_load_dwordx4 v[64:67], v7, s[44:47], s60 offen offset:2048 sc1
    buffer_load_dwordx4 v[68:71], v7, s[44:47], s60 offen offset:3072 sc1
    buffer_load_dwordx4 v[72:75], v7, s[44:47], s61 offen offset:0 sc1
    s_add_u32 s60, s95, 1
    s_cmp_ge_u32 s60, 10
    s_cselect_b32 s61, 10, 0
    s_sub_u32 s60, s60, s61
    s_mul_i32 s60, s60, 5120
    s_add_u32 s60, s60, s94
    s_add_u32 s61, s60, 4096
    buffer_load_dwordx4 v[76:79], v7, s[44:47], s60 offen offset:0 sc1
    buffer_load_dwordx4 v[80:83], v7, s[44:47], s60 offen offset:1024 sc1
    buffer_load_dwordx4 v[84:87], v7, s[44:47], s60 offen offset:2048 sc1
    buffer_load_dwordx4 v[88:91], v7, s[44:47], s60 offen offset:3072 sc1
    buffer_load_dwordx4 v[92:95], v7, s[44:47], s61 offen offset:0 sc1
    s_add_u32 s60, s95, 2
    s_cmp_ge_u32 s60, 10
    s_cselect_b32 s61, 10, 0
    s_sub_u32 s60, s60, s61
    s_mul_i32 s60, s60, 5120
    s_add_u32 s60, s60, s94
    s_add_u32 s61, s60, 4096
    buffer_load_dwordx4 v[96:99], v7, s[44:47], s60 offen offset:0 sc1
    buffer_load_dwordx4 v[100:103], v7, s[44:47], s60 offen offset:1024 sc1
    buffer_load_dwordx4 v[104:107], v7, s[44:47], s60 offen offset:2048 sc1
    buffer_load_dwordx4 v[108:111], v7, s[44:47], s60 offen offset:3072 sc1
    buffer_load_dwordx4 v[112:115], v7, s[44:47], s61 offen offset:0 sc1
    s_add_u32 s60, s95, 3
    s_cmp_ge_u32 s60, 10
    s_cselect_b32 s61, 10, 0
    s_sub_u32 s60, s60, s61
    s_mul_i32 s60, s60, 5120
    s_add_u32 s60, s60, s94
    s_add_u32 s61, s60, 4096
    buffer_load_dwordx4 v[116:119], v7, s[44:47], s60 offen offset:0 sc1
    buffer_load_dwordx4 v[120:123], v7, s[44:47], s60 offen offset:1024 sc1
    buffer_load_dwordx4 v[124:127], v7, s[44:47], s60 offen offset:2048 sc1
    buffer_load_dwordx4 v[128:131], v7, s[44:47], s60 offen offset:3072 sc1
    buffer_load_dwordx4 v[132:135], v7, s[44:47], s61 offen offset:0 sc1
    s_add_u32 s60, s95, 4
    s_cmp_ge_u32 s60, 10
    s_cselect_b32 s61, 10, 0
    s_sub_u32 s60, s60, s61
    s_mul_i32 s60, s60, 5120
    s_add_u32 s60, s60, s94
    s_add_u32 s61, s60, 4096
    buffer_load_dwordx4 v[136:139], v7, s[44:47], s60 offen offset:0 sc1
    buffer_load_dwordx4 v[140:143], v7, s[44:47], s60 offen offset:1024 sc1
    buffer_load_dwordx4 v[144:147], v7, s[44:47], s60 offen offset:2048 sc1
    buffer_load_dwordx4 v[148:151], v7, s[44:47], s60 offen offset:3072 sc1
    buffer_load_dwordx4 v[152:155], v7, s[44:47], s61 offen offset:0 sc1
    s_add_u32 s60, s95, 5
    s_cmp_ge_u32 s60, 10
    s_cselect_b32 s61, 10, 0
    s_sub_u32 s60, s60, s61
    s_mul_i32 s60, s60, 5120
    s_add_u32 s60, s60, s94
    s_add_u32 s61, s60, 4096
    buffer_load_dwordx4 v[156:159], v7, s[44:47], s60 offen offset:0 sc1
    buffer_load_dwordx4 v[160:163], v7, s[44:47], s60 offen offset:1024 sc1
    buffer_load_dwordx4 v[164:167], v7, s[44:47], s60 offen offset:2048 sc1
    buffer_load_dwordx4 v[168:171], v7, s[44:47], s60 offen offset:3072 sc1
    buffer_load_dwordx4 v[172:175], v7, s[44:47], s61 offen offset:0 sc1
    s_add_u32 s60, s95, 6
    s_cmp_ge_u32 s60, 10
    s_cselect_b32 s61, 10, 0
    s_sub_u32 s60, s60, s61
    s_mul_i32 s60, s60, 5120
    s_add_u32 s60, s60, s94
    s_add_u32 s61, s60, 4096
    buffer_load_dwordx4 v[176:179], v7, s[44:47], s60 offen offset:0 sc1
    buffer_load_dwordx4 v[180:183], v7, s[44:47], s60 offen offset:1024 sc1
    buffer_load_dwordx4 v[184:187], v7, s[44:47], s60 offen offset:2048 sc1
    buffer_load_dwordx4 v[188:191], v7, s[44:47], s60 offen offset:3072 sc1
    buffer_load_dwordx4 v[192:195], v7, s[44:47], s61 offen offset:0 sc1
L_tail:
    s_mov_b32 s3, 0x20000
Lpoll_252:
    buffer_load_dword v53, v52, s[44:47], s96 offen sc1
    s_waitcnt vmcnt(0)
Lpollc_253:
    v_cmp_ne_u32 vcc, 0, v53
    s_nop 0
    s_and_b64 s[6:7], vcc, s[4:5]
    s_cmp_eq_u64 s[6:7], s[4:5]
    s_cbranch_scc1 Lpolld_254
    s_sub_u32 s3, s3, 1
    s_cbranch_scc1 Lpolld_254
    s_sleep 2
    s_branch Lpoll_252
Lpolld_254:
    s_lshl_b32 s61, s95, 12
    s_add_u32 s60, s61, s90
    buffer_load_dwordx4 v[216:219], v7, s[44:47], s60 offen sc1
    s_add_u32 s61, s61, 4096
    s_cmp_eq_u32 s61, 40960
    s_cselect_b32 s61, 0, s61
    s_add_u32 s60, s61, s90
    buffer_load_dwordx4 v[220:223], v7, s[44:47], s60 offen sc1
    s_add_u32 s61, s61, 4096
    s_cmp_eq_u32 s61, 40960
    s_cselect_b32 s61, 0, s61
    s_add_u32 s60, s61, s90
    buffer_load_dwordx4 v[224:227], v7, s[44:47], s60 offen sc1
    s_add_u32 s61, s61, 4096
    s_cmp_eq_u32 s61, 40960
    s_cselect_b32 s61, 0, s61
    s_add_u32 s60, s61, s90
    buffer_load_dwordx4 v[228:231], v7, s[44:47], s60 offen sc1
    s_add_u32 s61, s61, 4096
    s_cmp_eq_u32 s61, 40960
    s_cselect_b32 s61, 0, s61
    s_add_u32 s60, s61, s90
    buffer_load_dwordx4 v[232:235], v7, s[44:47], s60 offen sc1
    s_add_u32 s61, s61, 4096
    s_cmp_eq_u32 s61, 40960
    s_cselect_b32 s61, 0, s61
    s_add_u32 s60, s61, s90
    buffer_load_dwordx4 v[236:239], v7, s[44:47], s60 offen sc1
    s_add_u32 s61, s61, 4096
    s_cmp_eq_u32 s61, 40960
    s_cselect_b32 s61, 0, s61
    s_add_u32 s60, s61, s90
    buffer_load_dwordx4 v[240:243], v7, s[44:47], s60 offen sc1
    s_add_u32 s61, s61, 4096
    s_cmp_eq_u32 s61, 40960
    s_cselect_b32 s61, 0, s61
    s_add_u32 s60, s61, s90
    buffer_load_dwordx4 v[244:247], v7, s[44:47], s60 offen sc1
    s_add_u32 s61, s61, 4096
    s_cmp_eq_u32 s61, 40960
    s_cselect_b32 s61, 0, s61
    s_add_u32 s60, s61, s90
    buffer_load_dwordx4 v[248:251], v7, s[44:47], s60 offen sc1
    s_add_u32 s61, s61, 4096
    s_cmp_eq_u32 s61, 40960
    s_cselect_b32 s61, 0, s61
    s_add_u32 s60, s61, s90
    buffer_load_dwordx4 v[252:255], v7, s[44:47], s60 offen sc1
    s_add_u32 s61, s61, 4096
    s_cmp_eq_u32 s61, 40960
    s_cselect_b32 s61, 0, s61
    v_mov_b32 v53, 0
    s_waitcnt lgkmcnt(0)
    s_waitcnt vmcnt(9)
    v_mfma_f32_16x16x32_bf16 v[196:199], v[56:59], v[216:219], 0
    v_mfma_f32_16x16x32_bf16 v[200:203], v[60:63], v[216:219], 0
    v_mfma_f32_16x16x32_bf16 v[204:207], v[64:67], v[216:219], 0
    v_mfma_f32_16x16x32_bf16 v[208:211], v[68:71], v[216:219], 0
    v_mfma_f32_16x16x32_bf16 v[212:215], v[72:75], v[216:219], 0
    ds_read_b128 v[56:59], v55 offset:0
    ds_read_b128 v[60:63], v55 offset:1024
    ds_read_b128 v[64:67], v55 offset:2048
    ds_read_b128 v[68:71], v55 offset:3072
    ds_read_b128 v[72:75], v55 offset:4096
    s_waitcnt vmcnt(8)
    v_mfma_f32_16x16x32_bf16 v[196:199], v[76:79], v[220:223], v[196:199]
    v_mfma_f32_16x16x32_bf16 v[200:203], v[80:83], v[220:223], v[200:203]
    v_mfma_f32_16x16x32_bf16 v[204:207], v[84:87], v[220:223], v[204:207]
    v_mfma_f32_16x16x32_bf16 v[208:211], v[88:91], v[220:223], v[208:211]
    v_mfma_f32_16x16x32_bf16 v[212:215], v[92:95], v[220:223], v[212:215]
    v_max3_u32 v53, v216, v220, v53
    ds_read_b128 v[76:79], v55 offset:5120
    ds_read_b128 v[80:83], v55 offset:6144
    ds_read_b128 v[84:87], v55 offset:7168
    ds_read_b128 v[88:91], v55 offset:8192
    ds_read_b128 v[92:95], v55 offset:9216
    s_waitcnt vmcnt(7)
    v_mfma_f32_16x16x32_bf16 v[196:199], v[96:99], v[224:227], v[196:199]
    v_mfma_f32_16x16x32_bf16 v[200:203], v[100:103], v[224:227], v[200:203]
    v_mfma_f32_16x16x32_bf16 v[204:207], v[104:107], v[224:227], v[204:207]
    v_mfma_f32_16x16x32_bf16 v[208:211], v[108:111], v[224:227], v[208:211]
    v_mfma_f32_16x16x32_bf16 v[212:215], v[112:115], v[224:227], v[212:215]
    ds_read_b128 v[96:99], v55 offset:10240
    ds_read_b128 v[100:103], v55 offset:11264
    ds_read_b128 v[104:107], v55 offset:12288
    ds_read_b128 v[108:111], v55 offset:13312
    ds_read_b128 v[112:115], v55 offset:14336
    s_waitcnt vmcnt(6)
    v_mfma_f32_16x16x32_bf16 v[196:199], v[116:119], v[228:231], v[196:199]
    v_mfma_f32_16x16x32_bf16 v[200:203], v[120:123], v[228:231], v[200:203]
    v_mfma_f32_16x16x32_bf16 v[204:207], v[124:127], v[228:231], v[204:207]
    v_mfma_f32_16x16x32_bf16 v[208:211], v[128:131], v[228:231], v[208:211]
    v_mfma_f32_16x16x32_bf16 v[212:215], v[132:135], v[228:231], v[212:215]
    v_max3_u32 v53, v224, v228, v53
    s_waitcnt vmcnt(5)
    v_mfma_f32_16x16x32_bf16 v[196:199], v[136:139], v[232:235], v[196:199]
    v_mfma_f32_16x16x32_bf16 v[200:203], v[140:143], v[232:235], v[200:203]
    v_mfma_f32_16x16x32_bf16 v[204:207], v[144:147], v[232:235], v[204:207]
    v_mfma_f32_16x16x32_bf16 v[208:211], v[148:151], v[232:235], v[208:211]
    v_mfma_f32_16x16x32_bf16 v[212:215], v[152:155], v[232:235], v[212:215]
    s_waitcnt vmcnt(4)
    v_mfma_f32_16x16x32_bf16 v[196:199], v[156:159], v[236:239], v[196:199]
    v_mfma_f32_16x16x32_bf16 v[200:203], v[160:163], v[236:239], v[200:203]
    v_mfma_f32_16x16x32_bf16 v[204:207], v[164:167], v[236:239], v[204:207]
    v_mfma_f32_16x16x32_bf16 v[208:211], v[168:171], v[236:239], v[208:211]
    v_mfma_f32_16x16x32_bf16 v[212:215], v[172:175], v[236:239], v[212:215]
    v_max3_u32 v53, v232, v236, v53
    s_waitcnt vmcnt(3)
    v_mfma_f32_16x16x32_bf16 v[196:199], v[176:179], v[240:243], v[196:199]
    v_mfma_f32_16x16x32_bf16 v[200:203], v[180:183], v[240:243], v[200:203]
    v_mfma_f32_16x16x32_bf16 v[204:207], v[184:187], v[240:243], v[204:207]
    v_mfma_f32_16x16x32_bf16 v[208:211], v[188:191], v[240:243], v[208:211]
    v_mfma_f32_16x16x32_bf16 v[212:215], v[192:195], v[240:243], v[212:215]
    s_waitcnt vmcnt(2)
    s_waitcnt lgkmcnt(10)
    v_mfma_f32_16x16x32_bf16 v[196:199], v[56:59], v[244:247], v[196:199]
    v_mfma_f32_16x16x32_bf16 v[200:203], v[60:63], v[244:247], v[200:203]
    v_mfma_f32_16x16x32_bf16 v[204:207], v[64:67], v[244:247], v[204:207]
    v_mfma_f32_16x16x32_bf16 v[208:211], v[68:71], v[244:247], v[208:211]
    v_mfma_f32_16x16x32_bf16 v[212:215], v[72:75], v[244:247], v[212:215]
    v_max3_u32 v53, v240, v244, v53
    s_waitcnt vmcnt(1)
    s_waitcnt lgkmcnt(5)
    v_mfma_f32_16x16x32_bf16 v[196:199], v[76:79], v[248:251], v[196:199]
    v_mfma_f32_16x16x32_bf16 v[200:203], v[80:83], v[248:251], v[200:203]
    v_mfma_f32_16x16x32_bf16 v[204:207], v[84:87], v[248:251], v[204:207]
    v_mfma_f32_16x16x32_bf16 v[208:211], v[88:91], v[248:251], v[208:211]
    v_mfma_f32_16x16x32_bf16 v[212:215], v[92:95], v[248:251], v[212:215]
    s_waitcnt vmcnt(0)
    s_waitcnt lgkmcnt(0)
    v_mfma_f32_16x16x32_bf16 v[196:199], v[96:99], v[252:255], v[196:199]
    v_mfma_f32_16x16x32_bf16 v[200:203], v[100:103], v[252:255], v[200:203]
    v_mfma_f32_16x16x32_bf16 v[204:207], v[104:107], v[252:255], v[204:207]
    v_mfma_f32_16x16x32_bf16 v[208:211], v[108:111], v[252:255], v[208:211]
    v_mfma_f32_16x16x32_bf16 v[212:215], v[112:115], v[252:255], v[212:215]
    v_max3_u32 v53, v248, v252, v53
    v_cmp_eq_u32 vcc, -1, v53
    s_and_b32 s61, s52, 3
    s_mul_i32 s61, s61, 5120
    s_add_u32 s61, s61, 102400
    v_add_u32 v8, s61, v7
    s_cbranch_vccz Lok_255
    s_sub_u32 s91, s91, 1
    s_cbranch_scc0 L_redo
Lok_255:
    s_cmp_ge_u32 s52, 4
    s_cbranch_scc1 L_finB
    ds_write_b128 v8, v[196:199] offset:0
    ds_write_b128 v8, v[200:203] offset:1024
    ds_write_b128 v8, v[204:207] offset:2048
    ds_write_b128 v8, v[208:211] offset:3072
    ds_write_b128 v8, v[212:215] offset:4096
    s_waitcnt lgkmcnt(0)
    s_barrier
    s_branch L_done
L_finB:
    s_mov_b32 s61, 0xffff0000
    v_lshlrev_b32 v76, 16, v30
    v_and_b32 v77, s61, v30
    v_lshlrev_b32 v78, 16, v31
    v_and_b32 v79, s61, v31
    v_lshlrev_b32 v80, 16, v32
    v_and_b32 v81, s61, v32
    v_lshlrev_b32 v82, 16, v33
    v_and_b32 v83, s61, v33
    v_lshlrev_b32 v84, 16, v34
    v_and_b32 v85, s61, v34
    v_lshlrev_b32 v86, 16, v35
    v_and_b32 v87, s61, v35
    v_lshlrev_b32 v88, 16, v36
    v_and_b32 v89, s61, v36
    v_lshlrev_b32 v90, 16, v37
    v_and_b32 v91, s61, v37
    v_lshlrev_b32 v92, 16, v38
    v_and_b32 v93, s61, v38
    v_lshlrev_b32 v94, 16, v39
    v_and_b32 v95, s61, v39
    s_barrier
    ds_read_b128 v[56:59], v8 offset:0
    ds_read_b128 v[60:63], v8 offset:1024
    ds_read_b128 v[64:67], v8 offset:2048
    ds_read_b128 v[68:71], v8 offset:3072
    ds_read_b128 v[72:75], v8 offset:4096
    s_waitcnt lgkmcnt(0)
    v_pk_add_f32 v[196:197], v[196:197], v[56:57]
    v_pk_add_f32 v[198:199], v[198:199], v[58:59]
    v_pk_add_f32 v[200:201], v[200:201], v[60:61]
    v_pk_add_f32 v[202:203], v[202:203], v[62:63]
    v_pk_add_f32 v[204:205], v[204:205], v[64:65]
    v_pk_add_f32 v[206:207], v[206:207], v[66:67]
    v_pk_add_f32 v[208:209], v[208:209], v[68:69]
    v_pk_add_f32 v[210:211], v[210:211], v[70:71]
    v_pk_add_f32 v[212:213], v[212:213], v[72:73]
    v_pk_add_f32 v[214:215], v[214:215], v[74:75]
    v_fma_f32 v196, v196, v12, v76
    v_fma_f32 v197, v197, v13, v77
    v_fma_f32 v198, v198, v14, v78
    v_fma_f32 v199, v199, v15, v79
    v_fma_f32 v200, v200, v16, v80
    v_fma_f32 v201, v201, v17, v81
    v_fma_f32 v202, v202, v18, v82
    v_fma_f32 v203, v203, v19, v83
    v_fma_f32 v204, v204, v20, v84
    v_fma_f32 v205, v205, v21, v85
    v_fma_f32 v206, v206, v22, v86
    v_fma_f32 v207, v207, v23, v87
    v_fma_f32 v208, v208, v24, v88
    v_fma_f32 v209, v209, v26, v89
    v_fma_f32 v210, v210, v27, v90
    v_fma_f32 v211, v211, v28, v91
    v_fma_f32 v212, v212, v29, v92
    v_fma_f32 v213, v213, v48, v93
    v_fma_f32 v214, v214, v49, v94
    v_fma_f32 v215, v215, v50, v95
    v_cvt_pk_bf16_f32 v56, v196, v197
    v_cvt_pk_bf16_f32 v57, v198, v199
    v_cvt_pk_bf16_f32 v58, v200, v201
    v_cvt_pk_bf16_f32 v59, v202, v203
    v_cvt_pk_bf16_f32 v60, v204, v205
    v_cvt_pk_bf16_f32 v61, v206, v207
    v_cvt_pk_bf16_f32 v62, v208, v209
    v_cvt_pk_bf16_f32 v63, v210, v211
    v_cvt_pk_bf16_f32 v64, v212, v213
    v_cvt_pk_bf16_f32 v65, v214, v215
    buffer_store_dwordx2 v[56:57], v46, s[40:43], s100 offen offset:0
    buffer_store_dwordx2 v[58:59], v46, s[40:43], s100 offen offset:32
    buffer_store_dwordx2 v[60:61], v46, s[40:43], s100 offen offset:64
    buffer_store_dwordx2 v[62:63], v46, s[40:43], s100 offen offset:96
    buffer_store_dwordx2 v[64:65], v46, s[40:43], s100 offen offset:128
L_done:
L_end:
    s_endpgm
.section .rodata,"a"
.p2align 6
.amdhsa_kernel recurrent_scan__grouped_kv_mqa__mixer_gmlp__prompt_kernel
  .amdhsa_next_free_vgpr 256
  .amdhsa_next_free_sgpr 102
  .amdhsa_accum_offset 256
  .amdhsa_group_segment_fixed_size 0
  .amdhsa_kernarg_size 104
  .amdhsa_user_sgpr_count 2
  .amdhsa_user_sgpr_kernarg_segment_ptr 1
  .amdhsa_system_sgpr_workgroup_id_x 1
.end_amdhsa_kernel
```
